```python
import torch

def _softmax(x, axis=-1):
    return torch.softmax(x, dim=axis)

def _gelu(x):
    return torch.nn.functional.gelu(x, approximate='tanh')

def _silu(x):
    return torch.nn.functional.silu(x)

def _sigmoid(x):
    return torch.sigmoid(x)

def _layernorm(x, axis=-1, eps=1e-05):
    m = x.mean(dim=axis, keepdim=True)
    v = x.var(dim=axis, keepdim=True, unbiased=False)
    return (x - m) / torch.sqrt(v + eps)

def _scatter_add(tgt, idx, src, axis=0):
    return tgt.clone().index_add_(axis, idx, src)

def _segment_sum(src, seg, n):
    out = torch.zeros((n,) + src.shape[1:], dtype=src.dtype)
    return out.index_add_(0, seg, src)

def _pad(x, pw):
    flat = tuple((v for pair in reversed(pw) for v in pair))
    return torch.nn.functional.pad(x, flat)
kernel_name = 'adaLN_cond__ssm_conv_s4__mixer_gmlp__prompt'

def setup_inputs():

    _w = lambda a: (lambda t: t.to(torch.bfloat16) if t.is_floating_point() else t)(torch.as_tensor(a))

    def _A_setup():
        B, L, D, N = (1, 2048, 640, 128)
        A_re = -(lambda _x: torch.exp(torch.as_tensor(_x)))((lambda *s: torch.randn(*s, dtype=torch.bfloat16) * 3.2)(D, N))
        A_im = torch.pi * (lambda *s: torch.randn(*s, dtype=torch.bfloat16) * 0.1)(D, N)
        B_re = (lambda *s: torch.randn(*s, dtype=torch.bfloat16) * 0.2)(D, N)
        B_im = (lambda *s: torch.randn(*s, dtype=torch.bfloat16) * 0.2)(D, N)
        C_re = (lambda *s: torch.randn(*s, dtype=torch.bfloat16) * 0.2)(D, N)
        C_im = (lambda *s: torch.randn(*s, dtype=torch.bfloat16) * 0.2)(D, N)
        log_dt = (lambda *s: torch.randn(*s, dtype=torch.bfloat16) * 0.1)(D) * 0.5 - 4.0
        Dskip = (lambda *s: torch.randn(*s, dtype=torch.bfloat16) * 0.1)(D)
        return {'u': _w((lambda *s: torch.randn(*s, dtype=torch.bfloat16) * 0.05)(B, L, D)), 'A_re': _w(A_re), 'A_im': _w(A_im), 'B_re': _w(B_re), 'B_im': _w(B_im), 'C_re': _w(C_re), 'C_im': _w(C_im), 'log_dt': _w(log_dt), 'Dskip': _w(Dskip)}
    _A_in = _A_setup()

    def _B_setup():
        B, S, D, F = (1, 2048, 640, 1728)
        Fh = F // 2
        return {'x': _w((lambda *s: torch.randn(*s, dtype=torch.bfloat16) * 0.05)(B, S, D)), 'w_in': _w((lambda *s: torch.randn(*s, dtype=torch.bfloat16) * 0.2)(D, 2 * Fh)), 'w_sp': _w(0.01 * (lambda *s: torch.randn(*s, dtype=torch.bfloat16) * 0.2)(S, S)), 'b_sp': _w(1.0 + 0.01 * (lambda *s: torch.randn(*s, dtype=torch.bfloat16) * 0.05)(S)), 'w_out': _w((lambda *s: torch.randn(*s, dtype=torch.bfloat16) * 0.05)(Fh, D))}
    _B_in = _B_setup()
    return {'A_u': _A_in['u'], 'A_A_re': _A_in['A_re'], 'A_A_im': _A_in['A_im'], 'A_B_re': _A_in['B_re'], 'A_B_im': _A_in['B_im'], 'A_C_re': _A_in['C_re'], 'A_C_im': _A_in['C_im'], 'A_log_dt': _A_in['log_dt'], 'A_Dskip': _A_in['Dskip'], 'B_x': _B_in['x'], 'B_w_in': _B_in['w_in'], 'B_w_sp': _B_in['w_sp'], 'B_b_sp': _B_in['b_sp'], 'B_w_out': _B_in['w_out'], 'c': _w((lambda *s: torch.randn(*s, dtype=torch.bfloat16) * 0.1)(1, 640) * 8.0), 'w_mod': _w((lambda *s: torch.randn(*s, dtype=torch.bfloat16) * 0.1)(640, 6 * 640) * 640 ** (-0.5) * 8.0)}

def reference(A_u, A_A_re, A_A_im, A_B_re, A_B_im, A_C_re, A_C_im, A_log_dt, A_Dskip, B_x, B_w_in, B_w_sp, B_b_sp, B_w_out, c, w_mod):

    def _A_ref(u, A_re, A_im, B_re, B_im, C_re, C_im, log_dt, Dskip):
        Bsz, L, D = u.shape
        dt = torch.exp(log_dt)[:, None]
        A = A_re + 1j * A_im
        Bc = B_re + 1j * B_im
        Cc = C_re + 1j * C_im
        logdA = dt * A
        dB = dt * Bc
        l = (lambda x, dt: x.to(dt))(torch.arange(L), A_re.dtype)
        P = torch.exp(logdA[:, :, None] * l[None, None, :])
        K = torch.einsum('dn,dnl,dn->dl', Cc, P, dB).real
        L2 = 2 * L
        Kp = _pad(K, ((0, 0), (0, L)))
        up = (lambda x, *d: x.permute(*d))(u, 0, 2, 1)
        up = _pad(up, ((0, 0), (0, 0), (0, L)))
        Kf = (lambda x, axes=(-2, -1): torch.fft.rfft2(x.float(), dim=axes))(Kp[:, None, :], axes=(-2, -1))
        Uf = (lambda x, axes=(-2, -1): torch.fft.rfft2(x.float(), dim=axes))(up[:, :, None, :], axes=(-2, -1))
        Yf = Uf * Kf[None, :, :, :]
        y = (lambda x, s, axes=(-2, -1): torch.fft.irfft2(x, s=s, dim=axes).to(torch.bfloat16))(Yf, (1, L2), axes=(-2, -1))[:, :, 0, :L]
        y = (lambda x, *d: x.permute(*d))(y, 0, 2, 1) + u * Dskip[None, None, :]
        return y

    def _B_ref(x, w_in, w_sp, b_sp, w_out):
        B, S, D = x.shape
        F = w_in.shape[-1]
        Fh = F // 2
        z = _gelu(torch.einsum('bsd,df->bsf', x, w_in))
        z1 = z[..., :Fh].clone()
        z2 = _layernorm(z[..., Fh:], axis=-1)
        g = torch.einsum('ts,bsf->btf', w_sp, z2) + b_sp[None, :, None]
        return torch.einsum('bsf,fd->bsd', z1 * g, w_out)
    x = A_u
    mod = (_silu(c) @ w_mod).reshape(c.shape[0], 6, 1, -1)
    sa, ca, ga, sb, cb, gb = (mod[:, 0].clone(), mod[:, 1].clone(), mod[:, 2].clone(), mod[:, 3].clone(), mod[:, 4].clone(), mod[:, 5].clone())
    h = _layernorm(x, axis=-1) * (1 + ca) + sa
    x = x + ga * _A_ref(h, A_A_re, A_A_im, A_B_re, A_B_im, A_C_re, A_C_im, A_log_dt, A_Dskip)
    h = _layernorm(x, axis=-1) * (1 + cb) + sb
    x = x + gb * _B_ref(h, B_w_in, B_w_sp, B_b_sp, B_w_out)
    return x
```

```asm
; @launch kernel=prep_kernel grid=(1070,1,1) block=(256,1,1) lds=32768
; @launch kernel=conv_kernel grid=(772,1,1) block=(256,1,1) lds=38912
; @launch kernel=gemm_kernel grid=(256,1,1) block=(256,1,1) lds=149504
.amdgcn_target "amdgcn-amd-amdhsa--gfx950"
.text
.globl prep_kernel
.p2align 8
.type prep_kernel,@function
prep_kernel:
    s_cmp_lt_u32 s2, 8
    s_cbranch_scc1 k1_code
    s_cmp_ge_u32 s2, 1070
    s_cbranch_scc1 k1_exit
    s_sub_u32 s2, s2, 8
    s_load_dwordx16 s[16:31], s[0:1], 0
    s_load_dwordx16 s[32:47], s[0:1], 64
    s_load_dwordx4 s[48:51], s[0:1], 128
    s_load_dwordx2 s[52:53], s[0:1], 144
    s_waitcnt lgkmcnt(0)
    s_cmp_ge_u32 s2, 1008
    s_cbranch_scc1 k1_wof
    s_cmp_ge_u32 s2, 768
    s_cbranch_scc1 k1_mod
    s_cmp_ge_u32 s2, 640
    s_cbranch_scc1 k1_ln1
    s_branch k1_kgen
k1_code:
    s_getpc_b64 s[4:5]
k1ct_here:
    s_sub_u32 s4, s4, k1ct_here-prep_kernel
    s_subb_u32 s5, s5, 0
    v_lshlrev_b32 v1, 4, v0
    global_load_dwordx4 v[4:7], v1, s[4:5]
    s_add_u32 s4, s4, 4096
    s_addc_u32 s5, s5, 0
    global_load_dwordx4 v[8:11], v1, s[4:5]
    s_add_u32 s4, s4, 4096
    s_addc_u32 s5, s5, 0
    global_load_dwordx4 v[12:15], v1, s[4:5]
    s_add_u32 s4, s4, 4096
    s_addc_u32 s5, s5, 0
    global_load_dwordx4 v[16:19], v1, s[4:5]
    s_add_u32 s4, s4, 4096
    s_addc_u32 s5, s5, 0
    global_load_dwordx4 v[20:23], v1, s[4:5]
    s_add_u32 s4, s4, 4096
    s_addc_u32 s5, s5, 0
    global_load_dwordx4 v[24:27], v1, s[4:5]
    s_add_u32 s4, s4, 4096
    s_addc_u32 s5, s5, 0
    global_load_dwordx4 v[28:31], v1, s[4:5]
    s_add_u32 s4, s4, 4096
    s_addc_u32 s5, s5, 0
    global_load_dwordx4 v[32:35], v1, s[4:5]
    s_add_u32 s4, s4, 4096
    s_addc_u32 s5, s5, 0
    global_load_dwordx4 v[4:7], v1, s[4:5]
    s_add_u32 s4, s4, 4096
    s_addc_u32 s5, s5, 0
    global_load_dwordx4 v[8:11], v1, s[4:5]
    s_add_u32 s4, s4, 4096
    s_addc_u32 s5, s5, 0
    global_load_dwordx4 v[12:15], v1, s[4:5]
    s_add_u32 s4, s4, 4096
    s_addc_u32 s5, s5, 0
    global_load_dwordx4 v[16:19], v1, s[4:5]
    s_add_u32 s4, s4, 4096
    s_addc_u32 s5, s5, 0
    s_waitcnt vmcnt(0)
    s_endpgm
k1_kgen:
    s_mov_b32 s56, s18
    s_mov_b32 s57, s19
    s_mov_b32 s58, 163840
    s_mov_b32 s59, 0x00020000
    s_mov_b32 s60, s20
    s_mov_b32 s61, s21
    s_mov_b32 s62, 163840
    s_mov_b32 s63, 0x00020000
    s_mov_b32 s64, s22
    s_mov_b32 s65, s23
    s_mov_b32 s66, 163840
    s_mov_b32 s67, 0x00020000
    s_mov_b32 s68, s24
    s_mov_b32 s69, s25
    s_mov_b32 s70, 163840
    s_mov_b32 s71, 0x00020000
    s_mov_b32 s72, s26
    s_mov_b32 s73, s27
    s_mov_b32 s74, 163840
    s_mov_b32 s75, 0x00020000
    s_mov_b32 s76, s28
    s_mov_b32 s77, s29
    s_mov_b32 s78, 163840
    s_mov_b32 s79, 0x00020000
    s_mov_b32 s80, s30
    s_mov_b32 s81, s31
    s_mov_b32 s82, 1280
    s_mov_b32 s83, 0x00020000
    s_add_u32 s84, s52, 5353472
    s_addc_u32 s85, s53, 0
    s_mov_b32 s86, 2641920
    s_mov_b32 s87, 0x00020000
    s_mov_b32 s3, s2
    v_and_b32 v1, 127, v0
    v_lshlrev_b32 v2, 1, v1
    s_lshl_b32 s4, s3, 8
    s_lshl_b32 s5, s3, 1
    v_mov_b32 v3, 0
    buffer_load_ushort v16, v3, s[80:83], s5 offen
    buffer_load_ushort v10, v2, s[56:59], s4 offen
    buffer_load_ushort v11, v2, s[60:63], s4 offen
    buffer_load_ushort v12, v2, s[64:67], s4 offen
    buffer_load_ushort v13, v2, s[68:71], s4 offen
    buffer_load_ushort v14, v2, s[72:75], s4 offen
    buffer_load_ushort v15, v2, s[76:79], s4 offen
    v_lshrrev_b32 v4, 6, v0
    v_lshlrev_b32 v5, 2, v1
    v_readfirstlane_b32 s6, v4
    s_waitcnt vmcnt(0)
    v_lshlrev_b32 v10, 16, v10
    v_lshlrev_b32 v11, 16, v11
    v_lshlrev_b32 v12, 16, v12
    v_lshlrev_b32 v13, 16, v13
    v_lshlrev_b32 v14, 16, v14
    v_lshlrev_b32 v15, 16, v15
    v_lshlrev_b32 v16, 16, v16
    v_mul_f32 v16, 0x3fb8aa3b, v16
    v_exp_f32 v16, v16
    s_nop 0
    v_cvt_pk_bf16_f32 v16, v16, v16
    v_lshlrev_b32 v16, 16, v16
    v_mul_f32 v10, v16, v10
    v_mul_f32 v10, 0x3fb8aa3b, v10
    v_mul_f32 v11, v16, v11
    v_mul_f32 v11, 0x3e22f983, v11
    v_mul_f32 v12, v16, v12
    v_mul_f32 v13, v16, v13
    v_mul_f32 v18, v14, v12
    v_fma_f32 v18, -v15, v13, v18
    v_mul_f32 v19, v14, v13
    v_fma_f32 v19, v15, v12, v19
    v_mul_f32 v6, v18, v18
    v_fma_f32 v6, v19, v19, v6
    v_max_f32 v6, 0x03aa2425, v6
    v_log_f32 v6, v6
    s_nop 0
    v_mul_f32 v7, 0x3e800000, v6
    v_exp_f32 v8, v7
    v_exp_f32 v7, -v7
    s_nop 0
    v_mul_f32 v18, v18, v7
    v_mul_f32 v19, v19, v7
    s_cmp_ge_u32 s6, 2
    s_cbranch_scc1 k1_kg_g1
    v_mul_f32 v6, 0x3f800000, v10
    v_mul_f32 v7, 0x3f800000, v11
    v_exp_f32 v6, v6
    v_fract_f32 v7, v7
    v_cos_f32 v20, v7
    v_sin_f32 v21, v7
    s_nop 0
    v_mul_f32 v20, v20, v6
    v_mul_f32 v21, v21, v6
    v_mul_f32 v6, 0x43000000, v10
    v_mul_f32 v7, 0x43000000, v11
    v_exp_f32 v6, v6
    v_fract_f32 v7, v7
    v_cos_f32 v22, v7
    v_sin_f32 v23, v7
    s_nop 0
    v_mul_f32 v22, v22, v6
    v_mul_f32 v23, v23, v6
    v_mul_f32 v6, 0x43800000, v10
    v_mul_f32 v7, 0x43800000, v11
    v_exp_f32 v6, v6
    v_fract_f32 v7, v7
    v_cos_f32 v24, v7
    v_sin_f32 v25, v7
    s_nop 0
    v_mul_f32 v24, v24, v6
    v_mul_f32 v25, v25, v6
    v_mul_f32 v6, 0x41000000, v10
    v_mul_f32 v7, 0x41000000, v11
    v_exp_f32 v6, v6
    v_fract_f32 v7, v7
    v_cos_f32 v26, v7
    v_sin_f32 v27, v7
    s_nop 0
    v_mul_f32 v26, v26, v6
    v_mul_f32 v27, v27, v6
    v_mov_b32 v28, v18
    v_mov_b32 v29, v19
    v_cvt_pk_f16_f32 v60, v28, -v29
    ds_write_b32 v5, v60 offset:0
    v_mov_b32 v48, v8
    v_mov_b32 v49, 0
    v_cvt_pk_f16_f32 v61, v48, v49
    ds_write_b32 v5, v61 offset:22304
    v_pk_mul_f32 v[30:31], v[28:29], v[20:21] op_sel:[0,0] op_sel_hi:[0,1]
    v_pk_fma_f32 v[30:31], v[28:29], v[20:21], v[30:31] op_sel:[1,1,0] op_sel_hi:[1,0,1] neg_lo:[0,1,0]
    v_cvt_pk_f16_f32 v62, v30, -v31
    ds_write_b32 v5, v62 offset:544
    v_pk_mul_f32 v[50:51], v[48:49], v[26:27] op_sel:[0,0] op_sel_hi:[0,1]
    v_pk_fma_f32 v[50:51], v[48:49], v[26:27], v[50:51] op_sel:[1,1,0] op_sel_hi:[1,0,1] neg_lo:[0,1,0]
    v_cvt_pk_f16_f32 v63, v50, v51
    ds_write_b32 v5, v63 offset:22848
    v_pk_mul_f32 v[32:33], v[30:31], v[20:21] op_sel:[0,0] op_sel_hi:[0,1]
    v_pk_fma_f32 v[32:33], v[30:31], v[20:21], v[32:33] op_sel:[1,1,0] op_sel_hi:[1,0,1] neg_lo:[0,1,0]
    v_cvt_pk_f16_f32 v64, v32, -v33
    ds_write_b32 v5, v64 offset:1088
    v_pk_mul_f32 v[48:49], v[50:51], v[26:27] op_sel:[0,0] op_sel_hi:[0,1]
    v_pk_fma_f32 v[48:49], v[50:51], v[26:27], v[48:49] op_sel:[1,1,0] op_sel_hi:[1,0,1] neg_lo:[0,1,0]
    v_cvt_pk_f16_f32 v65, v48, v49
    ds_write_b32 v5, v65 offset:23392
    v_pk_mul_f32 v[34:35], v[32:33], v[20:21] op_sel:[0,0] op_sel_hi:[0,1]
    v_pk_fma_f32 v[34:35], v[32:33], v[20:21], v[34:35] op_sel:[1,1,0] op_sel_hi:[1,0,1] neg_lo:[0,1,0]
    v_cvt_pk_f16_f32 v66, v34, -v35
    ds_write_b32 v5, v66 offset:1632
    v_pk_mul_f32 v[50:51], v[48:49], v[26:27] op_sel:[0,0] op_sel_hi:[0,1]
    v_pk_fma_f32 v[50:51], v[48:49], v[26:27], v[50:51] op_sel:[1,1,0] op_sel_hi:[1,0,1] neg_lo:[0,1,0]
    v_cvt_pk_f16_f32 v67, v50, v51
    ds_write_b32 v5, v67 offset:23936
    v_pk_mul_f32 v[36:37], v[34:35], v[20:21] op_sel:[0,0] op_sel_hi:[0,1]
    v_pk_fma_f32 v[36:37], v[34:35], v[20:21], v[36:37] op_sel:[1,1,0] op_sel_hi:[1,0,1] neg_lo:[0,1,0]
    v_cvt_pk_f16_f32 v60, v36, -v37
    ds_write_b32 v5, v60 offset:2176
    v_pk_mul_f32 v[48:49], v[50:51], v[26:27] op_sel:[0,0] op_sel_hi:[0,1]
    v_pk_fma_f32 v[48:49], v[50:51], v[26:27], v[48:49] op_sel:[1,1,0] op_sel_hi:[1,0,1] neg_lo:[0,1,0]
    v_cvt_pk_f16_f32 v61, v48, v49
    ds_write_b32 v5, v61 offset:24480
    v_pk_mul_f32 v[38:39], v[36:37], v[20:21] op_sel:[0,0] op_sel_hi:[0,1]
    v_pk_fma_f32 v[38:39], v[36:37], v[20:21], v[38:39] op_sel:[1,1,0] op_sel_hi:[1,0,1] neg_lo:[0,1,0]
    v_cvt_pk_f16_f32 v62, v38, -v39
    ds_write_b32 v5, v62 offset:2720
    v_pk_mul_f32 v[50:51], v[48:49], v[26:27] op_sel:[0,0] op_sel_hi:[0,1]
    v_pk_fma_f32 v[50:51], v[48:49], v[26:27], v[50:51] op_sel:[1,1,0] op_sel_hi:[1,0,1] neg_lo:[0,1,0]
    v_cvt_pk_f16_f32 v63, v50, v51
    ds_write_b32 v5, v63 offset:25024
    v_pk_mul_f32 v[40:41], v[38:39], v[20:21] op_sel:[0,0] op_sel_hi:[0,1]
    v_pk_fma_f32 v[40:41], v[38:39], v[20:21], v[40:41] op_sel:[1,1,0] op_sel_hi:[1,0,1] neg_lo:[0,1,0]
    v_cvt_pk_f16_f32 v64, v40, -v41
    ds_write_b32 v5, v64 offset:3264
    v_pk_mul_f32 v[48:49], v[50:51], v[26:27] op_sel:[0,0] op_sel_hi:[0,1]
    v_pk_fma_f32 v[48:49], v[50:51], v[26:27], v[48:49] op_sel:[1,1,0] op_sel_hi:[1,0,1] neg_lo:[0,1,0]
    v_cvt_pk_f16_f32 v65, v48, v49
    ds_write_b32 v5, v65 offset:25568
    v_pk_mul_f32 v[42:43], v[40:41], v[20:21] op_sel:[0,0] op_sel_hi:[0,1]
    v_pk_fma_f32 v[42:43], v[40:41], v[20:21], v[42:43] op_sel:[1,1,0] op_sel_hi:[1,0,1] neg_lo:[0,1,0]
    v_cvt_pk_f16_f32 v66, v42, -v43
    ds_write_b32 v5, v66 offset:3808
    v_pk_mul_f32 v[50:51], v[48:49], v[26:27] op_sel:[0,0] op_sel_hi:[0,1]
    v_pk_fma_f32 v[50:51], v[48:49], v[26:27], v[50:51] op_sel:[1,1,0] op_sel_hi:[1,0,1] neg_lo:[0,1,0]
    v_cvt_pk_f16_f32 v67, v50, v51
    ds_write_b32 v5, v67 offset:26112
    v_pk_mul_f32 v[44:45], v[28:29], v[22:23] op_sel:[0,0] op_sel_hi:[0,1]
    v_pk_fma_f32 v[44:45], v[28:29], v[22:23], v[44:45] op_sel:[1,1,0] op_sel_hi:[1,0,1] neg_lo:[0,1,0]
    v_cvt_pk_f16_f32 v60, v44, -v45
    ds_write_b32 v5, v60 offset:4352
    v_pk_mul_f32 v[52:53], v[44:45], v[24:25] op_sel:[0,0] op_sel_hi:[0,1]
    v_pk_fma_f32 v[52:53], v[44:45], v[24:25], v[52:53] op_sel:[1,1,0] op_sel_hi:[1,0,1] neg_lo:[0,1,0]
    v_cvt_pk_f16_f32 v61, v52, -v53
    ds_write_b32 v5, v61 offset:10880
    v_pk_mul_f32 v[54:55], v[28:29], v[24:25] op_sel:[0,0] op_sel_hi:[0,1]
    v_pk_fma_f32 v[54:55], v[28:29], v[24:25], v[54:55] op_sel:[1,1,0] op_sel_hi:[1,0,1] neg_lo:[0,1,0]
    v_cvt_pk_f16_f32 v62, v54, -v55
    ds_write_b32 v5, v62 offset:8704
    v_pk_mul_f32 v[46:47], v[30:31], v[22:23] op_sel:[0,0] op_sel_hi:[0,1]
    v_pk_fma_f32 v[46:47], v[30:31], v[22:23], v[46:47] op_sel:[1,1,0] op_sel_hi:[1,0,1] neg_lo:[0,1,0]
    v_cvt_pk_f16_f32 v63, v46, -v47
    ds_write_b32 v5, v63 offset:4896
    v_pk_mul_f32 v[44:45], v[32:33], v[22:23] op_sel:[0,0] op_sel_hi:[0,1]
    v_pk_fma_f32 v[44:45], v[32:33], v[22:23], v[44:45] op_sel:[1,1,0] op_sel_hi:[1,0,1] neg_lo:[0,1,0]
    v_cvt_pk_f16_f32 v64, v44, -v45
    ds_write_b32 v5, v64 offset:5440
    v_pk_mul_f32 v[52:53], v[44:45], v[24:25] op_sel:[0,0] op_sel_hi:[0,1]
    v_pk_fma_f32 v[52:53], v[44:45], v[24:25], v[52:53] op_sel:[1,1,0] op_sel_hi:[1,0,1] neg_lo:[0,1,0]
    v_cvt_pk_f16_f32 v65, v52, -v53
    ds_write_b32 v5, v65 offset:11424
    v_pk_mul_f32 v[54:55], v[32:33], v[24:25] op_sel:[0,0] op_sel_hi:[0,1]
    v_pk_fma_f32 v[54:55], v[32:33], v[24:25], v[54:55] op_sel:[1,1,0] op_sel_hi:[1,0,1] neg_lo:[0,1,0]
    v_cvt_pk_f16_f32 v66, v54, -v55
    ds_write_b32 v5, v66 offset:9248
    v_pk_mul_f32 v[46:47], v[34:35], v[22:23] op_sel:[0,0] op_sel_hi:[0,1]
    v_pk_fma_f32 v[46:47], v[34:35], v[22:23], v[46:47] op_sel:[1,1,0] op_sel_hi:[1,0,1] neg_lo:[0,1,0]
    v_cvt_pk_f16_f32 v67, v46, -v47
    ds_write_b32 v5, v67 offset:5984
    v_pk_mul_f32 v[44:45], v[36:37], v[22:23] op_sel:[0,0] op_sel_hi:[0,1]
    v_pk_fma_f32 v[44:45], v[36:37], v[22:23], v[44:45] op_sel:[1,1,0] op_sel_hi:[1,0,1] neg_lo:[0,1,0]
    v_cvt_pk_f16_f32 v60, v44, -v45
    ds_write_b32 v5, v60 offset:6528
    v_pk_mul_f32 v[52:53], v[44:45], v[24:25] op_sel:[0,0] op_sel_hi:[0,1]
    v_pk_fma_f32 v[52:53], v[44:45], v[24:25], v[52:53] op_sel:[1,1,0] op_sel_hi:[1,0,1] neg_lo:[0,1,0]
    v_cvt_pk_f16_f32 v61, v52, -v53
    ds_write_b32 v5, v61 offset:11968
    v_pk_mul_f32 v[54:55], v[36:37], v[24:25] op_sel:[0,0] op_sel_hi:[0,1]
    v_pk_fma_f32 v[54:55], v[36:37], v[24:25], v[54:55] op_sel:[1,1,0] op_sel_hi:[1,0,1] neg_lo:[0,1,0]
    v_cvt_pk_f16_f32 v62, v54, -v55
    ds_write_b32 v5, v62 offset:9792
    v_pk_mul_f32 v[46:47], v[38:39], v[22:23] op_sel:[0,0] op_sel_hi:[0,1]
    v_pk_fma_f32 v[46:47], v[38:39], v[22:23], v[46:47] op_sel:[1,1,0] op_sel_hi:[1,0,1] neg_lo:[0,1,0]
    v_cvt_pk_f16_f32 v63, v46, -v47
    ds_write_b32 v5, v63 offset:7072
    v_pk_mul_f32 v[44:45], v[40:41], v[22:23] op_sel:[0,0] op_sel_hi:[0,1]
    v_pk_fma_f32 v[44:45], v[40:41], v[22:23], v[44:45] op_sel:[1,1,0] op_sel_hi:[1,0,1] neg_lo:[0,1,0]
    v_cvt_pk_f16_f32 v64, v44, -v45
    ds_write_b32 v5, v64 offset:7616
    v_pk_mul_f32 v[52:53], v[44:45], v[24:25] op_sel:[0,0] op_sel_hi:[0,1]
    v_pk_fma_f32 v[52:53], v[44:45], v[24:25], v[52:53] op_sel:[1,1,0] op_sel_hi:[1,0,1] neg_lo:[0,1,0]
    v_cvt_pk_f16_f32 v65, v52, -v53
    ds_write_b32 v5, v65 offset:12512
    v_pk_mul_f32 v[54:55], v[40:41], v[24:25] op_sel:[0,0] op_sel_hi:[0,1]
    v_pk_fma_f32 v[54:55], v[40:41], v[24:25], v[54:55] op_sel:[1,1,0] op_sel_hi:[1,0,1] neg_lo:[0,1,0]
    v_cvt_pk_f16_f32 v66, v54, -v55
    ds_write_b32 v5, v66 offset:10336
    v_pk_mul_f32 v[46:47], v[42:43], v[22:23] op_sel:[0,0] op_sel_hi:[0,1]
    v_pk_fma_f32 v[46:47], v[42:43], v[22:23], v[46:47] op_sel:[1,1,0] op_sel_hi:[1,0,1] neg_lo:[0,1,0]
    v_cvt_pk_f16_f32 v67, v46, -v47
    ds_write_b32 v5, v67 offset:8160
    s_branch k1_kg_join
k1_kg_g1:
    v_mul_f32 v6, 0x40800000, v10
    v_mul_f32 v7, 0x40800000, v11
    v_exp_f32 v6, v6
    v_fract_f32 v7, v7
    v_cos_f32 v20, v7
    v_sin_f32 v21, v7
    s_nop 0
    v_mul_f32 v20, v20, v6
    v_mul_f32 v21, v21, v6
    v_mul_f32 v6, 0x43000000, v10
    v_mul_f32 v7, 0x43000000, v11
    v_exp_f32 v6, v6
    v_fract_f32 v7, v7
    v_cos_f32 v22, v7
    v_sin_f32 v23, v7
    s_nop 0
    v_mul_f32 v22, v22, v6
    v_mul_f32 v23, v23, v6
    v_mul_f32 v6, 0x44800000, v10
    v_mul_f32 v7, 0x44800000, v11
    v_exp_f32 v6, v6
    v_fract_f32 v7, v7
    v_cos_f32 v24, v7
    v_sin_f32 v25, v7
    s_nop 0
    v_mul_f32 v24, v24, v6
    v_mul_f32 v25, v25, v6
    v_mul_f32 v6, 0x41000000, v10
    v_mul_f32 v7, 0x41000000, v11
    v_exp_f32 v6, v6
    v_fract_f32 v7, v7
    v_cos_f32 v26, v7
    v_sin_f32 v27, v7
    s_nop 0
    v_mul_f32 v26, v26, v6
    v_mul_f32 v27, v27, v6
    v_mul_f32 v6, 0x42800000, v10
    v_mul_f32 v7, 0x42800000, v11
    v_exp_f32 v6, v6
    v_fract_f32 v7, v7
    v_cos_f32 v28, v7
    v_sin_f32 v29, v7
    s_nop 0
    v_mul_f32 v28, v28, v6
    v_mul_f32 v29, v29, v6
    v_mul_f32 v48, v28, v8
    v_mul_f32 v49, v29, v8
    v_cvt_pk_f16_f32 v60, v48, v49
    ds_write_b32 v5, v60 offset:26656
    v_pk_mul_f32 v[36:37], v[18:19], v[24:25] op_sel:[0,0] op_sel_hi:[0,1]
    v_pk_fma_f32 v[36:37], v[18:19], v[24:25], v[36:37] op_sel:[1,1,0] op_sel_hi:[1,0,1] neg_lo:[0,1,0]
    v_cvt_pk_f16_f32 v61, v36, -v37
    ds_write_b32 v5, v61 offset:17408
    v_pk_mul_f32 v[40:41], v[36:37], v[24:25] op_sel:[0,0] op_sel_hi:[0,1]
    v_pk_fma_f32 v[40:41], v[36:37], v[24:25], v[40:41] op_sel:[1,1,0] op_sel_hi:[1,0,1] neg_lo:[0,1,0]
    v_cvt_pk_f16_f32 v62, v40, -v41
    ds_write_b32 v5, v62 offset:21760
    v_pk_mul_f32 v[32:33], v[18:19], v[22:23] op_sel:[0,0] op_sel_hi:[0,1]
    v_pk_fma_f32 v[32:33], v[18:19], v[22:23], v[32:33] op_sel:[1,1,0] op_sel_hi:[1,0,1] neg_lo:[0,1,0]
    v_pk_mul_f32 v[50:51], v[48:49], v[26:27] op_sel:[0,0] op_sel_hi:[0,1]
    v_pk_fma_f32 v[50:51], v[48:49], v[26:27], v[50:51] op_sel:[1,1,0] op_sel_hi:[1,0,1] neg_lo:[0,1,0]
    v_cvt_pk_f16_f32 v63, v50, v51
    ds_write_b32 v5, v63 offset:27200
    v_pk_mul_f32 v[38:39], v[32:33], v[24:25] op_sel:[0,0] op_sel_hi:[0,1]
    v_pk_fma_f32 v[38:39], v[32:33], v[24:25], v[38:39] op_sel:[1,1,0] op_sel_hi:[1,0,1] neg_lo:[0,1,0]
    v_cvt_pk_f16_f32 v64, v38, -v39
    ds_write_b32 v5, v64 offset:17952
    v_pk_mul_f32 v[30:31], v[32:33], v[22:23] op_sel:[0,0] op_sel_hi:[0,1]
    v_pk_fma_f32 v[30:31], v[32:33], v[22:23], v[30:31] op_sel:[1,1,0] op_sel_hi:[1,0,1] neg_lo:[0,1,0]
    v_pk_mul_f32 v[48:49], v[50:51], v[26:27] op_sel:[0,0] op_sel_hi:[0,1]
    v_pk_fma_f32 v[48:49], v[50:51], v[26:27], v[48:49] op_sel:[1,1,0] op_sel_hi:[1,0,1] neg_lo:[0,1,0]
    v_cvt_pk_f16_f32 v65, v48, v49
    ds_write_b32 v5, v65 offset:27744
    v_pk_mul_f32 v[36:37], v[30:31], v[24:25] op_sel:[0,0] op_sel_hi:[0,1]
    v_pk_fma_f32 v[36:37], v[30:31], v[24:25], v[36:37] op_sel:[1,1,0] op_sel_hi:[1,0,1] neg_lo:[0,1,0]
    v_cvt_pk_f16_f32 v66, v36, -v37
    ds_write_b32 v5, v66 offset:18496
    v_pk_mul_f32 v[32:33], v[30:31], v[22:23] op_sel:[0,0] op_sel_hi:[0,1]
    v_pk_fma_f32 v[32:33], v[30:31], v[22:23], v[32:33] op_sel:[1,1,0] op_sel_hi:[1,0,1] neg_lo:[0,1,0]
    v_pk_mul_f32 v[50:51], v[48:49], v[26:27] op_sel:[0,0] op_sel_hi:[0,1]
    v_pk_fma_f32 v[50:51], v[48:49], v[26:27], v[50:51] op_sel:[1,1,0] op_sel_hi:[1,0,1] neg_lo:[0,1,0]
    v_cvt_pk_f16_f32 v67, v50, v51
    ds_write_b32 v5, v67 offset:28288
    v_pk_mul_f32 v[38:39], v[32:33], v[24:25] op_sel:[0,0] op_sel_hi:[0,1]
    v_pk_fma_f32 v[38:39], v[32:33], v[24:25], v[38:39] op_sel:[1,1,0] op_sel_hi:[1,0,1] neg_lo:[0,1,0]
    v_cvt_pk_f16_f32 v60, v38, -v39
    ds_write_b32 v5, v60 offset:19040
    v_pk_mul_f32 v[30:31], v[32:33], v[22:23] op_sel:[0,0] op_sel_hi:[0,1]
    v_pk_fma_f32 v[30:31], v[32:33], v[22:23], v[30:31] op_sel:[1,1,0] op_sel_hi:[1,0,1] neg_lo:[0,1,0]
    v_pk_mul_f32 v[48:49], v[50:51], v[26:27] op_sel:[0,0] op_sel_hi:[0,1]
    v_pk_fma_f32 v[48:49], v[50:51], v[26:27], v[48:49] op_sel:[1,1,0] op_sel_hi:[1,0,1] neg_lo:[0,1,0]
    v_cvt_pk_f16_f32 v61, v48, v49
    ds_write_b32 v5, v61 offset:28832
    v_pk_mul_f32 v[36:37], v[30:31], v[24:25] op_sel:[0,0] op_sel_hi:[0,1]
    v_pk_fma_f32 v[36:37], v[30:31], v[24:25], v[36:37] op_sel:[1,1,0] op_sel_hi:[1,0,1] neg_lo:[0,1,0]
    v_cvt_pk_f16_f32 v62, v36, -v37
    ds_write_b32 v5, v62 offset:19584
    v_cvt_pk_f16_f32 v63, v30, -v31
    ds_write_b32 v5, v63 offset:13056
    v_pk_mul_f32 v[42:43], v[30:31], v[20:21] op_sel:[0,0] op_sel_hi:[0,1]
    v_pk_fma_f32 v[42:43], v[30:31], v[20:21], v[42:43] op_sel:[1,1,0] op_sel_hi:[1,0,1] neg_lo:[0,1,0]
    v_cvt_pk_f16_f32 v64, v42, -v43
    ds_write_b32 v5, v64 offset:13600
    v_pk_mul_f32 v[32:33], v[30:31], v[22:23] op_sel:[0,0] op_sel_hi:[0,1]
    v_pk_fma_f32 v[32:33], v[30:31], v[22:23], v[32:33] op_sel:[1,1,0] op_sel_hi:[1,0,1] neg_lo:[0,1,0]
    v_pk_mul_f32 v[50:51], v[48:49], v[26:27] op_sel:[0,0] op_sel_hi:[0,1]
    v_pk_fma_f32 v[50:51], v[48:49], v[26:27], v[50:51] op_sel:[1,1,0] op_sel_hi:[1,0,1] neg_lo:[0,1,0]
    v_cvt_pk_f16_f32 v65, v50, v51
    ds_write_b32 v5, v65 offset:29376
    v_pk_mul_f32 v[38:39], v[32:33], v[24:25] op_sel:[0,0] op_sel_hi:[0,1]
    v_pk_fma_f32 v[38:39], v[32:33], v[24:25], v[38:39] op_sel:[1,1,0] op_sel_hi:[1,0,1] neg_lo:[0,1,0]
    v_cvt_pk_f16_f32 v66, v38, -v39
    ds_write_b32 v5, v66 offset:20128
    v_cvt_pk_f16_f32 v67, v32, -v33
    ds_write_b32 v5, v67 offset:14144
    v_pk_mul_f32 v[42:43], v[32:33], v[20:21] op_sel:[0,0] op_sel_hi:[0,1]
    v_pk_fma_f32 v[42:43], v[32:33], v[20:21], v[42:43] op_sel:[1,1,0] op_sel_hi:[1,0,1] neg_lo:[0,1,0]
    v_cvt_pk_f16_f32 v60, v42, -v43
    ds_write_b32 v5, v60 offset:14688
    v_pk_mul_f32 v[30:31], v[32:33], v[22:23] op_sel:[0,0] op_sel_hi:[0,1]
    v_pk_fma_f32 v[30:31], v[32:33], v[22:23], v[30:31] op_sel:[1,1,0] op_sel_hi:[1,0,1] neg_lo:[0,1,0]
    v_pk_mul_f32 v[48:49], v[50:51], v[26:27] op_sel:[0,0] op_sel_hi:[0,1]
    v_pk_fma_f32 v[48:49], v[50:51], v[26:27], v[48:49] op_sel:[1,1,0] op_sel_hi:[1,0,1] neg_lo:[0,1,0]
    v_cvt_pk_f16_f32 v61, v48, v49
    ds_write_b32 v5, v61 offset:29920
    v_pk_mul_f32 v[36:37], v[30:31], v[24:25] op_sel:[0,0] op_sel_hi:[0,1]
    v_pk_fma_f32 v[36:37], v[30:31], v[24:25], v[36:37] op_sel:[1,1,0] op_sel_hi:[1,0,1] neg_lo:[0,1,0]
    v_cvt_pk_f16_f32 v62, v36, -v37
    ds_write_b32 v5, v62 offset:20672
    v_cvt_pk_f16_f32 v63, v30, -v31
    ds_write_b32 v5, v63 offset:15232
    v_pk_mul_f32 v[42:43], v[30:31], v[20:21] op_sel:[0,0] op_sel_hi:[0,1]
    v_pk_fma_f32 v[42:43], v[30:31], v[20:21], v[42:43] op_sel:[1,1,0] op_sel_hi:[1,0,1] neg_lo:[0,1,0]
    v_cvt_pk_f16_f32 v64, v42, -v43
    ds_write_b32 v5, v64 offset:15776
    v_pk_mul_f32 v[32:33], v[30:31], v[22:23] op_sel:[0,0] op_sel_hi:[0,1]
    v_pk_fma_f32 v[32:33], v[30:31], v[22:23], v[32:33] op_sel:[1,1,0] op_sel_hi:[1,0,1] neg_lo:[0,1,0]
    v_pk_mul_f32 v[50:51], v[48:49], v[26:27] op_sel:[0,0] op_sel_hi:[0,1]
    v_pk_fma_f32 v[50:51], v[48:49], v[26:27], v[50:51] op_sel:[1,1,0] op_sel_hi:[1,0,1] neg_lo:[0,1,0]
    v_cvt_pk_f16_f32 v65, v50, v51
    ds_write_b32 v5, v65 offset:30464
    v_pk_mul_f32 v[38:39], v[32:33], v[24:25] op_sel:[0,0] op_sel_hi:[0,1]
    v_pk_fma_f32 v[38:39], v[32:33], v[24:25], v[38:39] op_sel:[1,1,0] op_sel_hi:[1,0,1] neg_lo:[0,1,0]
    v_cvt_pk_f16_f32 v66, v38, -v39
    ds_write_b32 v5, v66 offset:21216
    v_cvt_pk_f16_f32 v67, v32, -v33
    ds_write_b32 v5, v67 offset:16320
    v_pk_mul_f32 v[42:43], v[32:33], v[20:21] op_sel:[0,0] op_sel_hi:[0,1]
    v_pk_fma_f32 v[42:43], v[32:33], v[20:21], v[42:43] op_sel:[1,1,0] op_sel_hi:[1,0,1] neg_lo:[0,1,0]
    v_cvt_pk_f16_f32 v60, v42, -v43
    ds_write_b32 v5, v60 offset:16864
k1_kg_join:
    v_and_b32 v6, 63, v0
    v_and_b32 v7, 15, v6
    v_lshrrev_b32 v9, 4, v6
    v_mul_u32_u24 v10, 544, v7
    v_lshl_add_u32 v10, v9, 4, v10
    s_mul_i32 s7, s6, 8704
    v_add_u32 v11, s7, v10
    s_waitcnt lgkmcnt(0)
    s_barrier
    s_cmp_ge_u32 s6, 3
    s_cbranch_scc1 k1_kg_gather
    ds_read_b128 v[16:19], v11 offset:0
    ds_read_b128 v[20:23], v10 offset:22304
    ds_read_b128 v[24:27], v11 offset:64
    ds_read_b128 v[28:31], v10 offset:22368
    ds_read_b128 v[32:35], v11 offset:128
    ds_read_b128 v[36:39], v10 offset:22432
    ds_read_b128 v[40:43], v11 offset:192
    ds_read_b128 v[44:47], v10 offset:22496
    ds_read_b128 v[48:51], v11 offset:256
    ds_read_b128 v[52:55], v10 offset:22560
    ds_read_b128 v[56:59], v11 offset:320
    ds_read_b128 v[60:63], v10 offset:22624
    ds_read_b128 v[64:67], v11 offset:384
    ds_read_b128 v[68:71], v10 offset:22688
    ds_read_b128 v[72:75], v11 offset:448
    ds_read_b128 v[76:79], v10 offset:22752
    s_cmp_eq_u32 s6, 1
    s_cbranch_scc1 k1_kg_w1
    s_cmp_eq_u32 s6, 2
    s_cbranch_scc1 k1_kg_w2
    v_lshrrev_b32 v12, 1, v9
    v_lshlrev_b32 v12, 7, v12
    v_and_b32 v13, 1, v9
    v_lshl_add_u32 v12, v13, 2, v12
    v_lshl_add_u32 v12, v7, 3, v12
    v_add_u32 v13, 1, v12
    v_add_u32 v14, 2, v12
    v_add_u32 v15, 3, v12
    s_branch k1_kg_wj
k1_kg_w1:
    v_lshlrev_b32 v12, 6, v9
    v_add_u32 v12, 256, v12
    v_lshl_add_u32 v13, v7, 2, v12
    v_lshl_add_u32 v14, v7, 1, v12
    v_cmp_gt_u32 vcc, 2, v9
    s_nop 1
    v_cndmask_b32 v12, v14, v13, vcc
    v_mov_b32 v14, 32
    v_cndmask_b32_e64 v14, v14, 2, vcc
    v_add_u32 v13, 1, v12
    v_add_u32 v14, v14, v12
    v_add_u32 v15, 1, v14
    s_branch k1_kg_wj
k1_kg_w2:
    v_lshlrev_b32 v12, 6, v9
    v_add_u32 v12, 512, v12
    v_add_u32 v12, v12, v7
    v_add_u32 v13, 16, v12
    v_add_u32 v14, 32, v12
    v_add_u32 v15, 48, v12
k1_kg_wj:
    v_lshlrev_b32 v12, 1, v12
    v_lshlrev_b32 v13, 1, v13
    v_lshlrev_b32 v14, 1, v14
    v_lshlrev_b32 v15, 1, v15
    s_waitcnt lgkmcnt(14)
    v_mfma_f32_16x16x32_f16 v[80:83], v[16:19], v[20:23], 0
    s_waitcnt lgkmcnt(12)
    v_mfma_f32_16x16x32_f16 v[80:83], v[24:27], v[28:31], v[80:83]
    s_waitcnt lgkmcnt(10)
    v_mfma_f32_16x16x32_f16 v[80:83], v[32:35], v[36:39], v[80:83]
    s_waitcnt lgkmcnt(8)
    v_mfma_f32_16x16x32_f16 v[80:83], v[40:43], v[44:47], v[80:83]
    s_waitcnt lgkmcnt(6)
    v_mfma_f32_16x16x32_f16 v[80:83], v[48:51], v[52:55], v[80:83]
    s_waitcnt lgkmcnt(4)
    v_mfma_f32_16x16x32_f16 v[80:83], v[56:59], v[60:63], v[80:83]
    s_waitcnt lgkmcnt(2)
    v_mfma_f32_16x16x32_f16 v[80:83], v[64:67], v[68:71], v[80:83]
    s_waitcnt lgkmcnt(0)
    v_mfma_f32_16x16x32_f16 v[80:83], v[72:75], v[76:79], v[80:83]
    s_nop 7
    v_cvt_pk_bf16_f32 v84, v80, v81
    v_cvt_pk_bf16_f32 v85, v82, v83
    ds_write_b16 v12, v84 offset:31008
    ds_write_b16_d16_hi v13, v84 offset:31008
    ds_write_b16 v14, v85 offset:31008
    ds_write_b16_d16_hi v15, v85 offset:31008
k1_kg_gather:
    v_lshlrev_b32 v6, 3, v0
    v_sub_u32 v6, 2047, v6
    v_subrev_u32 v16, 0, v6
    v_cvt_f32_u32 v24, v16
    v_subrev_u32 v17, 1, v6
    v_cvt_f32_u32 v25, v17
    v_subrev_u32 v18, 2, v6
    v_cvt_f32_u32 v26, v18
    v_subrev_u32 v19, 3, v6
    v_cvt_f32_u32 v27, v19
    v_subrev_u32 v20, 4, v6
    v_cvt_f32_u32 v28, v20
    v_subrev_u32 v21, 5, v6
    v_cvt_f32_u32 v29, v21
    v_subrev_u32 v22, 6, v6
    v_cvt_f32_u32 v30, v22
    v_subrev_u32 v23, 7, v6
    v_cvt_f32_u32 v31, v23
    v_cvt_pk_bf16_f32 v32, v24, v25
    v_cvt_pk_bf16_f32 v33, v26, v27
    v_cvt_pk_bf16_f32 v34, v28, v29
    v_cvt_pk_bf16_f32 v35, v30, v31
    v_and_b32 v24, 0xffff, v32
    v_subrev_u32 v24, 17024, v24
    v_cmp_gt_u32 vcc, 128, v16
    s_nop 1
    v_cndmask_b32 v24, v24, v16, vcc
    v_lshlrev_b32 v24, 1, v24
    v_lshrrev_b32 v25, 16, v32
    v_subrev_u32 v25, 17024, v25
    v_cmp_gt_u32 vcc, 128, v17
    s_nop 1
    v_cndmask_b32 v25, v25, v17, vcc
    v_lshlrev_b32 v25, 1, v25
    v_and_b32 v26, 0xffff, v33
    v_subrev_u32 v26, 17024, v26
    v_cmp_gt_u32 vcc, 128, v18
    s_nop 1
    v_cndmask_b32 v26, v26, v18, vcc
    v_lshlrev_b32 v26, 1, v26
    v_lshrrev_b32 v27, 16, v33
    v_subrev_u32 v27, 17024, v27
    v_cmp_gt_u32 vcc, 128, v19
    s_nop 1
    v_cndmask_b32 v27, v27, v19, vcc
    v_lshlrev_b32 v27, 1, v27
    v_and_b32 v28, 0xffff, v34
    v_subrev_u32 v28, 17024, v28
    v_cmp_gt_u32 vcc, 128, v20
    s_nop 1
    v_cndmask_b32 v28, v28, v20, vcc
    v_lshlrev_b32 v28, 1, v28
    v_lshrrev_b32 v29, 16, v34
    v_subrev_u32 v29, 17024, v29
    v_cmp_gt_u32 vcc, 128, v21
    s_nop 1
    v_cndmask_b32 v29, v29, v21, vcc
    v_lshlrev_b32 v29, 1, v29
    v_and_b32 v30, 0xffff, v35
    v_subrev_u32 v30, 17024, v30
    v_cmp_gt_u32 vcc, 128, v22
    s_nop 1
    v_cndmask_b32 v30, v30, v22, vcc
    v_lshlrev_b32 v30, 1, v30
    v_lshrrev_b32 v31, 16, v35
    v_subrev_u32 v31, 17024, v31
    v_cmp_gt_u32 vcc, 128, v23
    s_nop 1
    v_cndmask_b32 v31, v31, v23, vcc
    v_lshlrev_b32 v31, 1, v31
    s_waitcnt lgkmcnt(0)
    s_barrier
    ds_read_u16 v44, v24 offset:31008
    ds_read_u16 v45, v25 offset:31008
    ds_read_u16 v46, v26 offset:31008
    ds_read_u16 v47, v27 offset:31008
    ds_read_u16 v48, v28 offset:31008
    ds_read_u16 v49, v29 offset:31008
    ds_read_u16 v50, v30 offset:31008
    ds_read_u16 v51, v31 offset:31008
    s_mul_i32 s7, s3, 4128
    v_lshlrev_b32 v6, 4, v0
    v_mov_b32 v40, 0
    v_mov_b32 v41, 0
    v_mov_b32 v42, 0
    v_mov_b32 v43, 0
    s_waitcnt lgkmcnt(0)
    v_lshl_or_b32 v36, v45, 16, v44
    v_lshl_or_b32 v37, v47, 16, v46
    v_lshl_or_b32 v38, v49, 16, v48
    v_lshl_or_b32 v39, v51, 16, v50
    buffer_store_dwordx4 v[36:39], v6, s[84:87], s7 offen
    v_cmp_gt_u32 vcc, 2, v0
    s_nop 0
    s_and_saveexec_b64 s[14:15], vcc
    s_cbranch_execz k1_kg_end
    s_add_u32 s7, s7, 4096
    buffer_store_dwordx4 v[40:43], v6, s[84:87], s7 offen
k1_kg_end:
    s_waitcnt vmcnt(0)
    s_endpgm
k1_ln1:
    s_mov_b32 s56, s16
    s_mov_b32 s57, s17
    s_mov_b32 s58, 2621440
    s_mov_b32 s59, 0x00020000
    s_add_u32 s60, s52, 77824
    s_addc_u32 s61, s53, 0
    s_mov_b32 s62, 2637824
    s_mov_b32 s63, 0x00020000
    s_add_u32 s64, s52, 2715648
    s_addc_u32 s65, s53, 0
    s_mov_b32 s66, 2637824
    s_mov_b32 s67, 0x00020000
    v_and_b32 v1, 15, v0
    v_lshrrev_b32 v2, 4, v0
    s_sub_u32 s9, s2, 640
    s_mul_i32 s3, s9, 20480
    v_mul_u32_u24 v3, 1280, v2
    v_lshl_add_u32 v3, v1, 4, v3
    buffer_load_dwordx4 v[8:11], v3, s[56:59], s3 offen offset:0
    buffer_load_dwordx4 v[12:15], v3, s[56:59], s3 offen offset:256
    buffer_load_dwordx4 v[16:19], v3, s[56:59], s3 offen offset:512
    buffer_load_dwordx4 v[20:23], v3, s[56:59], s3 offen offset:768
    buffer_load_dwordx4 v[24:27], v3, s[56:59], s3 offen offset:1024
    v_mul_u32_u24 v4, 1344, v2
    v_lshl_add_u32 v4, v1, 4, v4
    v_and_b32 v88, 63, v0
    v_lshrrev_b32 v89, 6, v0
    v_lshrrev_b32 v90, 4, v88
    v_bfe_u32 v91, v88, 2, 2
    v_and_b32 v92, 3, v88
    v_lshrrev_b32 v93, 1, v90
    v_and_b32 v94, 1, v90
    v_lshl_add_u32 v5, v93, 3, v91
    v_mul_u32_u24 v5, 1344, v5
    v_lshl_add_u32 v5, v94, 5, v5
    v_lshl_add_u32 v5, v92, 3, v5
    v_lshl_add_u32 v5, v89, 6, v5
    v_and_b32 v6, 15, v88
    v_lshl_add_u32 v6, v94, 4, v6
    v_lshl_add_u32 v6, v89, 5, v6
    v_lshlrev_b32 v6, 5, v6
    v_lshl_add_u32 v6, v93, 4, v6
    s_mul_i32 s4, s9, 20608
    s_add_u32 s5, s4, 4096
    s_add_u32 s6, s4, 8192
    s_add_u32 s7, s4, 12288
    s_add_u32 s8, s4, 16384
    s_waitcnt vmcnt(4)
    ds_write_b128 v4, v[8:11] offset:0
    s_waitcnt vmcnt(3)
    ds_write_b128 v4, v[12:15] offset:256
    s_waitcnt vmcnt(2)
    ds_write_b128 v4, v[16:19] offset:512
    s_waitcnt vmcnt(1)
    ds_write_b128 v4, v[20:23] offset:768
    s_waitcnt vmcnt(0)
    ds_write_b128 v4, v[24:27] offset:1024
    s_waitcnt lgkmcnt(0)
    s_barrier
    ds_read_b64_tr_b16 v[68:69], v5 offset:0
    ds_read_b64_tr_b16 v[70:71], v5 offset:5376
    ds_read_b64_tr_b16 v[72:73], v5 offset:256
    ds_read_b64_tr_b16 v[74:75], v5 offset:5632
    ds_read_b64_tr_b16 v[76:77], v5 offset:512
    ds_read_b64_tr_b16 v[78:79], v5 offset:5888
    ds_read_b64_tr_b16 v[80:81], v5 offset:768
    ds_read_b64_tr_b16 v[82:83], v5 offset:6144
    ds_read_b64_tr_b16 v[84:85], v5 offset:1024
    ds_read_b64_tr_b16 v[86:87], v5 offset:6400
    s_waitcnt lgkmcnt(8)
    buffer_store_dwordx4 v[68:71], v6, s[60:63], s4 offen
    s_waitcnt lgkmcnt(6)
    buffer_store_dwordx4 v[72:75], v6, s[60:63], s5 offen
    s_waitcnt lgkmcnt(4)
    buffer_store_dwordx4 v[76:79], v6, s[60:63], s6 offen
    s_waitcnt lgkmcnt(2)
    buffer_store_dwordx4 v[80:83], v6, s[60:63], s7 offen
    s_waitcnt lgkmcnt(0)
    buffer_store_dwordx4 v[84:87], v6, s[60:63], s8 offen
    v_lshlrev_b32 v28, 16, v8
    v_and_b32 v29, 0xffff0000, v8
    v_lshlrev_b32 v30, 16, v9
    v_and_b32 v31, 0xffff0000, v9
    v_lshlrev_b32 v32, 16, v10
    v_and_b32 v33, 0xffff0000, v10
    v_lshlrev_b32 v34, 16, v11
    v_and_b32 v35, 0xffff0000, v11
    v_lshlrev_b32 v36, 16, v12
    v_and_b32 v37, 0xffff0000, v12
    v_lshlrev_b32 v38, 16, v13
    v_and_b32 v39, 0xffff0000, v13
    v_lshlrev_b32 v40, 16, v14
    v_and_b32 v41, 0xffff0000, v14
    v_lshlrev_b32 v42, 16, v15
    v_and_b32 v43, 0xffff0000, v15
    v_lshlrev_b32 v44, 16, v16
    v_and_b32 v45, 0xffff0000, v16
    v_lshlrev_b32 v46, 16, v17
    v_and_b32 v47, 0xffff0000, v17
    v_lshlrev_b32 v48, 16, v18
    v_and_b32 v49, 0xffff0000, v18
    v_lshlrev_b32 v50, 16, v19
    v_and_b32 v51, 0xffff0000, v19
    v_lshlrev_b32 v52, 16, v20
    v_and_b32 v53, 0xffff0000, v20
    v_lshlrev_b32 v54, 16, v21
    v_and_b32 v55, 0xffff0000, v21
    v_lshlrev_b32 v56, 16, v22
    v_and_b32 v57, 0xffff0000, v22
    v_lshlrev_b32 v58, 16, v23
    v_and_b32 v59, 0xffff0000, v23
    v_lshlrev_b32 v60, 16, v24
    v_and_b32 v61, 0xffff0000, v24
    v_lshlrev_b32 v62, 16, v25
    v_and_b32 v63, 0xffff0000, v25
    v_lshlrev_b32 v64, 16, v26
    v_and_b32 v65, 0xffff0000, v26
    v_lshlrev_b32 v66, 16, v27
    v_and_b32 v67, 0xffff0000, v27
    v_pk_add_f32 v[8:9], v[28:29], v[30:31]
    v_pk_add_f32 v[10:11], v[32:33], v[34:35]
    v_pk_add_f32 v[8:9], v[8:9], v[36:37]
    v_pk_add_f32 v[10:11], v[10:11], v[38:39]
    v_pk_add_f32 v[8:9], v[8:9], v[40:41]
    v_pk_add_f32 v[10:11], v[10:11], v[42:43]
    v_pk_add_f32 v[8:9], v[8:9], v[44:45]
    v_pk_add_f32 v[10:11], v[10:11], v[46:47]
    v_pk_add_f32 v[8:9], v[8:9], v[48:49]
    v_pk_add_f32 v[10:11], v[10:11], v[50:51]
    v_pk_add_f32 v[8:9], v[8:9], v[52:53]
    v_pk_add_f32 v[10:11], v[10:11], v[54:55]
    v_pk_add_f32 v[8:9], v[8:9], v[56:57]
    v_pk_add_f32 v[10:11], v[10:11], v[58:59]
    v_pk_add_f32 v[8:9], v[8:9], v[60:61]
    v_pk_add_f32 v[10:11], v[10:11], v[62:63]
    v_pk_add_f32 v[8:9], v[8:9], v[64:65]
    v_pk_add_f32 v[10:11], v[10:11], v[66:67]
    v_pk_add_f32 v[8:9], v[8:9], v[10:11]
    v_add_f32 v8, v8, v9
    s_nop 1
    v_add_f32_dpp v8, v8, v8 row_ror:8 row_mask:0xf bank_mask:0xf
    s_nop 1
    v_add_f32_dpp v8, v8, v8 row_ror:4 row_mask:0xf bank_mask:0xf
    s_nop 1
    v_add_f32_dpp v8, v8, v8 row_ror:2 row_mask:0xf bank_mask:0xf
    s_nop 1
    v_add_f32_dpp v8, v8, v8 row_ror:1 row_mask:0xf bank_mask:0xf
    v_mul_f32 v10, 0xbacccccd, v8
    v_mov_b32 v11, v10
    v_pk_add_f32 v[28:29], v[28:29], v[10:11]
    v_pk_add_f32 v[30:31], v[30:31], v[10:11]
    v_pk_add_f32 v[32:33], v[32:33], v[10:11]
    v_pk_add_f32 v[34:35], v[34:35], v[10:11]
    v_pk_add_f32 v[36:37], v[36:37], v[10:11]
    v_pk_add_f32 v[38:39], v[38:39], v[10:11]
    v_pk_add_f32 v[40:41], v[40:41], v[10:11]
    v_pk_add_f32 v[42:43], v[42:43], v[10:11]
    v_pk_add_f32 v[44:45], v[44:45], v[10:11]
    v_pk_add_f32 v[46:47], v[46:47], v[10:11]
    v_pk_add_f32 v[48:49], v[48:49], v[10:11]
    v_pk_add_f32 v[50:51], v[50:51], v[10:11]
    v_pk_add_f32 v[52:53], v[52:53], v[10:11]
    v_pk_add_f32 v[54:55], v[54:55], v[10:11]
    v_pk_add_f32 v[56:57], v[56:57], v[10:11]
    v_pk_add_f32 v[58:59], v[58:59], v[10:11]
    v_pk_add_f32 v[60:61], v[60:61], v[10:11]
    v_pk_add_f32 v[62:63], v[62:63], v[10:11]
    v_pk_add_f32 v[64:65], v[64:65], v[10:11]
    v_pk_add_f32 v[66:67], v[66:67], v[10:11]
    v_pk_mul_f32 v[8:9], v[28:29], v[28:29]
    v_pk_mul_f32 v[12:13], v[30:31], v[30:31]
    v_pk_fma_f32 v[8:9], v[32:33], v[32:33], v[8:9]
    v_pk_fma_f32 v[12:13], v[34:35], v[34:35], v[12:13]
    v_pk_fma_f32 v[8:9], v[36:37], v[36:37], v[8:9]
    v_pk_fma_f32 v[12:13], v[38:39], v[38:39], v[12:13]
    v_pk_fma_f32 v[8:9], v[40:41], v[40:41], v[8:9]
    v_pk_fma_f32 v[12:13], v[42:43], v[42:43], v[12:13]
    v_pk_fma_f32 v[8:9], v[44:45], v[44:45], v[8:9]
    v_pk_fma_f32 v[12:13], v[46:47], v[46:47], v[12:13]
    v_pk_fma_f32 v[8:9], v[48:49], v[48:49], v[8:9]
    v_pk_fma_f32 v[12:13], v[50:51], v[50:51], v[12:13]
    v_pk_fma_f32 v[8:9], v[52:53], v[52:53], v[8:9]
    v_pk_fma_f32 v[12:13], v[54:55], v[54:55], v[12:13]
    v_pk_fma_f32 v[8:9], v[56:57], v[56:57], v[8:9]
    v_pk_fma_f32 v[12:13], v[58:59], v[58:59], v[12:13]
    v_pk_fma_f32 v[8:9], v[60:61], v[60:61], v[8:9]
    v_pk_fma_f32 v[12:13], v[62:63], v[62:63], v[12:13]
    v_pk_fma_f32 v[8:9], v[64:65], v[64:65], v[8:9]
    v_pk_fma_f32 v[12:13], v[66:67], v[66:67], v[12:13]
    v_pk_add_f32 v[8:9], v[8:9], v[12:13]
    v_add_f32 v8, v8, v9
    s_nop 1
    v_add_f32_dpp v8, v8, v8 row_ror:8 row_mask:0xf bank_mask:0xf
    s_nop 1
    v_add_f32_dpp v8, v8, v8 row_ror:4 row_mask:0xf bank_mask:0xf
    s_nop 1
    v_add_f32_dpp v8, v8, v8 row_ror:2 row_mask:0xf bank_mask:0xf
    s_nop 1
    v_add_f32_dpp v8, v8, v8 row_ror:1 row_mask:0xf bank_mask:0xf
    v_mov_b32 v9, 0x3727c5ac
    v_fmac_f32 v9, 0x3acccccd, v8
    v_rsq_f32 v10, v9
    s_nop 0
    v_mov_b32 v11, v10
    v_pk_mul_f32 v[28:29], v[28:29], v[10:11]
    v_pk_mul_f32 v[30:31], v[30:31], v[10:11]
    v_pk_mul_f32 v[32:33], v[32:33], v[10:11]
    v_pk_mul_f32 v[34:35], v[34:35], v[10:11]
    v_pk_mul_f32 v[36:37], v[36:37], v[10:11]
    v_pk_mul_f32 v[38:39], v[38:39], v[10:11]
    v_pk_mul_f32 v[40:41], v[40:41], v[10:11]
    v_pk_mul_f32 v[42:43], v[42:43], v[10:11]
    v_pk_mul_f32 v[44:45], v[44:45], v[10:11]
    v_pk_mul_f32 v[46:47], v[46:47], v[10:11]
    v_pk_mul_f32 v[48:49], v[48:49], v[10:11]
    v_pk_mul_f32 v[50:51], v[50:51], v[10:11]
    v_pk_mul_f32 v[52:53], v[52:53], v[10:11]
    v_pk_mul_f32 v[54:55], v[54:55], v[10:11]
    v_pk_mul_f32 v[56:57], v[56:57], v[10:11]
    v_pk_mul_f32 v[58:59], v[58:59], v[10:11]
    v_pk_mul_f32 v[60:61], v[60:61], v[10:11]
    v_pk_mul_f32 v[62:63], v[62:63], v[10:11]
    v_pk_mul_f32 v[64:65], v[64:65], v[10:11]
    v_pk_mul_f32 v[66:67], v[66:67], v[10:11]
    v_cvt_pk_bf16_f32 v8, v28, v29
    v_cvt_pk_bf16_f32 v9, v30, v31
    v_cvt_pk_bf16_f32 v10, v32, v33
    v_cvt_pk_bf16_f32 v11, v34, v35
    v_cvt_pk_bf16_f32 v12, v36, v37
    v_cvt_pk_bf16_f32 v13, v38, v39
    v_cvt_pk_bf16_f32 v14, v40, v41
    v_cvt_pk_bf16_f32 v15, v42, v43
    v_cvt_pk_bf16_f32 v16, v44, v45
    v_cvt_pk_bf16_f32 v17, v46, v47
    v_cvt_pk_bf16_f32 v18, v48, v49
    v_cvt_pk_bf16_f32 v19, v50, v51
    v_cvt_pk_bf16_f32 v20, v52, v53
    v_cvt_pk_bf16_f32 v21, v54, v55
    v_cvt_pk_bf16_f32 v22, v56, v57
    v_cvt_pk_bf16_f32 v23, v58, v59
    v_cvt_pk_bf16_f32 v24, v60, v61
    v_cvt_pk_bf16_f32 v25, v62, v63
    v_cvt_pk_bf16_f32 v26, v64, v65
    v_cvt_pk_bf16_f32 v27, v66, v67
    s_barrier
    ds_write_b128 v4, v[8:11] offset:0
    ds_write_b128 v4, v[12:15] offset:256
    ds_write_b128 v4, v[16:19] offset:512
    ds_write_b128 v4, v[20:23] offset:768
    ds_write_b128 v4, v[24:27] offset:1024
    s_waitcnt lgkmcnt(0)
    s_barrier
    ds_read_b64_tr_b16 v[28:29], v5 offset:0
    ds_read_b64_tr_b16 v[30:31], v5 offset:5376
    ds_read_b64_tr_b16 v[32:33], v5 offset:256
    ds_read_b64_tr_b16 v[34:35], v5 offset:5632
    ds_read_b64_tr_b16 v[36:37], v5 offset:512
    ds_read_b64_tr_b16 v[38:39], v5 offset:5888
    ds_read_b64_tr_b16 v[40:41], v5 offset:768
    ds_read_b64_tr_b16 v[42:43], v5 offset:6144
    ds_read_b64_tr_b16 v[44:45], v5 offset:1024
    ds_read_b64_tr_b16 v[46:47], v5 offset:6400
    s_waitcnt lgkmcnt(8)
    buffer_store_dwordx4 v[28:31], v6, s[64:67], s4 offen
    s_waitcnt lgkmcnt(6)
    buffer_store_dwordx4 v[32:35], v6, s[64:67], s5 offen
    s_waitcnt lgkmcnt(4)
    buffer_store_dwordx4 v[36:39], v6, s[64:67], s6 offen
    s_waitcnt lgkmcnt(2)
    buffer_store_dwordx4 v[40:43], v6, s[64:67], s7 offen
    s_waitcnt lgkmcnt(0)
    buffer_store_dwordx4 v[44:47], v6, s[64:67], s8 offen
    s_waitcnt vmcnt(0)
    s_endpgm
k1_mod:
    s_mov_b32 s56, s46
    s_mov_b32 s57, s47
    s_mov_b32 s58, 4915200
    s_mov_b32 s59, 0x00020000
    s_mov_b32 s60, s44
    s_mov_b32 s61, s45
    s_mov_b32 s62, 1280
    s_mov_b32 s63, 0x00020000
    s_mov_b32 s64, s52
    s_mov_b32 s65, s53
    s_mov_b32 s66, 61440
    s_mov_b32 s67, 0x00020000
    s_sub_u32 s3, s2, 768
    s_mul_i32 s4, s3, 1093
    s_lshr_b32 s4, s4, 16
    s_mul_i32 s5, s4, 60
    s_sub_u32 s5, s3, s5
    v_and_b32 v1, 7, v0
    v_lshrrev_b32 v2, 3, v0
    v_mul_u32_u24 v3, 7680, v2
    v_lshl_add_u32 v3, v1, 4, v3
    s_mul_i32 s6, s4, 1228800
    s_lshl_b32 s7, s5, 7
    s_add_u32 s6, s6, s7
    v_lshlrev_b32 v4, 1, v2
    s_mul_i32 s12, s4, 320
    s_add_u32 s7, s6, 245760
    s_add_u32 s8, s6, 491520
    s_add_u32 s9, s6, 737280
    s_add_u32 s10, s6, 983040
    buffer_load_ushort v28, v4, s[60:63], s12 offen offset:0
    buffer_load_ushort v29, v4, s[60:63], s12 offen offset:64
    buffer_load_ushort v30, v4, s[60:63], s12 offen offset:128
    buffer_load_ushort v31, v4, s[60:63], s12 offen offset:192
    buffer_load_ushort v32, v4, s[60:63], s12 offen offset:256
    buffer_load_dwordx4 v[8:11], v3, s[56:59], s6 offen
    buffer_load_dwordx4 v[12:15], v3, s[56:59], s7 offen
    buffer_load_dwordx4 v[16:19], v3, s[56:59], s8 offen
    buffer_load_dwordx4 v[20:23], v3, s[56:59], s9 offen
    buffer_load_dwordx4 v[24:27], v3, s[56:59], s10 offen
    s_waitcnt vmcnt(5)
    v_lshlrev_b32 v28, 16, v28
    v_mul_f32 v5, 0xbfb8aa3b, v28
    v_exp_f32 v5, v5
    s_nop 0
    v_add_f32 v5, 1.0, v5
    v_rcp_f32 v5, v5
    s_nop 0
    v_mul_f32 v5, v28, v5
    v_cvt_pk_bf16_f32 v5, v5, v5
    v_lshlrev_b32 v34, 16, v5
    v_lshlrev_b32 v35, 16, v5
    v_lshlrev_b32 v29, 16, v29
    v_mul_f32 v5, 0xbfb8aa3b, v29
    v_exp_f32 v5, v5
    s_nop 0
    v_add_f32 v5, 1.0, v5
    v_rcp_f32 v5, v5
    s_nop 0
    v_mul_f32 v5, v29, v5
    v_cvt_pk_bf16_f32 v5, v5, v5
    v_lshlrev_b32 v36, 16, v5
    v_lshlrev_b32 v37, 16, v5
    v_lshlrev_b32 v30, 16, v30
    v_mul_f32 v5, 0xbfb8aa3b, v30
    v_exp_f32 v5, v5
    s_nop 0
    v_add_f32 v5, 1.0, v5
    v_rcp_f32 v5, v5
    s_nop 0
    v_mul_f32 v5, v30, v5
    v_cvt_pk_bf16_f32 v5, v5, v5
    v_lshlrev_b32 v38, 16, v5
    v_lshlrev_b32 v39, 16, v5
    v_lshlrev_b32 v31, 16, v31
    v_mul_f32 v5, 0xbfb8aa3b, v31
    v_exp_f32 v5, v5
    s_nop 0
    v_add_f32 v5, 1.0, v5
    v_rcp_f32 v5, v5
    s_nop 0
    v_mul_f32 v5, v31, v5
    v_cvt_pk_bf16_f32 v5, v5, v5
    v_lshlrev_b32 v40, 16, v5
    v_lshlrev_b32 v41, 16, v5
    v_lshlrev_b32 v32, 16, v32
    v_mul_f32 v5, 0xbfb8aa3b, v32
    v_exp_f32 v5, v5
    s_nop 0
    v_add_f32 v5, 1.0, v5
    v_rcp_f32 v5, v5
    s_nop 0
    v_mul_f32 v5, v32, v5
    v_cvt_pk_bf16_f32 v5, v5, v5
    v_lshlrev_b32 v42, 16, v5
    v_lshlrev_b32 v43, 16, v5
    s_waitcnt vmcnt(4)
    v_lshlrev_b32 v52, 16, v8
    v_and_b32 v53, 0xffff0000, v8
    v_pk_mul_f32 v[44:45], v[52:53], v[34:35]
    v_lshlrev_b32 v52, 16, v9
    v_and_b32 v53, 0xffff0000, v9
    v_pk_mul_f32 v[46:47], v[52:53], v[34:35]
    v_lshlrev_b32 v52, 16, v10
    v_and_b32 v53, 0xffff0000, v10
    v_pk_mul_f32 v[48:49], v[52:53], v[34:35]
    v_lshlrev_b32 v52, 16, v11
    v_and_b32 v53, 0xffff0000, v11
    v_pk_mul_f32 v[50:51], v[52:53], v[34:35]
    s_waitcnt vmcnt(3)
    v_lshlrev_b32 v52, 16, v12
    v_and_b32 v53, 0xffff0000, v12
    v_pk_fma_f32 v[44:45], v[52:53], v[36:37], v[44:45]
    v_lshlrev_b32 v52, 16, v13
    v_and_b32 v53, 0xffff0000, v13
    v_pk_fma_f32 v[46:47], v[52:53], v[36:37], v[46:47]
    v_lshlrev_b32 v52, 16, v14
    v_and_b32 v53, 0xffff0000, v14
    v_pk_fma_f32 v[48:49], v[52:53], v[36:37], v[48:49]
    v_lshlrev_b32 v52, 16, v15
    v_and_b32 v53, 0xffff0000, v15
    v_pk_fma_f32 v[50:51], v[52:53], v[36:37], v[50:51]
    s_waitcnt vmcnt(2)
    v_lshlrev_b32 v52, 16, v16
    v_and_b32 v53, 0xffff0000, v16
    v_pk_fma_f32 v[44:45], v[52:53], v[38:39], v[44:45]
    v_lshlrev_b32 v52, 16, v17
    v_and_b32 v53, 0xffff0000, v17
    v_pk_fma_f32 v[46:47], v[52:53], v[38:39], v[46:47]
    v_lshlrev_b32 v52, 16, v18
    v_and_b32 v53, 0xffff0000, v18
    v_pk_fma_f32 v[48:49], v[52:53], v[38:39], v[48:49]
    v_lshlrev_b32 v52, 16, v19
    v_and_b32 v53, 0xffff0000, v19
    v_pk_fma_f32 v[50:51], v[52:53], v[38:39], v[50:51]
    s_waitcnt vmcnt(1)
    v_lshlrev_b32 v52, 16, v20
    v_and_b32 v53, 0xffff0000, v20
    v_pk_fma_f32 v[44:45], v[52:53], v[40:41], v[44:45]
    v_lshlrev_b32 v52, 16, v21
    v_and_b32 v53, 0xffff0000, v21
    v_pk_fma_f32 v[46:47], v[52:53], v[40:41], v[46:47]
    v_lshlrev_b32 v52, 16, v22
    v_and_b32 v53, 0xffff0000, v22
    v_pk_fma_f32 v[48:49], v[52:53], v[40:41], v[48:49]
    v_lshlrev_b32 v52, 16, v23
    v_and_b32 v53, 0xffff0000, v23
    v_pk_fma_f32 v[50:51], v[52:53], v[40:41], v[50:51]
    s_waitcnt vmcnt(0)
    v_lshlrev_b32 v52, 16, v24
    v_and_b32 v53, 0xffff0000, v24
    v_pk_fma_f32 v[44:45], v[52:53], v[42:43], v[44:45]
    v_lshlrev_b32 v52, 16, v25
    v_and_b32 v53, 0xffff0000, v25
    v_pk_fma_f32 v[46:47], v[52:53], v[42:43], v[46:47]
    v_lshlrev_b32 v52, 16, v26
    v_and_b32 v53, 0xffff0000, v26
    v_pk_fma_f32 v[48:49], v[52:53], v[42:43], v[48:49]
    v_lshlrev_b32 v52, 16, v27
    v_and_b32 v53, 0xffff0000, v27
    v_pk_fma_f32 v[50:51], v[52:53], v[42:43], v[50:51]
    v_add_f32_dpp v44, v44, v44 row_ror:8 row_mask:0xf bank_mask:0xf
    v_add_f32_dpp v45, v45, v45 row_ror:8 row_mask:0xf bank_mask:0xf
    v_add_f32_dpp v46, v46, v46 row_ror:8 row_mask:0xf bank_mask:0xf
    v_add_f32_dpp v47, v47, v47 row_ror:8 row_mask:0xf bank_mask:0xf
    v_add_f32_dpp v48, v48, v48 row_ror:8 row_mask:0xf bank_mask:0xf
    v_add_f32_dpp v49, v49, v49 row_ror:8 row_mask:0xf bank_mask:0xf
    v_add_f32_dpp v50, v50, v50 row_ror:8 row_mask:0xf bank_mask:0xf
    v_add_f32_dpp v51, v51, v51 row_ror:8 row_mask:0xf bank_mask:0xf
    v_lshrrev_b32 v5, 4, v0
    v_lshlrev_b32 v5, 8, v5
    v_lshl_add_u32 v5, v1, 5, v5
    ds_write_b128 v5, v[44:47]
    ds_write_b128 v5, v[48:51] offset:16
    s_waitcnt lgkmcnt(0)
    s_barrier
    v_cmp_gt_u32 vcc, 64, v0
    s_nop 0
    s_and_saveexec_b64 s[14:15], vcc
    s_cbranch_execz k1_mod_end
    v_lshlrev_b32 v6, 2, v0
    ds_read_b32 v8, v6 offset:0
    ds_read_b32 v9, v6 offset:256
    ds_read_b32 v10, v6 offset:512
    ds_read_b32 v11, v6 offset:768
    ds_read_b32 v12, v6 offset:1024
    ds_read_b32 v13, v6 offset:1280
    ds_read_b32 v14, v6 offset:1536
    ds_read_b32 v15, v6 offset:1792
    ds_read_b32 v16, v6 offset:2048
    ds_read_b32 v17, v6 offset:2304
    ds_read_b32 v18, v6 offset:2560
    ds_read_b32 v19, v6 offset:2816
    ds_read_b32 v20, v6 offset:3072
    ds_read_b32 v21, v6 offset:3328
    ds_read_b32 v22, v6 offset:3584
    ds_read_b32 v23, v6 offset:3840
    s_waitcnt lgkmcnt(0)
    v_add_f32 v8, v8, v16
    v_add_f32 v9, v9, v17
    v_add_f32 v10, v10, v18
    v_add_f32 v11, v11, v19
    v_add_f32 v12, v12, v20
    v_add_f32 v13, v13, v21
    v_add_f32 v14, v14, v22
    v_add_f32 v15, v15, v23
    v_add_f32 v8, v8, v12
    v_add_f32 v9, v9, v13
    v_add_f32 v10, v10, v14
    v_add_f32 v11, v11, v15
    v_add_f32 v8, v8, v10
    v_add_f32 v9, v9, v11
    v_add_f32 v8, v8, v9
    s_mul_i32 s6, s4, 15360
    s_lshl_b32 s7, s5, 8
    s_add_u32 s6, s6, s7
    buffer_store_dword v8, v6, s[64:67], s6 offen
k1_mod_end:
    s_waitcnt vmcnt(0)
    s_endpgm
k1_wof:
    s_mov_b32 s56, s42
    s_mov_b32 s57, s43
    s_mov_b32 s58, 1105920
    s_mov_b32 s59, 0x00020000
    s_add_u32 s60, s52, 7995392
    s_addc_u32 s61, s53, 0
    s_mov_b32 s62, 1105920
    s_mov_b32 s63, 0x00020000
    s_sub_u32 s3, s2, 1008
    s_lshr_b32 s4, s3, 1
    s_and_b32 s5, s3, 1
    v_and_b32 v1, 7, v0
    v_lshrrev_b32 v2, 3, v0
    v_mul_u32_u24 v3, 1280, v2
    v_lshl_add_u32 v3, v1, 4, v3
    s_mul_i32 s6, s4, 40960
    s_mul_i32 s7, s5, 640
    s_add_u32 s6, s6, s7
    buffer_load_dwordx4 v[8:11], v3, s[56:59], s6 offen offset:0
    buffer_load_dwordx4 v[12:15], v3, s[56:59], s6 offen offset:128
    buffer_load_dwordx4 v[16:19], v3, s[56:59], s6 offen offset:256
    buffer_load_dwordx4 v[20:23], v3, s[56:59], s6 offen offset:384
    buffer_load_dwordx4 v[24:27], v3, s[56:59], s6 offen offset:512
    v_mul_u32_u24 v4, 704, v2
    v_lshl_add_u32 v4, v1, 4, v4
    v_and_b32 v40, 63, v0
    v_lshrrev_b32 v41, 6, v0
    v_lshrrev_b32 v42, 4, v40
    v_bfe_u32 v43, v40, 2, 2
    v_and_b32 v44, 3, v40
    v_lshl_add_u32 v5, v42, 3, v43
    v_mul_u32_u24 v5, 704, v5
    v_lshl_add_u32 v5, v44, 4, v5
    v_lshlrev_b32 v6, 4, v40
    v_readfirstlane_b32 s8, v41
    s_waitcnt vmcnt(4)
    ds_write_b128 v4, v[8:11] offset:0
    s_waitcnt vmcnt(3)
    ds_write_b128 v4, v[12:15] offset:128
    s_waitcnt vmcnt(2)
    ds_write_b128 v4, v[16:19] offset:256
    s_waitcnt vmcnt(1)
    ds_write_b128 v4, v[20:23] offset:384
    s_waitcnt vmcnt(0)
    ds_write_b128 v4, v[24:27] offset:512
    s_mul_i32 s8, s8, 5
    s_mul_i32 s9, s4, 40
    s_mul_i32 s10, s5, 20
    s_add_u32 s9, s9, s10
    s_add_u32 s9, s9, s8
    s_lshl_b32 s9, s9, 10
    s_waitcnt lgkmcnt(0)
    s_barrier
    s_add_u32 s10, s8, 0
    s_lshr_b32 s11, s10, 1
    s_lshl_b32 s11, s11, 6
    s_and_b32 s10, s10, 1
    s_lshl_b32 s10, s10, 3
    s_add_u32 s10, s10, s11
    v_add_u32 v7, s10, v5
    ds_read_b64_tr_b16 v[8:9], v7
    ds_read_b64_tr_b16 v[10:11], v7 offset:2816
    s_add_u32 s10, s8, 1
    s_lshr_b32 s11, s10, 1
    s_lshl_b32 s11, s11, 6
    s_and_b32 s10, s10, 1
    s_lshl_b32 s10, s10, 3
    s_add_u32 s10, s10, s11
    v_add_u32 v7, s10, v5
    ds_read_b64_tr_b16 v[12:13], v7
    ds_read_b64_tr_b16 v[14:15], v7 offset:2816
    s_add_u32 s10, s8, 2
    s_lshr_b32 s11, s10, 1
    s_lshl_b32 s11, s11, 6
    s_and_b32 s10, s10, 1
    s_lshl_b32 s10, s10, 3
    s_add_u32 s10, s10, s11
    v_add_u32 v7, s10, v5
    ds_read_b64_tr_b16 v[16:17], v7
    ds_read_b64_tr_b16 v[18:19], v7 offset:2816
    s_add_u32 s10, s8, 3
    s_lshr_b32 s11, s10, 1
    s_lshl_b32 s11, s11, 6
    s_and_b32 s10, s10, 1
    s_lshl_b32 s10, s10, 3
    s_add_u32 s10, s10, s11
    v_add_u32 v7, s10, v5
    ds_read_b64_tr_b16 v[20:21], v7
    ds_read_b64_tr_b16 v[22:23], v7 offset:2816
    s_add_u32 s10, s8, 4
    s_lshr_b32 s11, s10, 1
    s_lshl_b32 s11, s11, 6
    s_and_b32 s10, s10, 1
    s_lshl_b32 s10, s10, 3
    s_add_u32 s10, s10, s11
    v_add_u32 v7, s10, v5
    ds_read_b64_tr_b16 v[24:25], v7
    ds_read_b64_tr_b16 v[26:27], v7 offset:2816
    s_waitcnt lgkmcnt(8)
    buffer_store_dwordx4 v[8:11], v6, s[60:63], s9 offen offset:0
    s_waitcnt lgkmcnt(6)
    buffer_store_dwordx4 v[12:15], v6, s[60:63], s9 offen offset:1024
    s_waitcnt lgkmcnt(4)
    buffer_store_dwordx4 v[16:19], v6, s[60:63], s9 offen offset:2048
    s_waitcnt lgkmcnt(2)
    buffer_store_dwordx4 v[20:23], v6, s[60:63], s9 offen offset:3072
    s_waitcnt lgkmcnt(0)
    s_add_u32 s9, s9, 4096
    buffer_store_dwordx4 v[24:27], v6, s[60:63], s9 offen
    s_endpgm
k1_exit:
    s_endpgm
prep_kernel_end:
.globl conv_kernel
.p2align 8
.type conv_kernel,@function
conv_kernel:
    s_cmp_ge_u32 s2, 772
    s_cbranch_scc1 k2_exit
    s_load_dwordx16 s[16:31], s[0:1], 0
    s_load_dwordx16 s[32:47], s[0:1], 64
    s_load_dwordx4 s[48:51], s[0:1], 128
    s_load_dwordx2 s[52:53], s[0:1], 144
    s_waitcnt lgkmcnt(0)
    s_cmp_ge_u32 s2, 764
    s_cbranch_scc1 k2_code
    s_cmp_ge_u32 s2, 748
    s_cbranch_scc1 k2_misc
    s_cmp_ge_u32 s2, 748
    s_cbranch_scc1 k2_wsf
    s_cmp_ge_u32 s2, 640
    s_cbranch_scc1 k2_wp
    s_add_u32 s56, s52, 5353472
    s_addc_u32 s57, s53, 0
    s_mov_b32 s58, 2641920
    s_mov_b32 s59, 0x00020000
    s_add_u32 s60, s52, 2715648
    s_addc_u32 s61, s53, 0
    s_mov_b32 s62, 2637824
    s_mov_b32 s63, 0x00020000
    s_add_u32 s64, s52, 77824
    s_addc_u32 s65, s53, 0
    s_mov_b32 s66, 2637824
    s_mov_b32 s67, 0x00020000
    s_mov_b32 s68, s52
    s_mov_b32 s69, s53
    s_mov_b32 s70, 61440
    s_mov_b32 s71, 0x00020000
    s_mov_b32 s72, s32
    s_mov_b32 s73, s33
    s_mov_b32 s74, 1280
    s_mov_b32 s75, 0x00020000
    s_add_u32 s76, s52, 11370496
    s_addc_u32 s77, s53, 0
    s_mov_b32 s78, 2703360
    s_mov_b32 s79, 0x00020000
    s_and_b32 s3, s2, 7
    s_lshl_b32 s3, s3, 2
    s_lshr_b32 s4, s2, 3
    s_and_b32 s5, s4, 3
    s_add_u32 s3, s3, s5
    s_lshr_b32 s4, s4, 2
    s_lshl_b32 s4, s4, 5
    s_add_u32 s3, s3, s4
    v_and_b32 v1, 63, v0
    v_lshrrev_b32 v8, 6, v0
    v_lshlrev_b32 v11, 4, v0
    v_readfirstlane_b32 s4, v8
    s_mul_i32 s5, s3, 4128
    s_mul_i32 s6, s3, 4224
    buffer_load_dwordx4 v[40:43], v11, s[56:59], s5 offen
    buffer_load_dwordx4 v[44:47], v11, s[56:59], s5 offen offset:16
    v_and_b32 v16, 3, v1
    v_mul_u32_u24 v16, 15360, v16
    v_bfe_u32 v17, v1, 2, 2
    v_min_u32 v17, 2, v17
    v_mul_u32_u24 v17, 2560, v17
    v_add_u32 v16, v16, v17
    s_lshl_b32 s10, s3, 2
    buffer_load_dword v18, v16, s[68:71], s10 offen
    v_lshrrev_b32 v9, 1, v0
    v_mul_u32_u24 v9, 20608, v9
    v_and_b32 v10, 1, v0
    v_lshl_add_u32 v9, v10, 4, v9
    s_lshl_b32 s7, s3, 5
    buffer_load_dwordx4 v[12:15], v9, s[60:63], s7 offen
    v_mov_b32 v19, 0
    s_lshl_b32 s11, s3, 1
    buffer_load_ushort v20, v19, s[72:75], s11 offen
    v_and_b32 v21, 15, v1
    v_lshrrev_b32 v22, 4, v1
    v_mul_u32_u24 v23, 20608, v21
    v_lshl_add_u32 v23, v22, 3, v23
    s_mul_i32 s8, s4, 659456
    s_add_u32 s8, s8, s7
    s_add_u32 s9, s8, 329728
    buffer_load_dwordx2 v[4:5], v23, s[64:67], s8 offen
    buffer_load_dwordx2 v[6:7], v23, s[64:67], s9 offen
    s_lshl_b32 s12, s4, 10
    s_add_u32 s13, s6, s12
    v_mov_b32 v24, 0
    v_mov_b32 v25, 0
    v_mov_b32 v26, 0
    v_mov_b32 v27, 0
    v_and_b32 v28, 7, v0
    v_mul_u32_u24 v28, 4160, v28
    ds_write_b128 v28, v[24:27] offset:4096
    v_min_u32 v29, 29, v1
    v_lshlrev_b32 v29, 4, v29
    ds_write_b128 v29, v[24:27] offset:33280
    v_sub_u32 v30, 15, v21
    v_and_b32 v31, 7, v30
    v_mul_u32_u24 v2, 4160, v31
    v_lshrrev_b32 v30, 3, v30
    v_add_u32 v30, v30, v22
    v_lshl_add_u32 v2, v30, 4, v2
    s_lshl_b32 s14, s4, 7
    s_sub_u32 s14, 384, s14
    v_add_u32 v2, s14, v2
    v_lshlrev_b32 v3, 5, v21
    v_lshl_add_u32 v3, v22, 4, v3
    s_add_u32 s15, s14, 33280
    v_add_u32 v3, s15, v3
    s_waitcnt vmcnt(5)
    ds_write_b128 v11, v[40:43] offset:0
    ds_write_b128 v11, v[42:45] offset:16640
    v_mov_b32 v48, v41
    v_mov_b32 v49, v42
    v_mov_b32 v50, v43
    v_mov_b32 v51, v44
    v_mov_b32 v52, v45
    v_mov_b32 v53, v46
    ds_write_b128 v11, v[48:51] offset:8320
    ds_write_b128 v11, v[50:53] offset:24960
    v_alignbit_b32 v56, v41, v40, 16
    v_alignbit_b32 v57, v42, v41, 16
    v_alignbit_b32 v58, v43, v42, 16
    v_alignbit_b32 v59, v44, v43, 16
    v_alignbit_b32 v60, v45, v44, 16
    v_alignbit_b32 v61, v46, v45, 16
    ds_write_b128 v11, v[56:59] offset:4160
    ds_write_b128 v11, v[58:61] offset:20800
    v_alignbit_b32 v64, v42, v41, 16
    v_alignbit_b32 v65, v43, v42, 16
    v_alignbit_b32 v66, v44, v43, 16
    v_alignbit_b32 v67, v45, v44, 16
    v_alignbit_b32 v68, v46, v45, 16
    v_alignbit_b32 v69, v47, v46, 16
    ds_write_b128 v11, v[64:67] offset:12480
    ds_write_b128 v11, v[66:69] offset:29120
    s_waitcnt vmcnt(4)
    v_add_f32_dpp v18, v18, v18 quad_perm:[1,0,3,2] row_mask:0xf bank_mask:0xf
    s_nop 1
    v_add_f32_dpp v18, v18, v18 quad_perm:[2,3,0,1] row_mask:0xf bank_mask:0xf
    v_cvt_pk_bf16_f32 v18, v18, v18
    v_lshlrev_b32 v18, 16, v18
    s_nop 0
    v_readlane_b32 s80, v18, 0
    v_readlane_b32 s81, v18, 4
    v_readlane_b32 s82, v18, 8
    s_nop 1
    v_mov_b32 v32, s81
    v_add_f32 v32, 1.0, v32
    v_mov_b32 v33, v32
    v_mov_b32 v34, s80
    v_mov_b32 v35, s80
    s_waitcnt vmcnt(3)
    v_lshlrev_b32 v36, 16, v12
    v_and_b32 v37, 0xffff0000, v12
    v_pk_fma_f32 v[36:37], v[36:37], v[32:33], v[34:35]
    v_cvt_pk_bf16_f32 v12, v36, v37
    v_lshlrev_b32 v36, 16, v13
    v_and_b32 v37, 0xffff0000, v13
    v_pk_fma_f32 v[36:37], v[36:37], v[32:33], v[34:35]
    v_cvt_pk_bf16_f32 v13, v36, v37
    v_lshlrev_b32 v36, 16, v14
    v_and_b32 v37, 0xffff0000, v14
    v_pk_fma_f32 v[36:37], v[36:37], v[32:33], v[34:35]
    v_cvt_pk_bf16_f32 v14, v36, v37
    v_lshlrev_b32 v36, 16, v15
    v_and_b32 v37, 0xffff0000, v15
    v_pk_fma_f32 v[36:37], v[36:37], v[32:33], v[34:35]
    v_cvt_pk_bf16_f32 v15, v36, v37
    ds_write_b128 v11, v[12:15] offset:33760
    s_waitcnt vmcnt(2)
    v_lshlrev_b32 v20, 16, v20
    s_nop 0
    v_readfirstlane_b32 s83, v20
    s_waitcnt lgkmcnt(0)
    s_barrier
    ds_read_b128 v[40:43], v3 offset:64
    ds_read_b128 v[36:39], v2 offset:64
    ds_read_b128 v[44:47], v3 offset:576
    ds_read_b128 v[32:35], v2 offset:576
    ds_read_b128 v[48:51], v3 offset:1088
    ds_read_b128 v[28:31], v2 offset:1088
    ds_read_b128 v[52:55], v3 offset:1600
    ds_read_b128 v[24:27], v2 offset:1600
    ds_read_b128 v[56:59], v3 offset:2112
    ds_read_b128 v[20:23], v2 offset:2112
    ds_read_b128 v[60:63], v3 offset:2624
    ds_read_b128 v[16:19], v2 offset:2624
    ds_read_b128 v[64:67], v3 offset:3136
    ds_read_b128 v[12:15], v2 offset:3136
    ds_read_b128 v[68:71], v3 offset:3648
    ds_read_b128 v[8:11], v2 offset:3648
    s_waitcnt lgkmcnt(14)
    v_mfma_f32_16x16x32_bf16 v[100:103], v[36:39], v[40:43], 0
    ds_read_b128 v[36:39], v2 offset:0
    s_waitcnt lgkmcnt(13)
    v_mfma_f32_16x16x32_bf16 v[96:99], v[32:35], v[40:43], 0
    v_mfma_f32_16x16x32_bf16 v[100:103], v[32:35], v[44:47], v[100:103]
    ds_read_b128 v[32:35], v2 offset:512
    s_waitcnt lgkmcnt(12)
    v_mfma_f32_16x16x32_bf16 v[92:95], v[28:31], v[40:43], 0
    v_mfma_f32_16x16x32_bf16 v[96:99], v[28:31], v[44:47], v[96:99]
    v_mfma_f32_16x16x32_bf16 v[100:103], v[28:31], v[48:51], v[100:103]
    ds_read_b128 v[28:31], v2 offset:1024
    s_waitcnt lgkmcnt(11)
    v_mfma_f32_16x16x32_bf16 v[88:91], v[24:27], v[40:43], 0
    v_mfma_f32_16x16x32_bf16 v[92:95], v[24:27], v[44:47], v[92:95]
    v_mfma_f32_16x16x32_bf16 v[96:99], v[24:27], v[48:51], v[96:99]
    v_mfma_f32_16x16x32_bf16 v[100:103], v[24:27], v[52:55], v[100:103]
    ds_read_b128 v[24:27], v2 offset:1536
    s_waitcnt lgkmcnt(10)
    v_mfma_f32_16x16x32_bf16 v[84:87], v[20:23], v[40:43], 0
    v_mfma_f32_16x16x32_bf16 v[88:91], v[20:23], v[44:47], v[88:91]
    v_mfma_f32_16x16x32_bf16 v[92:95], v[20:23], v[48:51], v[92:95]
    v_mfma_f32_16x16x32_bf16 v[96:99], v[20:23], v[52:55], v[96:99]
    v_mfma_f32_16x16x32_bf16 v[100:103], v[20:23], v[56:59], v[100:103]
    ds_read_b128 v[20:23], v2 offset:2048
    s_waitcnt lgkmcnt(9)
    v_mfma_f32_16x16x32_bf16 v[80:83], v[16:19], v[40:43], 0
    v_mfma_f32_16x16x32_bf16 v[84:87], v[16:19], v[44:47], v[84:87]
    v_mfma_f32_16x16x32_bf16 v[88:91], v[16:19], v[48:51], v[88:91]
    v_mfma_f32_16x16x32_bf16 v[92:95], v[16:19], v[52:55], v[92:95]
    v_mfma_f32_16x16x32_bf16 v[96:99], v[16:19], v[56:59], v[96:99]
    v_mfma_f32_16x16x32_bf16 v[100:103], v[16:19], v[60:63], v[100:103]
    ds_read_b128 v[16:19], v2 offset:2560
    s_waitcnt lgkmcnt(8)
    v_mfma_f32_16x16x32_bf16 v[76:79], v[12:15], v[40:43], 0
    v_mfma_f32_16x16x32_bf16 v[80:83], v[12:15], v[44:47], v[80:83]
    v_mfma_f32_16x16x32_bf16 v[84:87], v[12:15], v[48:51], v[84:87]
    v_mfma_f32_16x16x32_bf16 v[88:91], v[12:15], v[52:55], v[88:91]
    v_mfma_f32_16x16x32_bf16 v[92:95], v[12:15], v[56:59], v[92:95]
    v_mfma_f32_16x16x32_bf16 v[96:99], v[12:15], v[60:63], v[96:99]
    v_mfma_f32_16x16x32_bf16 v[100:103], v[12:15], v[64:67], v[100:103]
    ds_read_b128 v[12:15], v2 offset:3072
    s_waitcnt lgkmcnt(7)
    v_mfma_f32_16x16x32_bf16 v[72:75], v[8:11], v[40:43], 0
    v_mfma_f32_16x16x32_bf16 v[76:79], v[8:11], v[44:47], v[76:79]
    v_mfma_f32_16x16x32_bf16 v[80:83], v[8:11], v[48:51], v[80:83]
    v_mfma_f32_16x16x32_bf16 v[84:87], v[8:11], v[52:55], v[84:87]
    v_mfma_f32_16x16x32_bf16 v[88:91], v[8:11], v[56:59], v[88:91]
    v_mfma_f32_16x16x32_bf16 v[92:95], v[8:11], v[60:63], v[92:95]
    v_mfma_f32_16x16x32_bf16 v[96:99], v[8:11], v[64:67], v[96:99]
    v_mfma_f32_16x16x32_bf16 v[100:103], v[8:11], v[68:71], v[100:103]
    ds_read_b128 v[8:11], v2 offset:3584
    ds_read_b128 v[40:43], v3 offset:0
    ds_read_b128 v[44:47], v3 offset:512
    ds_read_b128 v[48:51], v3 offset:1024
    ds_read_b128 v[52:55], v3 offset:1536
    ds_read_b128 v[56:59], v3 offset:2048
    ds_read_b128 v[60:63], v3 offset:2560
    ds_read_b128 v[64:67], v3 offset:3072
    ds_read_b128 v[68:71], v3 offset:3584
    s_waitcnt lgkmcnt(7)
    v_mfma_f32_16x16x32_bf16 v[100:103], v[36:39], v[40:43], v[100:103]
    v_mfma_f32_16x16x32_bf16 v[96:99], v[32:35], v[40:43], v[96:99]
    v_mfma_f32_16x16x32_bf16 v[92:95], v[28:31], v[40:43], v[92:95]
    v_mfma_f32_16x16x32_bf16 v[88:91], v[24:27], v[40:43], v[88:91]
    v_mfma_f32_16x16x32_bf16 v[84:87], v[20:23], v[40:43], v[84:87]
    v_mfma_f32_16x16x32_bf16 v[80:83], v[16:19], v[40:43], v[80:83]
    v_mfma_f32_16x16x32_bf16 v[76:79], v[12:15], v[40:43], v[76:79]
    v_mfma_f32_16x16x32_bf16 v[72:75], v[8:11], v[40:43], v[72:75]
    s_waitcnt lgkmcnt(6)
    v_mfma_f32_16x16x32_bf16 v[100:103], v[32:35], v[44:47], v[100:103]
    v_mfma_f32_16x16x32_bf16 v[96:99], v[28:31], v[44:47], v[96:99]
    v_mfma_f32_16x16x32_bf16 v[92:95], v[24:27], v[44:47], v[92:95]
    v_mfma_f32_16x16x32_bf16 v[88:91], v[20:23], v[44:47], v[88:91]
    v_mfma_f32_16x16x32_bf16 v[84:87], v[16:19], v[44:47], v[84:87]
    v_mfma_f32_16x16x32_bf16 v[80:83], v[12:15], v[44:47], v[80:83]
    v_mfma_f32_16x16x32_bf16 v[76:79], v[8:11], v[44:47], v[76:79]
    s_waitcnt lgkmcnt(5)
    v_mfma_f32_16x16x32_bf16 v[100:103], v[28:31], v[48:51], v[100:103]
    v_mfma_f32_16x16x32_bf16 v[96:99], v[24:27], v[48:51], v[96:99]
    v_mfma_f32_16x16x32_bf16 v[92:95], v[20:23], v[48:51], v[92:95]
    v_mfma_f32_16x16x32_bf16 v[88:91], v[16:19], v[48:51], v[88:91]
    v_mfma_f32_16x16x32_bf16 v[84:87], v[12:15], v[48:51], v[84:87]
    v_mfma_f32_16x16x32_bf16 v[80:83], v[8:11], v[48:51], v[80:83]
    s_waitcnt lgkmcnt(4)
    v_mfma_f32_16x16x32_bf16 v[100:103], v[24:27], v[52:55], v[100:103]
    v_mfma_f32_16x16x32_bf16 v[96:99], v[20:23], v[52:55], v[96:99]
    v_mfma_f32_16x16x32_bf16 v[92:95], v[16:19], v[52:55], v[92:95]
    v_mfma_f32_16x16x32_bf16 v[88:91], v[12:15], v[52:55], v[88:91]
    v_mfma_f32_16x16x32_bf16 v[84:87], v[8:11], v[52:55], v[84:87]
    s_waitcnt lgkmcnt(3)
    v_mfma_f32_16x16x32_bf16 v[100:103], v[20:23], v[56:59], v[100:103]
    v_mfma_f32_16x16x32_bf16 v[96:99], v[16:19], v[56:59], v[96:99]
    v_mfma_f32_16x16x32_bf16 v[92:95], v[12:15], v[56:59], v[92:95]
    v_mfma_f32_16x16x32_bf16 v[88:91], v[8:11], v[56:59], v[88:91]
    s_waitcnt lgkmcnt(2)
    v_mfma_f32_16x16x32_bf16 v[100:103], v[16:19], v[60:63], v[100:103]
    v_mfma_f32_16x16x32_bf16 v[96:99], v[12:15], v[60:63], v[96:99]
    v_mfma_f32_16x16x32_bf16 v[92:95], v[8:11], v[60:63], v[92:95]
    s_waitcnt lgkmcnt(1)
    v_mfma_f32_16x16x32_bf16 v[100:103], v[12:15], v[64:67], v[100:103]
    v_mfma_f32_16x16x32_bf16 v[96:99], v[8:11], v[64:67], v[96:99]
    s_waitcnt lgkmcnt(0)
    v_mfma_f32_16x16x32_bf16 v[100:103], v[8:11], v[68:71], v[100:103]
    v_lshlrev_b32 v8, 4, v1
    s_barrier
    s_cmp_eq_u32 s4, 0
    s_cbranch_scc0 k2_red_0
    ds_write_b128 v8, v[80:83] offset:8192
    ds_write_b128 v8, v[84:87] offset:11264
    ds_write_b128 v8, v[88:91] offset:13312
    ds_write_b128 v8, v[92:95] offset:16384
    ds_write_b128 v8, v[96:99] offset:18432
    ds_write_b128 v8, v[100:103] offset:21504
    v_mov_b32 v40, v72
    v_mov_b32 v41, v73
    v_mov_b32 v42, v74
    v_mov_b32 v43, v75
    v_mov_b32 v44, v76
    v_mov_b32 v45, v77
    v_mov_b32 v46, v78
    v_mov_b32 v47, v79
k2_red_0:
    s_cmp_eq_u32 s4, 1
    s_cbranch_scc0 k2_red_1
    ds_write_b128 v8, v[72:75] offset:0
    ds_write_b128 v8, v[76:79] offset:3072
    ds_write_b128 v8, v[88:91] offset:14336
    ds_write_b128 v8, v[92:95] offset:17408
    ds_write_b128 v8, v[96:99] offset:19456
    ds_write_b128 v8, v[100:103] offset:22528
    v_mov_b32 v40, v80
    v_mov_b32 v41, v81
    v_mov_b32 v42, v82
    v_mov_b32 v43, v83
    v_mov_b32 v44, v84
    v_mov_b32 v45, v85
    v_mov_b32 v46, v86
    v_mov_b32 v47, v87
k2_red_1:
    s_cmp_eq_u32 s4, 2
    s_cbranch_scc0 k2_red_2
    ds_write_b128 v8, v[72:75] offset:1024
    ds_write_b128 v8, v[76:79] offset:4096
    ds_write_b128 v8, v[80:83] offset:6144
    ds_write_b128 v8, v[84:87] offset:9216
    ds_write_b128 v8, v[96:99] offset:20480
    ds_write_b128 v8, v[100:103] offset:23552
    v_mov_b32 v40, v88
    v_mov_b32 v41, v89
    v_mov_b32 v42, v90
    v_mov_b32 v43, v91
    v_mov_b32 v44, v92
    v_mov_b32 v45, v93
    v_mov_b32 v46, v94
    v_mov_b32 v47, v95
k2_red_2:
    s_cmp_eq_u32 s4, 3
    s_cbranch_scc0 k2_red_3
    ds_write_b128 v8, v[72:75] offset:2048
    ds_write_b128 v8, v[76:79] offset:5120
    ds_write_b128 v8, v[80:83] offset:7168
    ds_write_b128 v8, v[84:87] offset:10240
    ds_write_b128 v8, v[88:91] offset:12288
    ds_write_b128 v8, v[92:95] offset:15360
    v_mov_b32 v40, v96
    v_mov_b32 v41, v97
    v_mov_b32 v42, v98
    v_mov_b32 v43, v99
    v_mov_b32 v44, v100
    v_mov_b32 v45, v101
    v_mov_b32 v46, v102
    v_mov_b32 v47, v103
k2_red_3:
    s_mul_i32 s12, s4, 6144
    v_add_u32 v9, s12, v8
    v_and_b32 v21, 15, v1
    v_lshrrev_b32 v22, 4, v1
    v_lshlrev_b32 v23, 5, v21
    v_lshl_add_u32 v23, v22, 3, v23
    s_lshl_b32 s12, s4, 10
    v_add_u32 v10, s12, v23
    v_lshrrev_b32 v11, 1, v21
    v_lshlrev_b32 v11, 6, v11
    v_and_b32 v12, 1, v22
    v_lshl_add_u32 v11, v12, 5, v11
    v_and_b32 v12, 1, v21
    v_lshl_add_u32 v11, v12, 4, v11
    v_lshrrev_b32 v12, 1, v22
    v_lshl_add_u32 v11, v12, 3, v11
    s_waitcnt lgkmcnt(0)
    s_barrier
    ds_read_b64 v[12:13], v10 offset:33760
    ds_read_b64 v[14:15], v10 offset:34272
    ds_read_b128 v[48:51], v9 offset:0
    ds_read_b128 v[52:55], v9 offset:1024
    ds_read_b128 v[56:59], v9 offset:2048
    ds_read_b128 v[60:63], v9 offset:3072
    ds_read_b128 v[64:67], v9 offset:4096
    ds_read_b128 v[68:71], v9 offset:5120
    v_mov_b32 v16, s83
    v_mov_b32 v17, s83
    v_mov_b32 v18, s82
    v_mov_b32 v19, s82
    s_waitcnt lgkmcnt(0) vmcnt(0)
    v_pk_add_f32 v[40:41], v[40:41], v[48:49]
    v_pk_add_f32 v[42:43], v[42:43], v[50:51]
    v_pk_add_f32 v[40:41], v[40:41], v[52:53]
    v_pk_add_f32 v[42:43], v[42:43], v[54:55]
    v_pk_add_f32 v[40:41], v[40:41], v[56:57]
    v_pk_add_f32 v[42:43], v[42:43], v[58:59]
    v_lshlrev_b32 v20, 16, v12
    v_and_b32 v21, 0xffff0000, v12
    v_pk_fma_f32 v[40:41], v[20:21], v[16:17], v[40:41]
    v_lshlrev_b32 v22, 16, v4
    v_and_b32 v23, 0xffff0000, v4
    v_pk_fma_f32 v[40:41], v[40:41], v[18:19], v[22:23]
    v_cvt_pk_bf16_f32 v24, v40, v41
    v_lshlrev_b32 v20, 16, v13
    v_and_b32 v21, 0xffff0000, v13
    v_pk_fma_f32 v[42:43], v[20:21], v[16:17], v[42:43]
    v_lshlrev_b32 v22, 16, v5
    v_and_b32 v23, 0xffff0000, v5
    v_pk_fma_f32 v[42:43], v[42:43], v[18:19], v[22:23]
    v_cvt_pk_bf16_f32 v25, v42, v43
    buffer_store_dwordx2 v[24:25], v11, s[76:79], s13 offen offset:0
    v_pk_add_f32 v[44:45], v[44:45], v[60:61]
    v_pk_add_f32 v[46:47], v[46:47], v[62:63]
    v_pk_add_f32 v[44:45], v[44:45], v[64:65]
    v_pk_add_f32 v[46:47], v[46:47], v[66:67]
    v_pk_add_f32 v[44:45], v[44:45], v[68:69]
    v_pk_add_f32 v[46:47], v[46:47], v[70:71]
    v_lshlrev_b32 v20, 16, v14
    v_and_b32 v21, 0xffff0000, v14
    v_pk_fma_f32 v[44:45], v[20:21], v[16:17], v[44:45]
    v_lshlrev_b32 v22, 16, v6
    v_and_b32 v23, 0xffff0000, v6
    v_pk_fma_f32 v[44:45], v[44:45], v[18:19], v[22:23]
    v_cvt_pk_bf16_f32 v26, v44, v45
    v_lshlrev_b32 v20, 16, v15
    v_and_b32 v21, 0xffff0000, v15
    v_pk_fma_f32 v[46:47], v[20:21], v[16:17], v[46:47]
    v_lshlrev_b32 v22, 16, v7
    v_and_b32 v23, 0xffff0000, v7
    v_pk_fma_f32 v[46:47], v[46:47], v[18:19], v[22:23]
    v_cvt_pk_bf16_f32 v27, v46, v47
    buffer_store_dwordx2 v[26:27], v11, s[76:79], s13 offen offset:512
    s_waitcnt vmcnt(0)
    s_endpgm
k2_wp:
    s_mov_b32 s56, s36
    s_mov_b32 s57, s37
    s_mov_b32 s58, 2211840
    s_mov_b32 s59, 0x00020000
    s_mov_b32 s60, s52
    s_mov_b32 s61, s53
    s_mov_b32 s62, 61440
    s_mov_b32 s63, 0x00020000
    s_add_u32 s64, s52, 9101312
    s_addc_u32 s65, s53, 0
    s_mov_b32 s66, 2211840
    s_mov_b32 s67, 0x00020000
    s_add_u32 s68, s52, 11313152
    s_addc_u32 s69, s53, 0
    s_mov_b32 s70, 27648
    s_mov_b32 s71, 0x00020000
    s_add_u32 s72, s52, 11341824
    s_addc_u32 s73, s53, 0
    s_mov_b32 s74, 27648
    s_mov_b32 s75, 0x00020000
    s_sub_u32 s3, s2, 640
    s_mul_i32 s4, s3, 2428
    s_lshr_b32 s4, s4, 16
    s_mul_i32 s5, s4, 27
    s_sub_u32 s5, s3, s5
    v_and_b32 v1, 7, v0
    v_lshrrev_b32 v2, 3, v0
    v_mul_u32_u24 v3, 3456, v2
    v_lshl_add_u32 v3, v1, 4, v3
    s_mul_i32 s6, s4, 552960
    s_lshl_b32 s7, s5, 7
    s_add_u32 s6, s6, s7
    v_and_b32 v4, 3, v1
    v_mul_u32_u24 v4, 15360, v4
    v_lshrrev_b32 v5, 2, v1
    v_mul_u32_u24 v5, 2560, v5
    v_add_u32 v4, v4, v5
    v_lshl_add_u32 v4, v2, 2, v4
    s_mul_i32 s12, s4, 640
    s_add_u32 s12, s12, 7680
    s_add_u32 s7, s6, 110592
    s_add_u32 s8, s6, 221184
    s_add_u32 s9, s6, 331776
    s_add_u32 s10, s6, 442368
    buffer_load_dword v28, v4, s[60:63], s12 offen offset:0
    buffer_load_dword v29, v4, s[60:63], s12 offen offset:128
    buffer_load_dword v30, v4, s[60:63], s12 offen offset:256
    buffer_load_dword v31, v4, s[60:63], s12 offen offset:384
    buffer_load_dword v32, v4, s[60:63], s12 offen offset:512
    buffer_load_dwordx4 v[8:11], v3, s[56:59], s6 offen
    buffer_load_dwordx4 v[12:15], v3, s[56:59], s7 offen
    buffer_load_dwordx4 v[16:19], v3, s[56:59], s8 offen
    buffer_load_dwordx4 v[20:23], v3, s[56:59], s9 offen
    buffer_load_dwordx4 v[24:27], v3, s[56:59], s10 offen
    v_mul_u32_u24 v6, 192, v2
    v_lshl_add_u32 v6, v1, 4, v6
    v_cmp_gt_u32 vcc, 4, v1
    s_waitcnt vmcnt(5)
    v_add_f32_dpp v28, v28, v28 quad_perm:[1,0,3,2] row_mask:0xf bank_mask:0xf
    s_nop 1
    v_add_f32_dpp v28, v28, v28 quad_perm:[2,3,0,1] row_mask:0xf bank_mask:0xf
    v_cvt_pk_bf16_f32 v28, v28, v28
    v_lshlrev_b32 v28, 16, v28
    s_nop 1
    v_mov_b32_dpp v5, v28 row_half_mirror row_mask:0xf bank_mask:0xf
    v_cndmask_b32 v34, v28, v5, vcc
    v_cndmask_b32 v36, v5, v28, vcc
    v_add_f32 v34, 1.0, v34
    v_mov_b32 v35, v34
    v_mov_b32 v37, v36
    v_add_f32_dpp v29, v29, v29 quad_perm:[1,0,3,2] row_mask:0xf bank_mask:0xf
    s_nop 1
    v_add_f32_dpp v29, v29, v29 quad_perm:[2,3,0,1] row_mask:0xf bank_mask:0xf
    v_cvt_pk_bf16_f32 v29, v29, v29
    v_lshlrev_b32 v29, 16, v29
    s_nop 1
    v_mov_b32_dpp v5, v29 row_half_mirror row_mask:0xf bank_mask:0xf
    v_cndmask_b32 v38, v29, v5, vcc
    v_cndmask_b32 v40, v5, v29, vcc
    v_add_f32 v38, 1.0, v38
    v_mov_b32 v39, v38
    v_mov_b32 v41, v40
    v_add_f32_dpp v30, v30, v30 quad_perm:[1,0,3,2] row_mask:0xf bank_mask:0xf
    s_nop 1
    v_add_f32_dpp v30, v30, v30 quad_perm:[2,3,0,1] row_mask:0xf bank_mask:0xf
    v_cvt_pk_bf16_f32 v30, v30, v30
    v_lshlrev_b32 v30, 16, v30
    s_nop 1
    v_mov_b32_dpp v5, v30 row_half_mirror row_mask:0xf bank_mask:0xf
    v_cndmask_b32 v42, v30, v5, vcc
    v_cndmask_b32 v44, v5, v30, vcc
    v_add_f32 v42, 1.0, v42
    v_mov_b32 v43, v42
    v_mov_b32 v45, v44
    v_add_f32_dpp v31, v31, v31 quad_perm:[1,0,3,2] row_mask:0xf bank_mask:0xf
    s_nop 1
    v_add_f32_dpp v31, v31, v31 quad_perm:[2,3,0,1] row_mask:0xf bank_mask:0xf
    v_cvt_pk_bf16_f32 v31, v31, v31
    v_lshlrev_b32 v31, 16, v31
    s_nop 1
    v_mov_b32_dpp v5, v31 row_half_mirror row_mask:0xf bank_mask:0xf
    v_cndmask_b32 v46, v31, v5, vcc
    v_cndmask_b32 v48, v5, v31, vcc
    v_add_f32 v46, 1.0, v46
    v_mov_b32 v47, v46
    v_mov_b32 v49, v48
    v_add_f32_dpp v32, v32, v32 quad_perm:[1,0,3,2] row_mask:0xf bank_mask:0xf
    s_nop 1
    v_add_f32_dpp v32, v32, v32 quad_perm:[2,3,0,1] row_mask:0xf bank_mask:0xf
    v_cvt_pk_bf16_f32 v32, v32, v32
    v_lshlrev_b32 v32, 16, v32
    s_nop 1
    v_mov_b32_dpp v5, v32 row_half_mirror row_mask:0xf bank_mask:0xf
    v_cndmask_b32 v50, v32, v5, vcc
    v_cndmask_b32 v52, v5, v32, vcc
    v_add_f32 v50, 1.0, v50
    v_mov_b32 v51, v50
    v_mov_b32 v53, v52
    s_waitcnt vmcnt(4)
    v_lshlrev_b32 v72, 16, v8
    v_and_b32 v73, 0xffff0000, v8
    v_pk_mul_f32 v[74:75], v[72:73], v[34:35]
    v_pk_mul_f32 v[64:65], v[72:73], v[36:37]
    v_cvt_pk_bf16_f32 v8, v74, v75
    v_lshlrev_b32 v56, 16, v8
    v_and_b32 v57, 0xffff0000, v8
    v_lshlrev_b32 v72, 16, v9
    v_and_b32 v73, 0xffff0000, v9
    v_pk_mul_f32 v[74:75], v[72:73], v[34:35]
    v_pk_mul_f32 v[66:67], v[72:73], v[36:37]
    v_cvt_pk_bf16_f32 v9, v74, v75
    v_lshlrev_b32 v58, 16, v9
    v_and_b32 v59, 0xffff0000, v9
    v_lshlrev_b32 v72, 16, v10
    v_and_b32 v73, 0xffff0000, v10
    v_pk_mul_f32 v[74:75], v[72:73], v[34:35]
    v_pk_mul_f32 v[68:69], v[72:73], v[36:37]
    v_cvt_pk_bf16_f32 v10, v74, v75
    v_lshlrev_b32 v60, 16, v10
    v_and_b32 v61, 0xffff0000, v10
    v_lshlrev_b32 v72, 16, v11
    v_and_b32 v73, 0xffff0000, v11
    v_pk_mul_f32 v[74:75], v[72:73], v[34:35]
    v_pk_mul_f32 v[70:71], v[72:73], v[36:37]
    v_cvt_pk_bf16_f32 v11, v74, v75
    v_lshlrev_b32 v62, 16, v11
    v_and_b32 v63, 0xffff0000, v11
    ds_write_b128 v6, v[8:11] offset:0
    s_waitcnt vmcnt(3)
    v_lshlrev_b32 v72, 16, v12
    v_and_b32 v73, 0xffff0000, v12
    v_pk_mul_f32 v[74:75], v[72:73], v[38:39]
    v_pk_fma_f32 v[64:65], v[72:73], v[40:41], v[64:65]
    v_cvt_pk_bf16_f32 v12, v74, v75
    v_lshlrev_b32 v76, 16, v12
    v_and_b32 v77, 0xffff0000, v12
    v_pk_add_f32 v[56:57], v[56:57], v[76:77]
    v_lshlrev_b32 v72, 16, v13
    v_and_b32 v73, 0xffff0000, v13
    v_pk_mul_f32 v[74:75], v[72:73], v[38:39]
    v_pk_fma_f32 v[66:67], v[72:73], v[40:41], v[66:67]
    v_cvt_pk_bf16_f32 v13, v74, v75
    v_lshlrev_b32 v76, 16, v13
    v_and_b32 v77, 0xffff0000, v13
    v_pk_add_f32 v[58:59], v[58:59], v[76:77]
    v_lshlrev_b32 v72, 16, v14
    v_and_b32 v73, 0xffff0000, v14
    v_pk_mul_f32 v[74:75], v[72:73], v[38:39]
    v_pk_fma_f32 v[68:69], v[72:73], v[40:41], v[68:69]
    v_cvt_pk_bf16_f32 v14, v74, v75
    v_lshlrev_b32 v76, 16, v14
    v_and_b32 v77, 0xffff0000, v14
    v_pk_add_f32 v[60:61], v[60:61], v[76:77]
    v_lshlrev_b32 v72, 16, v15
    v_and_b32 v73, 0xffff0000, v15
    v_pk_mul_f32 v[74:75], v[72:73], v[38:39]
    v_pk_fma_f32 v[70:71], v[72:73], v[40:41], v[70:71]
    v_cvt_pk_bf16_f32 v15, v74, v75
    v_lshlrev_b32 v76, 16, v15
    v_and_b32 v77, 0xffff0000, v15
    v_pk_add_f32 v[62:63], v[62:63], v[76:77]
    ds_write_b128 v6, v[12:15] offset:6144
    s_waitcnt vmcnt(2)
    v_lshlrev_b32 v72, 16, v16
    v_and_b32 v73, 0xffff0000, v16
    v_pk_mul_f32 v[74:75], v[72:73], v[42:43]
    v_pk_fma_f32 v[64:65], v[72:73], v[44:45], v[64:65]
    v_cvt_pk_bf16_f32 v16, v74, v75
    v_lshlrev_b32 v76, 16, v16
    v_and_b32 v77, 0xffff0000, v16
    v_pk_add_f32 v[56:57], v[56:57], v[76:77]
    v_lshlrev_b32 v72, 16, v17
    v_and_b32 v73, 0xffff0000, v17
    v_pk_mul_f32 v[74:75], v[72:73], v[42:43]
    v_pk_fma_f32 v[66:67], v[72:73], v[44:45], v[66:67]
    v_cvt_pk_bf16_f32 v17, v74, v75
    v_lshlrev_b32 v76, 16, v17
    v_and_b32 v77, 0xffff0000, v17
    v_pk_add_f32 v[58:59], v[58:59], v[76:77]
    v_lshlrev_b32 v72, 16, v18
    v_and_b32 v73, 0xffff0000, v18
    v_pk_mul_f32 v[74:75], v[72:73], v[42:43]
    v_pk_fma_f32 v[68:69], v[72:73], v[44:45], v[68:69]
    v_cvt_pk_bf16_f32 v18, v74, v75
    v_lshlrev_b32 v76, 16, v18
    v_and_b32 v77, 0xffff0000, v18
    v_pk_add_f32 v[60:61], v[60:61], v[76:77]
    v_lshlrev_b32 v72, 16, v19
    v_and_b32 v73, 0xffff0000, v19
    v_pk_mul_f32 v[74:75], v[72:73], v[42:43]
    v_pk_fma_f32 v[70:71], v[72:73], v[44:45], v[70:71]
    v_cvt_pk_bf16_f32 v19, v74, v75
    v_lshlrev_b32 v76, 16, v19
    v_and_b32 v77, 0xffff0000, v19
    v_pk_add_f32 v[62:63], v[62:63], v[76:77]
    ds_write_b128 v6, v[16:19] offset:12288
    s_waitcnt vmcnt(1)
    v_lshlrev_b32 v72, 16, v20
    v_and_b32 v73, 0xffff0000, v20
    v_pk_mul_f32 v[74:75], v[72:73], v[46:47]
    v_pk_fma_f32 v[64:65], v[72:73], v[48:49], v[64:65]
    v_cvt_pk_bf16_f32 v20, v74, v75
    v_lshlrev_b32 v76, 16, v20
    v_and_b32 v77, 0xffff0000, v20
    v_pk_add_f32 v[56:57], v[56:57], v[76:77]
    v_lshlrev_b32 v72, 16, v21
    v_and_b32 v73, 0xffff0000, v21
    v_pk_mul_f32 v[74:75], v[72:73], v[46:47]
    v_pk_fma_f32 v[66:67], v[72:73], v[48:49], v[66:67]
    v_cvt_pk_bf16_f32 v21, v74, v75
    v_lshlrev_b32 v76, 16, v21
    v_and_b32 v77, 0xffff0000, v21
    v_pk_add_f32 v[58:59], v[58:59], v[76:77]
    v_lshlrev_b32 v72, 16, v22
    v_and_b32 v73, 0xffff0000, v22
    v_pk_mul_f32 v[74:75], v[72:73], v[46:47]
    v_pk_fma_f32 v[68:69], v[72:73], v[48:49], v[68:69]
    v_cvt_pk_bf16_f32 v22, v74, v75
    v_lshlrev_b32 v76, 16, v22
    v_and_b32 v77, 0xffff0000, v22
    v_pk_add_f32 v[60:61], v[60:61], v[76:77]
    v_lshlrev_b32 v72, 16, v23
    v_and_b32 v73, 0xffff0000, v23
    v_pk_mul_f32 v[74:75], v[72:73], v[46:47]
    v_pk_fma_f32 v[70:71], v[72:73], v[48:49], v[70:71]
    v_cvt_pk_bf16_f32 v23, v74, v75
    v_lshlrev_b32 v76, 16, v23
    v_and_b32 v77, 0xffff0000, v23
    v_pk_add_f32 v[62:63], v[62:63], v[76:77]
    ds_write_b128 v6, v[20:23] offset:18432
    s_waitcnt vmcnt(0)
    v_lshlrev_b32 v72, 16, v24
    v_and_b32 v73, 0xffff0000, v24
    v_pk_mul_f32 v[74:75], v[72:73], v[50:51]
    v_pk_fma_f32 v[64:65], v[72:73], v[52:53], v[64:65]
    v_cvt_pk_bf16_f32 v24, v74, v75
    v_lshlrev_b32 v76, 16, v24
    v_and_b32 v77, 0xffff0000, v24
    v_pk_add_f32 v[56:57], v[56:57], v[76:77]
    v_lshlrev_b32 v72, 16, v25
    v_and_b32 v73, 0xffff0000, v25
    v_pk_mul_f32 v[74:75], v[72:73], v[50:51]
    v_pk_fma_f32 v[66:67], v[72:73], v[52:53], v[66:67]
    v_cvt_pk_bf16_f32 v25, v74, v75
    v_lshlrev_b32 v76, 16, v25
    v_and_b32 v77, 0xffff0000, v25
    v_pk_add_f32 v[58:59], v[58:59], v[76:77]
    v_lshlrev_b32 v72, 16, v26
    v_and_b32 v73, 0xffff0000, v26
    v_pk_mul_f32 v[74:75], v[72:73], v[50:51]
    v_pk_fma_f32 v[68:69], v[72:73], v[52:53], v[68:69]
    v_cvt_pk_bf16_f32 v26, v74, v75
    v_lshlrev_b32 v76, 16, v26
    v_and_b32 v77, 0xffff0000, v26
    v_pk_add_f32 v[60:61], v[60:61], v[76:77]
    v_lshlrev_b32 v72, 16, v27
    v_and_b32 v73, 0xffff0000, v27
    v_pk_mul_f32 v[74:75], v[72:73], v[50:51]
    v_pk_fma_f32 v[70:71], v[72:73], v[52:53], v[70:71]
    v_cvt_pk_bf16_f32 v27, v74, v75
    v_lshlrev_b32 v76, 16, v27
    v_and_b32 v77, 0xffff0000, v27
    v_pk_add_f32 v[62:63], v[62:63], v[76:77]
    ds_write_b128 v6, v[24:27] offset:24576
    v_add_f32_dpp v56, v56, v56 row_ror:8 row_mask:0xf bank_mask:0xf
    v_add_f32_dpp v57, v57, v57 row_ror:8 row_mask:0xf bank_mask:0xf
    v_add_f32_dpp v58, v58, v58 row_ror:8 row_mask:0xf bank_mask:0xf
    v_add_f32_dpp v59, v59, v59 row_ror:8 row_mask:0xf bank_mask:0xf
    v_add_f32_dpp v60, v60, v60 row_ror:8 row_mask:0xf bank_mask:0xf
    v_add_f32_dpp v61, v61, v61 row_ror:8 row_mask:0xf bank_mask:0xf
    v_add_f32_dpp v62, v62, v62 row_ror:8 row_mask:0xf bank_mask:0xf
    v_add_f32_dpp v63, v63, v63 row_ror:8 row_mask:0xf bank_mask:0xf
    v_add_f32_dpp v64, v64, v64 row_ror:8 row_mask:0xf bank_mask:0xf
    v_add_f32_dpp v65, v65, v65 row_ror:8 row_mask:0xf bank_mask:0xf
    v_add_f32_dpp v66, v66, v66 row_ror:8 row_mask:0xf bank_mask:0xf
    v_add_f32_dpp v67, v67, v67 row_ror:8 row_mask:0xf bank_mask:0xf
    v_add_f32_dpp v68, v68, v68 row_ror:8 row_mask:0xf bank_mask:0xf
    v_add_f32_dpp v69, v69, v69 row_ror:8 row_mask:0xf bank_mask:0xf
    v_add_f32_dpp v70, v70, v70 row_ror:8 row_mask:0xf bank_mask:0xf
    v_add_f32_dpp v71, v71, v71 row_ror:8 row_mask:0xf bank_mask:0xf
    v_lshrrev_b32 v5, 4, v0
    v_lshlrev_b32 v5, 8, v5
    v_lshl_add_u32 v5, v1, 5, v5
    ds_write_b128 v5, v[56:59] offset:30720
    ds_write_b128 v5, v[60:63] offset:30736
    ds_write_b128 v5, v[64:67] offset:34816
    ds_write_b128 v5, v[68:71] offset:34832
    v_and_b32 v40, 63, v0
    v_lshrrev_b32 v41, 6, v0
    v_lshrrev_b32 v42, 4, v40
    v_bfe_u32 v43, v40, 2, 2
    v_and_b32 v44, 3, v40
    v_lshl_add_u32 v7, v42, 3, v43
    v_mul_u32_u24 v7, 192, v7
    v_lshl_add_u32 v7, v44, 4, v7
    v_lshrrev_b32 v45, 1, v41
    v_lshl_add_u32 v7, v45, 6, v7
    v_and_b32 v45, 1, v41
    v_lshl_add_u32 v7, v45, 3, v7
    v_lshlrev_b32 v46, 4, v40
    v_lshl_add_u32 v46, v41, 10, v46
    s_mul_i32 s6, s4, 540
    s_lshl_b32 s7, s5, 2
    s_add_u32 s6, s6, s7
    s_lshl_b32 s6, s6, 10
    s_waitcnt lgkmcnt(0)
    s_barrier
    ds_read_b64_tr_b16 v[8:9], v7 offset:0
    ds_read_b64_tr_b16 v[10:11], v7 offset:768
    ds_read_b64_tr_b16 v[12:13], v7 offset:6144
    ds_read_b64_tr_b16 v[14:15], v7 offset:6912
    ds_read_b64_tr_b16 v[16:17], v7 offset:12288
    ds_read_b64_tr_b16 v[18:19], v7 offset:13056
    ds_read_b64_tr_b16 v[20:21], v7 offset:18432
    ds_read_b64_tr_b16 v[22:23], v7 offset:19200
    ds_read_b64_tr_b16 v[24:25], v7 offset:24576
    ds_read_b64_tr_b16 v[26:27], v7 offset:25344
    s_waitcnt lgkmcnt(8)
    buffer_store_dwordx4 v[8:11], v46, s[64:67], s6 offen
    s_add_u32 s6, s6, 110592
    s_waitcnt lgkmcnt(6)
    buffer_store_dwordx4 v[12:15], v46, s[64:67], s6 offen
    s_add_u32 s6, s6, 110592
    s_waitcnt lgkmcnt(4)
    buffer_store_dwordx4 v[16:19], v46, s[64:67], s6 offen
    s_add_u32 s6, s6, 110592
    s_waitcnt lgkmcnt(2)
    buffer_store_dwordx4 v[20:23], v46, s[64:67], s6 offen
    s_add_u32 s6, s6, 110592
    s_waitcnt lgkmcnt(0)
    buffer_store_dwordx4 v[24:27], v46, s[64:67], s6 offen
    s_add_u32 s6, s6, 110592
    v_cmp_gt_u32 vcc, 128, v0
    s_nop 0
    s_and_saveexec_b64 s[14:15], vcc
    s_cbranch_execz k2_wp_end
    v_lshlrev_b32 v6, 2, v40
    v_lshl_add_u32 v5, v41, 12, v6
    ds_read_b32 v48, v5 offset:30720
    ds_read_b32 v49, v5 offset:30976
    ds_read_b32 v50, v5 offset:31232
    ds_read_b32 v51, v5 offset:31488
    ds_read_b32 v52, v5 offset:31744
    ds_read_b32 v53, v5 offset:32000
    ds_read_b32 v54, v5 offset:32256
    ds_read_b32 v55, v5 offset:32512
    ds_read_b32 v56, v5 offset:32768
    ds_read_b32 v57, v5 offset:33024
    ds_read_b32 v58, v5 offset:33280
    ds_read_b32 v59, v5 offset:33536
    ds_read_b32 v60, v5 offset:33792
    ds_read_b32 v61, v5 offset:34048
    ds_read_b32 v62, v5 offset:34304
    ds_read_b32 v63, v5 offset:34560
    s_waitcnt lgkmcnt(0)
    v_add_f32 v48, v48, v56
    v_add_f32 v49, v49, v57
    v_add_f32 v50, v50, v58
    v_add_f32 v51, v51, v59
    v_add_f32 v52, v52, v60
    v_add_f32 v53, v53, v61
    v_add_f32 v54, v54, v62
    v_add_f32 v55, v55, v63
    v_add_f32 v48, v48, v52
    v_add_f32 v49, v49, v53
    v_add_f32 v50, v50, v54
    v_add_f32 v51, v51, v55
    v_add_f32 v48, v48, v50
    v_add_f32 v49, v49, v51
    v_add_f32 v48, v48, v49
    s_mul_i32 s6, s4, 6912
    s_lshl_b32 s7, s5, 8
    s_add_u32 s6, s6, s7
    v_readfirstlane_b32 s8, v41
    s_nop 0
    s_cmp_eq_u32 s8, 0
    s_cbranch_scc0 k2_wp_b
    buffer_store_dword v48, v6, s[68:71], s6 offen
    s_endpgm
k2_wp_b:
    buffer_store_dword v48, v6, s[72:75], s6 offen
k2_wp_end:
    s_endpgm
k2_wsf:
    s_mov_b32 s56, s38
    s_mov_b32 s57, s39
    s_mov_b32 s58, 8388608
    s_mov_b32 s59, 0x00020000
    s_sub_u32 s3, s2, 748
    s_lshl_b32 s3, s3, 16
    v_lshlrev_b32 v1, 4, v0
    buffer_load_dwordx4 v[4:7], v1, s[56:59], s3 offen
    s_add_u32 s3, s3, 4096
    buffer_load_dwordx4 v[8:11], v1, s[56:59], s3 offen
    s_add_u32 s3, s3, 4096
    buffer_load_dwordx4 v[12:15], v1, s[56:59], s3 offen
    s_add_u32 s3, s3, 4096
    buffer_load_dwordx4 v[16:19], v1, s[56:59], s3 offen
    s_add_u32 s3, s3, 4096
    buffer_load_dwordx4 v[20:23], v1, s[56:59], s3 offen
    s_add_u32 s3, s3, 4096
    buffer_load_dwordx4 v[24:27], v1, s[56:59], s3 offen
    s_add_u32 s3, s3, 4096
    buffer_load_dwordx4 v[28:31], v1, s[56:59], s3 offen
    s_add_u32 s3, s3, 4096
    buffer_load_dwordx4 v[32:35], v1, s[56:59], s3 offen
    s_add_u32 s3, s3, 4096
    buffer_load_dwordx4 v[36:39], v1, s[56:59], s3 offen
    s_add_u32 s3, s3, 4096
    buffer_load_dwordx4 v[40:43], v1, s[56:59], s3 offen
    s_add_u32 s3, s3, 4096
    buffer_load_dwordx4 v[44:47], v1, s[56:59], s3 offen
    s_add_u32 s3, s3, 4096
    buffer_load_dwordx4 v[48:51], v1, s[56:59], s3 offen
    s_add_u32 s3, s3, 4096
    buffer_load_dwordx4 v[52:55], v1, s[56:59], s3 offen
    s_add_u32 s3, s3, 4096
    buffer_load_dwordx4 v[56:59], v1, s[56:59], s3 offen
    s_add_u32 s3, s3, 4096
    buffer_load_dwordx4 v[60:63], v1, s[56:59], s3 offen
    s_add_u32 s3, s3, 4096
    buffer_load_dwordx4 v[64:67], v1, s[56:59], s3 offen
    s_add_u32 s3, s3, 4096
    s_waitcnt vmcnt(0)
    s_endpgm
k2_misc:
    s_add_u32 s56, s52, 27312128
    s_addc_u32 s57, s53, 0
    s_mov_b32 s58, 16384
    s_mov_b32 s59, 0x00020000
    s_mov_b32 s60, s52
    s_mov_b32 s61, s53
    s_mov_b32 s62, 61440
    s_mov_b32 s63, 0x00020000
    s_add_u32 s64, s52, 61440
    s_addc_u32 s65, s53, 0
    s_mov_b32 s66, 15360
    s_mov_b32 s67, 0x00020000
    s_add_u32 s68, s52, 27328512
    s_addc_u32 s69, s53, 0
    s_mov_b32 s70, 12288
    s_mov_b32 s71, 0x00020000
    s_sub_u32 s3, s2, 748
    s_lshl_b32 s4, s3, 12
    s_sub_u32 s9, s4, 16384
    v_lshlrev_b32 v1, 4, v0
    v_mov_b32 v4, 0
    v_mov_b32 v5, 0
    v_mov_b32 v6, 0
    v_mov_b32 v7, 0
    s_cmp_ge_u32 s3, 4
    s_cbranch_scc1 k2_misc_b
    buffer_store_dwordx4 v[4:7], v1, s[56:59], s4 offen
    s_branch k2_misc_a
k2_misc_b:
    s_cmp_ge_u32 s3, 7
    s_cbranch_scc1 k2_misc_a
    buffer_store_dwordx4 v[4:7], v1, s[68:71], s9 offen
k2_misc_a:
    s_cmp_ge_u32 s3, 15
    s_cbranch_scc1 k2_misc_end
    v_lshlrev_b32 v2, 2, v0
    s_lshl_b32 s5, s3, 10
    s_add_u32 s6, s5, 15360
    s_add_u32 s7, s5, 30720
    s_add_u32 s8, s5, 46080
    buffer_load_dword v8, v2, s[60:63], s5 offen
    buffer_load_dword v9, v2, s[60:63], s6 offen
    buffer_load_dword v10, v2, s[60:63], s7 offen
    buffer_load_dword v11, v2, s[60:63], s8 offen
    s_waitcnt vmcnt(0)
    v_add_f32 v8, v8, v9
    v_add_f32 v10, v10, v11
    v_add_f32 v8, v8, v10
    v_cvt_pk_bf16_f32 v8, v8, v8
    v_lshlrev_b32 v8, 16, v8
    buffer_store_dword v8, v2, s[64:67], s5 offen
k2_misc_end:
    s_endpgm
k2_code:
    s_getpc_b64 s[4:5]
k2ct_here:
    s_add_u32 s4, s4, gemm_kernel-k2ct_here
    s_addc_u32 s5, s5, 0
    v_lshlrev_b32 v1, 4, v0
    global_load_dwordx4 v[4:7], v1, s[4:5]
    s_add_u32 s4, s4, 4096
    s_addc_u32 s5, s5, 0
    global_load_dwordx4 v[8:11], v1, s[4:5]
    s_add_u32 s4, s4, 4096
    s_addc_u32 s5, s5, 0
    global_load_dwordx4 v[12:15], v1, s[4:5]
    s_add_u32 s4, s4, 4096
    s_addc_u32 s5, s5, 0
    global_load_dwordx4 v[16:19], v1, s[4:5]
    s_add_u32 s4, s4, 4096
    s_addc_u32 s5, s5, 0
    global_load_dwordx4 v[20:23], v1, s[4:5]
    s_add_u32 s4, s4, 4096
    s_addc_u32 s5, s5, 0
    global_load_dwordx4 v[24:27], v1, s[4:5]
    s_add_u32 s4, s4, 4096
    s_addc_u32 s5, s5, 0
    global_load_dwordx4 v[28:31], v1, s[4:5]
    s_add_u32 s4, s4, 4096
    s_addc_u32 s5, s5, 0
    global_load_dwordx4 v[32:35], v1, s[4:5]
    s_add_u32 s4, s4, 4096
    s_addc_u32 s5, s5, 0
    global_load_dwordx4 v[4:7], v1, s[4:5]
    s_add_u32 s4, s4, 4096
    s_addc_u32 s5, s5, 0
    s_waitcnt vmcnt(0)
    s_endpgm
k2_exit:
    s_endpgm
conv_kernel_end:
.globl gemm_kernel
.p2align 8
.type gemm_kernel,@function
gemm_kernel:
    s_cmp_ge_u32 s2, 256
    s_cbranch_scc1 kg_exit
    s_load_dwordx16 s[16:31], s[0:1], 0
    s_load_dwordx16 s[32:47], s[0:1], 64
    s_load_dwordx4 s[48:51], s[0:1], 128
    s_load_dwordx2 s[52:53], s[0:1], 144
    s_and_b32 s3, s2, 7
    s_lshr_b32 s5, s2, 3
    s_lshr_b32 s6, s3, 1
    s_and_b32 s7, s3, 1
    s_lshl_b32 s54, s6, 2
    s_and_b32 s8, s5, 3
    s_add_u32 s54, s54, s8
    s_lshl_b32 s55, s7, 3
    s_lshr_b32 s8, s5, 2
    s_add_u32 s55, s55, s8
    s_lshl_b32 s98, s6, 3
    s_and_b32 s8, s5, 7
    s_add_u32 s98, s98, s8
    s_lshl_b32 s99, s7, 2
    s_lshr_b32 s8, s5, 3
    s_add_u32 s99, s99, s8
    v_and_b32 v1, 63, v0
    v_lshrrev_b32 v15, 6, v0
    v_lshlrev_b32 v12, 4, v1
    v_and_b32 v13, 15, v1
    v_lshrrev_b32 v14, 4, v1
    v_readfirstlane_b32 s4, v15
    s_waitcnt lgkmcnt(0)
    s_add_u32 s56, s52, 11369472
    s_addc_u32 s57, s53, 0
    s_mov_b32 s58, 2704384
    s_mov_b32 s59, 0x00020000
    s_add_u32 s60, s52, 9101312
    s_addc_u32 s61, s53, 0
    s_mov_b32 s62, 2211840
    s_mov_b32 s63, 0x00020000
    s_add_u32 s64, s52, 14073856
    s_addc_u32 s65, s53, 0
    s_mov_b32 s66, 2621440
    s_mov_b32 s67, 0x00020000
    s_add_u32 s76, s52, 11313152
    s_addc_u32 s77, s53, 0
    s_mov_b32 s78, 27648
    s_mov_b32 s79, 0x00020000
    s_add_u32 s80, s52, 11341824
    s_addc_u32 s81, s53, 0
    s_mov_b32 s82, 27648
    s_mov_b32 s83, 0x00020000
    s_lshl_b32 s9, s54, 2
    s_add_u32 s9, s9, s4
    s_mul_i32 s10, s4, 3072
    s_lshl_b32 s11, s54, 8
    s_lshr_b32 s5, s55, 1
    s_mul_i32 s5, s5, 7
    s_min_u32 s5, s5, 47
    s_and_b32 s6, s55, 1
    s_lshl_b32 s7, s6, 2
    s_add_u32 s70, s5, s7
    s_mul_i32 s7, s6, 3
    s_add_u32 s71, s5, s7
    s_sub_u32 s68, 3, s6
    s_add_u32 s69, s6, 2
    s_min_u32 s12, s4, s68
    s_add_u32 s12, s12, s70
    s_add_u32 s12, s12, 54
    s_lshl_b32 s12, s12, 10
    s_min_u32 s13, s4, s69
    s_add_u32 s13, s13, s71
    s_lshl_b32 s13, s13, 10
    s_mul_i32 s15, s4, 20480
    s_add_u32 s15, s15, 65536
    s_and_b32 s3, s4, 1
    s_lshl_b32 s3, s3, 3
    v_lshlrev_b32 v16, 1, v14
    v_add_u32 v16, s3, v16
    v_xor_b32 v16, v16, v13
    v_lshlrev_b32 v16, 4, v16
    v_mul_u32_u24 v3, 4224, v14
    v_add_u32 v3, v3, v16
    s_mul_i32 s3, s4, 33792
    v_add_u32 v3, s3, v3
    v_add_u32 v4, 15872, v3
    s_add_u32 m0, s10, 0
    s_nop 0
    buffer_load_dwordx4 v12, s[60:63], s12 offen lds
    buffer_load_dwordx4 v3, s[56:59], s11 offen offset:1024 lds
    buffer_load_dwordx4 v4, s[56:59], s11 offen offset:2048 lds
    s_add_u32 s11, s11, 135168
    s_add_u32 s12, s12, 110592
    s_add_u32 m0, s10, 12288
    s_nop 0
    buffer_load_dwordx4 v12, s[60:63], s12 offen lds
    buffer_load_dwordx4 v3, s[56:59], s11 offen offset:1024 lds
    buffer_load_dwordx4 v4, s[56:59], s11 offen offset:2048 lds
    s_add_u32 s11, s11, 135168
    s_add_u32 s12, s12, 110592
    s_add_u32 m0, s10, 24576
    s_nop 0
    buffer_load_dwordx4 v12, s[60:63], s12 offen lds
    buffer_load_dwordx4 v3, s[56:59], s11 offen offset:1024 lds
    buffer_load_dwordx4 v4, s[56:59], s11 offen offset:2048 lds
    s_add_u32 s11, s11, 135168
    s_add_u32 s12, s12, 110592
    s_add_u32 m0, s10, 36864
    s_nop 0
    buffer_load_dwordx4 v12, s[60:63], s12 offen lds
    buffer_load_dwordx4 v3, s[56:59], s11 offen offset:1024 lds
    buffer_load_dwordx4 v4, s[56:59], s11 offen offset:2048 lds
    s_add_u32 s11, s11, 135168
    s_add_u32 s12, s12, 110592
    s_add_u32 m0, s10, 49152
    s_nop 0
    buffer_load_dwordx4 v12, s[60:63], s12 offen lds
    buffer_load_dwordx4 v3, s[56:59], s11 offen offset:1024 lds
    buffer_load_dwordx4 v4, s[56:59], s11 offen offset:2048 lds
    s_add_u32 s11, s11, 135168
    s_add_u32 s12, s12, 110592
    v_bfe_u32 v17, v0, 4, 2
    v_min_u32 v18, s68, v17
    v_add_u32 v18, s70, v18
    v_add_u32 v18, 54, v18
    v_min_u32 v19, s69, v17
    v_add_u32 v19, s71, v19
    v_and_b32 v17, 64, v0
    v_cmp_eq_u32 vcc, 0, v17
    s_nop 1
    v_cndmask_b32 v17, v19, v18, vcc
    v_lshrrev_b32 v18, 1, v17
    v_lshlrev_b32 v18, 5, v18
    v_and_b32 v17, 1, v17
    v_lshl_add_u32 v18, v17, 2, v18
    v_lshrrev_b32 v17, 2, v13
    v_lshl_add_u32 v18, v17, 3, v18
    v_and_b32 v17, 3, v13
    v_add_u32 v18, v18, v17
    v_lshlrev_b32 v18, 2, v18
    s_mov_b32 s14, 6912
    s_mov_b32 s7, 13824
    s_mov_b32 s3, 20736
    s_cmp_ge_u32 s4, 2
    s_cbranch_scc1 kgA_cb
    buffer_load_dword v20, v18, s[76:79], 0 offen
    buffer_load_dword v21, v18, s[76:79], s14 offen
    buffer_load_dword v22, v18, s[76:79], s7 offen
    buffer_load_dword v23, v18, s[76:79], s3 offen
    s_branch kgA_cj
kgA_cb:
    buffer_load_dword v20, v18, s[80:83], 0 offen
    buffer_load_dword v21, v18, s[80:83], s14 offen
    buffer_load_dword v22, v18, s[80:83], s7 offen
    buffer_load_dword v23, v18, s[80:83], s3 offen
kgA_cj:
    s_lshl_b32 s3, s9, 11
    v_add_u32 v5, s3, v12
    v_lshrrev_b32 v218, 1, v5
    v_bfe_u32 v16, v1, 2, 2
    v_bfe_u32 v17, v1, 1, 1
    s_lshl_b32 s3, s4, 2
    v_add_u32 v17, s3, v17
    v_and_b32 v18, 1, v14
    v_lshlrev_b32 v18, 3, v18
    v_lshl_add_u32 v18, v16, 1, v18
    v_xor_b32 v17, v17, v18
    v_lshlrev_b32 v6, 4, v17
    v_lshl_add_u32 v6, v16, 8, v6
    v_mul_u32_u24 v18, 3072, v14
    v_add_u32 v6, v6, v18
    v_and_b32 v18, 1, v1
    v_lshl_add_u32 v6, v18, 3, v6
    v_add_u32 v6, 1024, v6
    v_xor_b32 v7, 32, v6
    s_mov_b32 s72, 0xbdd2d3e8
    s_mov_b32 s73, 0xbdd2d3e8
    s_mov_b32 s74, 1.0
    s_mov_b32 s75, 1.0
    v_mov_b32 v176, 0xc0135761
    v_mov_b32 v177, 0xc0135761
    v_mov_b32 v140, 0x3f803f80
    v_mov_b32 v141, 0x3f803f80
    v_mov_b32 v142, 0x3f803f80
    v_mov_b32 v143, 0x3f803f80
    s_add_u32 s76, s52, 27312128
    s_addc_u32 s77, s53, 0
    s_mov_b32 s78, 16384
    s_mov_b32 s79, 0x00020000
    s_add_u32 s80, s52, 16695296
    s_addc_u32 s81, s53, 0
    s_mov_b32 s82, 3538944
    s_mov_b32 s83, 0x00020000
    s_add_u32 s92, s52, 20234240
    s_addc_u32 s93, s53, 0
    s_mov_b32 s94, 3538944
    s_mov_b32 s95, 0x00020000
    s_add_u32 s84, s52, 27328512
    s_addc_u32 s85, s53, 0
    s_mov_b32 s86, 12288
    s_mov_b32 s87, 0x00020000
    s_waitcnt vmcnt(16)
    s_barrier
    ds_read_b64_tr_b16 a[0:1], v6 offset:0
    ds_read_b64_tr_b16 a[2:3], v6 offset:1024
    ds_read_b64_tr_b16 a[4:5], v7 offset:0
    ds_read_b64_tr_b16 a[6:7], v7 offset:1024
    ds_read_b128 v[28:31], v12 offset:0
    ds_read_b128 v[32:35], v12 offset:3072
    ds_read_b128 v[36:39], v12 offset:6144
    ds_read_b128 v[40:43], v12 offset:9216
    s_waitcnt vmcnt(13) lgkmcnt(0)
    s_barrier
    v_mfma_f32_16x16x32_bf16 v[60:63], a[0:3], v[28:31], 0
    ds_read_b64_tr_b16 a[8:9], v6 offset:12288
    v_mfma_f32_16x16x32_bf16 v[64:67], a[0:3], v[32:35], 0
    ds_read_b64_tr_b16 a[10:11], v6 offset:13312
    v_mfma_f32_16x16x32_bf16 v[68:71], a[0:3], v[36:39], 0
    ds_read_b64_tr_b16 a[12:13], v7 offset:12288
    v_mfma_f32_16x16x32_bf16 v[72:75], a[0:3], v[40:43], 0
    ds_read_b64_tr_b16 a[14:15], v7 offset:13312
    v_mfma_f32_16x16x32_bf16 v[124:127], a[0:3], a[0:3], 0
    ds_read_b128 v[44:47], v12 offset:12288
    v_mfma_f32_16x16x32_bf16 v[132:135], a[0:3], v[140:143], 0
    ds_read_b128 v[48:51], v12 offset:15360
    v_mfma_f32_16x16x32_bf16 v[76:79], a[4:7], v[28:31], 0
    ds_read_b128 v[52:55], v12 offset:18432
    v_mfma_f32_16x16x32_bf16 v[80:83], a[4:7], v[32:35], 0
    ds_read_b128 v[56:59], v12 offset:21504
    v_mfma_f32_16x16x32_bf16 v[84:87], a[4:7], v[36:39], 0
    s_add_u32 m0, s10, 0
    s_nop 0
    buffer_load_dwordx4 v12, s[60:63], s12 offen lds
    v_mfma_f32_16x16x32_bf16 v[88:91], a[4:7], v[40:43], 0
    buffer_load_dwordx4 v3, s[56:59], s11 offen offset:1024 lds
    v_mfma_f32_16x16x32_bf16 v[128:131], a[4:7], a[4:7], 0
    buffer_load_dwordx4 v4, s[56:59], s11 offen offset:2048 lds
    s_add_u32 s11, s11, 135168
    s_add_u32 s12, s12, 110592
    v_mfma_f32_16x16x32_bf16 v[136:139], a[4:7], v[140:143], 0
    s_add_u32 m0, s15, 0
    s_nop 0
    buffer_load_dwordx4 v12, s[60:63], s13 offen lds
    s_add_u32 s13, s13, 110592
    s_waitcnt vmcnt(14) lgkmcnt(0)
    s_barrier
    v_mfma_f32_16x16x32_bf16 v[60:63], a[8:11], v[44:47], v[60:63]
    ds_read_b64_tr_b16 a[16:17], v6 offset:24576
    v_mfma_f32_16x16x32_bf16 v[64:67], a[8:11], v[48:51], v[64:67]
    ds_read_b64_tr_b16 a[18:19], v6 offset:25600
    v_mfma_f32_16x16x32_bf16 v[68:71], a[8:11], v[52:55], v[68:71]
    ds_read_b64_tr_b16 a[20:21], v7 offset:24576
    v_mfma_f32_16x16x32_bf16 v[72:75], a[8:11], v[56:59], v[72:75]
    ds_read_b64_tr_b16 a[22:23], v7 offset:25600
    v_mfma_f32_16x16x32_bf16 v[124:127], a[8:11], a[8:11], v[124:127]
    ds_read_b128 v[28:31], v12 offset:24576
    v_mfma_f32_16x16x32_bf16 v[132:135], a[8:11], v[140:143], v[132:135]
    ds_read_b128 v[32:35], v12 offset:27648
    v_mfma_f32_16x16x32_bf16 v[76:79], a[12:15], v[44:47], v[76:79]
    ds_read_b128 v[36:39], v12 offset:30720
    v_mfma_f32_16x16x32_bf16 v[80:83], a[12:15], v[48:51], v[80:83]
    ds_read_b128 v[40:43], v12 offset:33792
    v_mfma_f32_16x16x32_bf16 v[84:87], a[12:15], v[52:55], v[84:87]
    s_add_u32 m0, s10, 12288
    s_nop 0
    buffer_load_dwordx4 v12, s[60:63], s12 offen lds
    v_mfma_f32_16x16x32_bf16 v[88:91], a[12:15], v[56:59], v[88:91]
    buffer_load_dwordx4 v3, s[56:59], s11 offen offset:1024 lds
    v_mfma_f32_16x16x32_bf16 v[128:131], a[12:15], a[12:15], v[128:131]
    buffer_load_dwordx4 v4, s[56:59], s11 offen offset:2048 lds
    s_add_u32 s11, s11, 135168
    s_add_u32 s12, s12, 110592
    v_mfma_f32_16x16x32_bf16 v[136:139], a[12:15], v[140:143], v[136:139]
    s_add_u32 m0, s15, 1024
    s_nop 0
    buffer_load_dwordx4 v12, s[60:63], s13 offen lds
    s_add_u32 s13, s13, 110592
    s_waitcnt vmcnt(15) lgkmcnt(0)
    s_barrier
    v_mfma_f32_16x16x32_bf16 v[60:63], a[16:19], v[28:31], v[60:63]
    ds_read_b64_tr_b16 a[24:25], v6 offset:36864
    v_mfma_f32_16x16x32_bf16 v[64:67], a[16:19], v[32:35], v[64:67]
    ds_read_b64_tr_b16 a[26:27], v6 offset:37888
    v_mfma_f32_16x16x32_bf16 v[68:71], a[16:19], v[36:39], v[68:71]
    ds_read_b64_tr_b16 a[28:29], v7 offset:36864
    v_mfma_f32_16x16x32_bf16 v[72:75], a[16:19], v[40:43], v[72:75]
    ds_read_b64_tr_b16 a[30:31], v7 offset:37888
    v_mfma_f32_16x16x32_bf16 v[124:127], a[16:19], a[16:19], v[124:127]
    ds_read_b128 v[44:47], v12 offset:36864
    v_mfma_f32_16x16x32_bf16 v[132:135], a[16:19], v[140:143], v[132:135]
    ds_read_b128 v[48:51], v12 offset:39936
    v_mfma_f32_16x16x32_bf16 v[76:79], a[20:23], v[28:31], v[76:79]
    ds_read_b128 v[52:55], v12 offset:43008
    v_mfma_f32_16x16x32_bf16 v[80:83], a[20:23], v[32:35], v[80:83]
    ds_read_b128 v[56:59], v12 offset:46080
    v_mfma_f32_16x16x32_bf16 v[84:87], a[20:23], v[36:39], v[84:87]
    s_add_u32 m0, s10, 24576
    s_nop 0
    buffer_load_dwordx4 v12, s[60:63], s12 offen lds
    v_mfma_f32_16x16x32_bf16 v[88:91], a[20:23], v[40:43], v[88:91]
    buffer_load_dwordx4 v3, s[56:59], s11 offen offset:1024 lds
    v_mfma_f32_16x16x32_bf16 v[128:131], a[20:23], a[20:23], v[128:131]
    buffer_load_dwordx4 v4, s[56:59], s11 offen offset:2048 lds
    s_add_u32 s11, s11, 135168
    s_add_u32 s12, s12, 110592
    v_mfma_f32_16x16x32_bf16 v[136:139], a[20:23], v[140:143], v[136:139]
    s_add_u32 m0, s15, 2048
    s_nop 0
    buffer_load_dwordx4 v12, s[60:63], s13 offen lds
    s_add_u32 s13, s13, 110592
    s_waitcnt vmcnt(16) lgkmcnt(0)
    s_barrier
    v_mfma_f32_16x16x32_bf16 v[60:63], a[24:27], v[44:47], v[60:63]
    ds_read_b64_tr_b16 a[32:33], v6 offset:49152
    v_mfma_f32_16x16x32_bf16 v[64:67], a[24:27], v[48:51], v[64:67]
    ds_read_b64_tr_b16 a[34:35], v6 offset:50176
    v_mfma_f32_16x16x32_bf16 v[68:71], a[24:27], v[52:55], v[68:71]
    ds_read_b64_tr_b16 a[36:37], v7 offset:49152
    v_mfma_f32_16x16x32_bf16 v[72:75], a[24:27], v[56:59], v[72:75]
    ds_read_b64_tr_b16 a[38:39], v7 offset:50176
    v_mfma_f32_16x16x32_bf16 v[124:127], a[24:27], a[24:27], v[124:127]
    ds_read_b128 v[28:31], v12 offset:49152
    v_mfma_f32_16x16x32_bf16 v[132:135], a[24:27], v[140:143], v[132:135]
    ds_read_b128 v[32:35], v12 offset:52224
    v_mfma_f32_16x16x32_bf16 v[76:79], a[28:31], v[44:47], v[76:79]
    ds_read_b128 v[36:39], v12 offset:55296
    v_mfma_f32_16x16x32_bf16 v[80:83], a[28:31], v[48:51], v[80:83]
    ds_read_b128 v[40:43], v12 offset:58368
    v_mfma_f32_16x16x32_bf16 v[84:87], a[28:31], v[52:55], v[84:87]
    s_add_u32 m0, s10, 36864
    s_nop 0
    buffer_load_dwordx4 v12, s[60:63], s12 offen lds
    v_mfma_f32_16x16x32_bf16 v[88:91], a[28:31], v[56:59], v[88:91]
    buffer_load_dwordx4 v3, s[56:59], s11 offen offset:1024 lds
    v_mfma_f32_16x16x32_bf16 v[128:131], a[28:31], a[28:31], v[128:131]
    buffer_load_dwordx4 v4, s[56:59], s11 offen offset:2048 lds
    s_add_u32 s11, s11, 135168
    s_add_u32 s12, s12, 110592
    v_mfma_f32_16x16x32_bf16 v[136:139], a[28:31], v[140:143], v[136:139]
    s_add_u32 m0, s15, 3072
    s_nop 0
    buffer_load_dwordx4 v12, s[60:63], s13 offen lds
    s_add_u32 s13, s13, 110592
    s_waitcnt vmcnt(13) lgkmcnt(0)
    s_barrier
    v_mfma_f32_16x16x32_bf16 v[60:63], a[32:35], v[28:31], v[60:63]
    ds_read_b64_tr_b16 a[40:41], v6 offset:0
    v_mfma_f32_16x16x32_bf16 v[64:67], a[32:35], v[32:35], v[64:67]
    ds_read_b64_tr_b16 a[42:43], v6 offset:1024
    v_mfma_f32_16x16x32_bf16 v[68:71], a[32:35], v[36:39], v[68:71]
    ds_read_b64_tr_b16 a[44:45], v7 offset:0
    v_mfma_f32_16x16x32_bf16 v[72:75], a[32:35], v[40:43], v[72:75]
    ds_read_b64_tr_b16 a[46:47], v7 offset:1024
    v_mfma_f32_16x16x32_bf16 v[124:127], a[32:35], a[32:35], v[124:127]
    ds_read_b128 v[44:47], v12 offset:0
    v_mfma_f32_16x16x32_bf16 v[132:135], a[32:35], v[140:143], v[132:135]
    ds_read_b128 v[48:51], v12 offset:3072
    v_mfma_f32_16x16x32_bf16 v[76:79], a[36:39], v[28:31], v[76:79]
    ds_read_b128 v[52:55], v12 offset:6144
    v_mfma_f32_16x16x32_bf16 v[80:83], a[36:39], v[32:35], v[80:83]
    ds_read_b128 v[56:59], v12 offset:9216
    v_mfma_f32_16x16x32_bf16 v[84:87], a[36:39], v[36:39], v[84:87]
    s_add_u32 m0, s10, 49152
    s_nop 0
    buffer_load_dwordx4 v12, s[60:63], s12 offen lds
    v_mfma_f32_16x16x32_bf16 v[88:91], a[36:39], v[40:43], v[88:91]
    buffer_load_dwordx4 v3, s[56:59], s11 offen offset:1024 lds
    v_mfma_f32_16x16x32_bf16 v[128:131], a[36:39], a[36:39], v[128:131]
    buffer_load_dwordx4 v4, s[56:59], s11 offen offset:2048 lds
    s_add_u32 s11, s11, 135168
    s_add_u32 s12, s12, 110592
    v_mfma_f32_16x16x32_bf16 v[136:139], a[36:39], v[140:143], v[136:139]
    s_add_u32 m0, s15, 4096
    s_nop 0
    buffer_load_dwordx4 v12, s[60:63], s13 offen lds
    s_add_u32 s13, s13, 110592
    s_waitcnt vmcnt(13) lgkmcnt(0)
    s_barrier
    v_mfma_f32_16x16x32_bf16 v[60:63], a[40:43], v[44:47], v[60:63]
    ds_read_b64_tr_b16 a[48:49], v6 offset:12288
    v_mfma_f32_16x16x32_bf16 v[64:67], a[40:43], v[48:51], v[64:67]
    ds_read_b64_tr_b16 a[50:51], v6 offset:13312
    v_mfma_f32_16x16x32_bf16 v[68:71], a[40:43], v[52:55], v[68:71]
    ds_read_b64_tr_b16 a[52:53], v7 offset:12288
    v_mfma_f32_16x16x32_bf16 v[72:75], a[40:43], v[56:59], v[72:75]
    ds_read_b64_tr_b16 a[54:55], v7 offset:13312
    v_mfma_f32_16x16x32_bf16 v[124:127], a[40:43], a[40:43], v[124:127]
    ds_read_b128 v[28:31], v12 offset:12288
    v_mfma_f32_16x16x32_bf16 v[132:135], a[40:43], v[140:143], v[132:135]
    ds_read_b128 v[32:35], v12 offset:15360
    v_mfma_f32_16x16x32_bf16 v[76:79], a[44:47], v[44:47], v[76:79]
    ds_read_b128 v[36:39], v12 offset:18432
    v_mfma_f32_16x16x32_bf16 v[80:83], a[44:47], v[48:51], v[80:83]
    ds_read_b128 v[40:43], v12 offset:21504
    v_mfma_f32_16x16x32_bf16 v[84:87], a[44:47], v[52:55], v[84:87]
    s_add_u32 m0, s10, 0
    s_nop 0
    buffer_load_dwordx4 v12, s[60:63], s12 offen lds
    v_mfma_f32_16x16x32_bf16 v[88:91], a[44:47], v[56:59], v[88:91]
    buffer_load_dwordx4 v3, s[56:59], s11 offen offset:1024 lds
    v_mfma_f32_16x16x32_bf16 v[128:131], a[44:47], a[44:47], v[128:131]
    buffer_load_dwordx4 v4, s[56:59], s11 offen offset:2048 lds
    s_add_u32 s11, s11, 135168
    s_add_u32 s12, s12, 110592
    v_mfma_f32_16x16x32_bf16 v[136:139], a[44:47], v[140:143], v[136:139]
    s_add_u32 m0, s15, 5120
    s_nop 0
    buffer_load_dwordx4 v12, s[60:63], s13 offen lds
    s_add_u32 s13, s13, 110592
    s_waitcnt vmcnt(13) lgkmcnt(0)
    s_barrier
    v_mfma_f32_16x16x32_bf16 v[60:63], a[48:51], v[28:31], v[60:63]
    ds_read_b64_tr_b16 a[56:57], v6 offset:24576
    v_mfma_f32_16x16x32_bf16 v[64:67], a[48:51], v[32:35], v[64:67]
    ds_read_b64_tr_b16 a[58:59], v6 offset:25600
    v_mfma_f32_16x16x32_bf16 v[68:71], a[48:51], v[36:39], v[68:71]
    ds_read_b64_tr_b16 a[60:61], v7 offset:24576
    v_mfma_f32_16x16x32_bf16 v[72:75], a[48:51], v[40:43], v[72:75]
    ds_read_b64_tr_b16 a[62:63], v7 offset:25600
    v_mfma_f32_16x16x32_bf16 v[124:127], a[48:51], a[48:51], v[124:127]
    ds_read_b128 v[44:47], v12 offset:24576
    v_mfma_f32_16x16x32_bf16 v[132:135], a[48:51], v[140:143], v[132:135]
    ds_read_b128 v[48:51], v12 offset:27648
    v_mfma_f32_16x16x32_bf16 v[76:79], a[52:55], v[28:31], v[76:79]
    ds_read_b128 v[52:55], v12 offset:30720
    v_mfma_f32_16x16x32_bf16 v[80:83], a[52:55], v[32:35], v[80:83]
    ds_read_b128 v[56:59], v12 offset:33792
    v_mfma_f32_16x16x32_bf16 v[84:87], a[52:55], v[36:39], v[84:87]
    s_add_u32 m0, s10, 12288
    s_nop 0
    buffer_load_dwordx4 v12, s[60:63], s12 offen lds
    v_mfma_f32_16x16x32_bf16 v[88:91], a[52:55], v[40:43], v[88:91]
    buffer_load_dwordx4 v3, s[56:59], s11 offen offset:1024 lds
    v_mfma_f32_16x16x32_bf16 v[128:131], a[52:55], a[52:55], v[128:131]
    buffer_load_dwordx4 v4, s[56:59], s11 offen offset:2048 lds
    s_add_u32 s11, s11, 135168
    s_add_u32 s12, s12, 110592
    v_mfma_f32_16x16x32_bf16 v[136:139], a[52:55], v[140:143], v[136:139]
    s_add_u32 m0, s15, 6144
    s_nop 0
    buffer_load_dwordx4 v12, s[60:63], s13 offen lds
    s_add_u32 s13, s13, 110592
    v_add_f32 v20, v20, v21
    v_add_f32 v22, v22, v23
    v_add_f32 v20, v20, v22
    v_lshlrev_b32 v16, 2, v0
    v_add_u32 v16, 147456, v16
    ds_write_b32 v16, v20
    s_waitcnt vmcnt(13) lgkmcnt(0)
    s_barrier
    v_mfma_f32_16x16x32_bf16 v[60:63], a[56:59], v[44:47], v[60:63]
    ds_read_b64_tr_b16 a[64:65], v6 offset:36864
    v_mfma_f32_16x16x32_bf16 v[64:67], a[56:59], v[48:51], v[64:67]
    ds_read_b64_tr_b16 a[66:67], v6 offset:37888
    v_mfma_f32_16x16x32_bf16 v[68:71], a[56:59], v[52:55], v[68:71]
    ds_read_b64_tr_b16 a[68:69], v7 offset:36864
    v_mfma_f32_16x16x32_bf16 v[72:75], a[56:59], v[56:59], v[72:75]
    ds_read_b64_tr_b16 a[70:71], v7 offset:37888
    v_mfma_f32_16x16x32_bf16 v[124:127], a[56:59], a[56:59], v[124:127]
    ds_read_b128 v[28:31], v12 offset:36864
    v_mfma_f32_16x16x32_bf16 v[132:135], a[56:59], v[140:143], v[132:135]
    ds_read_b128 v[32:35], v12 offset:39936
    v_mfma_f32_16x16x32_bf16 v[76:79], a[60:63], v[44:47], v[76:79]
    ds_read_b128 v[36:39], v12 offset:43008
    v_mfma_f32_16x16x32_bf16 v[80:83], a[60:63], v[48:51], v[80:83]
    ds_read_b128 v[40:43], v12 offset:46080
    v_mfma_f32_16x16x32_bf16 v[84:87], a[60:63], v[52:55], v[84:87]
    s_add_u32 m0, s10, 24576
    s_nop 0
    buffer_load_dwordx4 v12, s[60:63], s12 offen lds
    v_mfma_f32_16x16x32_bf16 v[88:91], a[60:63], v[56:59], v[88:91]
    buffer_load_dwordx4 v3, s[56:59], s11 offen offset:1024 lds
    v_mfma_f32_16x16x32_bf16 v[128:131], a[60:63], a[60:63], v[128:131]
    buffer_load_dwordx4 v4, s[56:59], s11 offen offset:2048 lds
    s_add_u32 s11, s11, 135168
    s_add_u32 s12, s12, 110592
    v_mfma_f32_16x16x32_bf16 v[136:139], a[60:63], v[140:143], v[136:139]
    s_add_u32 m0, s15, 7168
    s_nop 0
    buffer_load_dwordx4 v12, s[60:63], s13 offen lds
    s_add_u32 s13, s13, 110592
    s_waitcnt vmcnt(13) lgkmcnt(0)
    s_barrier
    v_mfma_f32_16x16x32_bf16 v[60:63], a[64:67], v[28:31], v[60:63]
    ds_read_b64_tr_b16 a[72:73], v6 offset:49152
    v_mfma_f32_16x16x32_bf16 v[64:67], a[64:67], v[32:35], v[64:67]
    ds_read_b64_tr_b16 a[74:75], v6 offset:50176
    v_mfma_f32_16x16x32_bf16 v[68:71], a[64:67], v[36:39], v[68:71]
    ds_read_b64_tr_b16 a[76:77], v7 offset:49152
    v_mfma_f32_16x16x32_bf16 v[72:75], a[64:67], v[40:43], v[72:75]
    ds_read_b64_tr_b16 a[78:79], v7 offset:50176
    v_mfma_f32_16x16x32_bf16 v[124:127], a[64:67], a[64:67], v[124:127]
    ds_read_b128 v[44:47], v12 offset:49152
    v_mfma_f32_16x16x32_bf16 v[132:135], a[64:67], v[140:143], v[132:135]
    ds_read_b128 v[48:51], v12 offset:52224
    v_mfma_f32_16x16x32_bf16 v[76:79], a[68:71], v[28:31], v[76:79]
    ds_read_b128 v[52:55], v12 offset:55296
    v_mfma_f32_16x16x32_bf16 v[80:83], a[68:71], v[32:35], v[80:83]
    ds_read_b128 v[56:59], v12 offset:58368
    v_mfma_f32_16x16x32_bf16 v[84:87], a[68:71], v[36:39], v[84:87]
    s_add_u32 m0, s10, 36864
    s_nop 0
    buffer_load_dwordx4 v12, s[60:63], s12 offen lds
    v_mfma_f32_16x16x32_bf16 v[88:91], a[68:71], v[40:43], v[88:91]
    buffer_load_dwordx4 v3, s[56:59], s11 offen offset:1024 lds
    v_mfma_f32_16x16x32_bf16 v[128:131], a[68:71], a[68:71], v[128:131]
    buffer_load_dwordx4 v4, s[56:59], s11 offen offset:2048 lds
    s_add_u32 s11, s11, 135168
    s_add_u32 s12, s12, 110592
    v_mfma_f32_16x16x32_bf16 v[136:139], a[68:71], v[140:143], v[136:139]
    s_add_u32 m0, s15, 8192
    s_nop 0
    buffer_load_dwordx4 v12, s[60:63], s13 offen lds
    s_add_u32 s13, s13, 110592
    s_waitcnt vmcnt(13) lgkmcnt(0)
    s_barrier
    v_mfma_f32_16x16x32_bf16 v[60:63], a[72:75], v[44:47], v[60:63]
    ds_read_b64_tr_b16 a[80:81], v6 offset:0
    v_mfma_f32_16x16x32_bf16 v[64:67], a[72:75], v[48:51], v[64:67]
    ds_read_b64_tr_b16 a[82:83], v6 offset:1024
    v_mfma_f32_16x16x32_bf16 v[68:71], a[72:75], v[52:55], v[68:71]
    ds_read_b64_tr_b16 a[84:85], v7 offset:0
    v_mfma_f32_16x16x32_bf16 v[72:75], a[72:75], v[56:59], v[72:75]
    ds_read_b64_tr_b16 a[86:87], v7 offset:1024
    v_mfma_f32_16x16x32_bf16 v[124:127], a[72:75], a[72:75], v[124:127]
    ds_read_b128 v[28:31], v12 offset:0
    v_mfma_f32_16x16x32_bf16 v[132:135], a[72:75], v[140:143], v[132:135]
    ds_read_b128 v[32:35], v12 offset:3072
    v_mfma_f32_16x16x32_bf16 v[76:79], a[76:79], v[44:47], v[76:79]
    ds_read_b128 v[36:39], v12 offset:6144
    v_mfma_f32_16x16x32_bf16 v[80:83], a[76:79], v[48:51], v[80:83]
    ds_read_b128 v[40:43], v12 offset:9216
    v_mfma_f32_16x16x32_bf16 v[84:87], a[76:79], v[52:55], v[84:87]
    s_add_u32 m0, s10, 49152
    s_nop 0
    buffer_load_dwordx4 v12, s[60:63], s12 offen lds
    v_mfma_f32_16x16x32_bf16 v[88:91], a[76:79], v[56:59], v[88:91]
    buffer_load_dwordx4 v3, s[56:59], s11 offen offset:1024 lds
    v_mfma_f32_16x16x32_bf16 v[128:131], a[76:79], a[76:79], v[128:131]
    buffer_load_dwordx4 v4, s[56:59], s11 offen offset:2048 lds
    s_add_u32 s11, s11, 135168
    s_add_u32 s12, s12, 110592
    v_mfma_f32_16x16x32_bf16 v[136:139], a[76:79], v[140:143], v[136:139]
    s_add_u32 m0, s15, 9216
    s_nop 0
    buffer_load_dwordx4 v12, s[60:63], s13 offen lds
    s_add_u32 s13, s13, 110592
    s_waitcnt vmcnt(13) lgkmcnt(0)
    s_barrier
    v_mfma_f32_16x16x32_bf16 v[60:63], a[80:83], v[28:31], v[60:63]
    ds_read_b64_tr_b16 a[88:89], v6 offset:12288
    v_mfma_f32_16x16x32_bf16 v[64:67], a[80:83], v[32:35], v[64:67]
    ds_read_b64_tr_b16 a[90:91], v6 offset:13312
    v_mfma_f32_16x16x32_bf16 v[68:71], a[80:83], v[36:39], v[68:71]
    ds_read_b64_tr_b16 a[92:93], v7 offset:12288
    v_mfma_f32_16x16x32_bf16 v[72:75], a[80:83], v[40:43], v[72:75]
    ds_read_b64_tr_b16 a[94:95], v7 offset:13312
    v_mfma_f32_16x16x32_bf16 v[124:127], a[80:83], a[80:83], v[124:127]
    ds_read_b128 v[44:47], v12 offset:12288
    v_mfma_f32_16x16x32_bf16 v[132:135], a[80:83], v[140:143], v[132:135]
    ds_read_b128 v[48:51], v12 offset:15360
    v_mfma_f32_16x16x32_bf16 v[76:79], a[84:87], v[28:31], v[76:79]
    ds_read_b128 v[52:55], v12 offset:18432
    v_mfma_f32_16x16x32_bf16 v[80:83], a[84:87], v[32:35], v[80:83]
    ds_read_b128 v[56:59], v12 offset:21504
    v_mfma_f32_16x16x32_bf16 v[84:87], a[84:87], v[36:39], v[84:87]
    s_add_u32 m0, s10, 0
    s_nop 0
    buffer_load_dwordx4 v12, s[60:63], s12 offen lds
    v_mfma_f32_16x16x32_bf16 v[88:91], a[84:87], v[40:43], v[88:91]
    buffer_load_dwordx4 v3, s[56:59], s11 offen offset:1024 lds
    v_mfma_f32_16x16x32_bf16 v[128:131], a[84:87], a[84:87], v[128:131]
    buffer_load_dwordx4 v4, s[56:59], s11 offen offset:2048 lds
    s_add_u32 s11, s11, 135168
    s_add_u32 s12, s12, 110592
    v_mfma_f32_16x16x32_bf16 v[136:139], a[84:87], v[140:143], v[136:139]
    s_add_u32 m0, s15, 10240
    s_nop 0
    buffer_load_dwordx4 v12, s[60:63], s13 offen lds
    s_add_u32 s13, s13, 110592
    s_waitcnt vmcnt(13) lgkmcnt(0)
    s_barrier
    v_mfma_f32_16x16x32_bf16 v[60:63], a[88:91], v[44:47], v[60:63]
    ds_read_b64_tr_b16 a[96:97], v6 offset:24576
    v_mfma_f32_16x16x32_bf16 v[64:67], a[88:91], v[48:51], v[64:67]
    ds_read_b64_tr_b16 a[98:99], v6 offset:25600
    v_mfma_f32_16x16x32_bf16 v[68:71], a[88:91], v[52:55], v[68:71]
    ds_read_b64_tr_b16 a[100:101], v7 offset:24576
    v_mfma_f32_16x16x32_bf16 v[72:75], a[88:91], v[56:59], v[72:75]
    ds_read_b64_tr_b16 a[102:103], v7 offset:25600
    v_mfma_f32_16x16x32_bf16 v[124:127], a[88:91], a[88:91], v[124:127]
    ds_read_b128 v[28:31], v12 offset:24576
    v_mfma_f32_16x16x32_bf16 v[132:135], a[88:91], v[140:143], v[132:135]
    ds_read_b128 v[32:35], v12 offset:27648
    v_mfma_f32_16x16x32_bf16 v[76:79], a[92:95], v[44:47], v[76:79]
    ds_read_b128 v[36:39], v12 offset:30720
    v_mfma_f32_16x16x32_bf16 v[80:83], a[92:95], v[48:51], v[80:83]
    ds_read_b128 v[40:43], v12 offset:33792
    v_mfma_f32_16x16x32_bf16 v[84:87], a[92:95], v[52:55], v[84:87]
    s_add_u32 m0, s10, 12288
    s_nop 0
    buffer_load_dwordx4 v12, s[60:63], s12 offen lds
    v_mfma_f32_16x16x32_bf16 v[88:91], a[92:95], v[56:59], v[88:91]
    buffer_load_dwordx4 v3, s[56:59], s11 offen offset:1024 lds
    v_mfma_f32_16x16x32_bf16 v[128:131], a[92:95], a[92:95], v[128:131]
    buffer_load_dwordx4 v4, s[56:59], s11 offen offset:2048 lds
    s_add_u32 s11, s11, 135168
    s_add_u32 s12, s12, 110592
    v_mfma_f32_16x16x32_bf16 v[136:139], a[92:95], v[140:143], v[136:139]
    s_add_u32 m0, s15, 11264
    s_nop 0
    buffer_load_dwordx4 v12, s[60:63], s13 offen lds
    s_add_u32 s13, s13, 110592
    s_waitcnt vmcnt(13) lgkmcnt(0)
    s_barrier
    v_mfma_f32_16x16x32_bf16 v[60:63], a[96:99], v[28:31], v[60:63]
    ds_read_b64_tr_b16 a[104:105], v6 offset:36864
    v_mfma_f32_16x16x32_bf16 v[64:67], a[96:99], v[32:35], v[64:67]
    ds_read_b64_tr_b16 a[106:107], v6 offset:37888
    v_mfma_f32_16x16x32_bf16 v[68:71], a[96:99], v[36:39], v[68:71]
    ds_read_b64_tr_b16 a[108:109], v7 offset:36864
    v_mfma_f32_16x16x32_bf16 v[72:75], a[96:99], v[40:43], v[72:75]
    ds_read_b64_tr_b16 a[110:111], v7 offset:37888
    v_mfma_f32_16x16x32_bf16 v[124:127], a[96:99], a[96:99], v[124:127]
    ds_read_b128 v[44:47], v12 offset:36864
    v_mfma_f32_16x16x32_bf16 v[132:135], a[96:99], v[140:143], v[132:135]
    ds_read_b128 v[48:51], v12 offset:39936
    v_mfma_f32_16x16x32_bf16 v[76:79], a[100:103], v[28:31], v[76:79]
    ds_read_b128 v[52:55], v12 offset:43008
    v_mfma_f32_16x16x32_bf16 v[80:83], a[100:103], v[32:35], v[80:83]
    ds_read_b128 v[56:59], v12 offset:46080
    v_mfma_f32_16x16x32_bf16 v[84:87], a[100:103], v[36:39], v[84:87]
    s_add_u32 m0, s10, 24576
    s_nop 0
    buffer_load_dwordx4 v12, s[60:63], s12 offen lds
    v_mfma_f32_16x16x32_bf16 v[88:91], a[100:103], v[40:43], v[88:91]
    buffer_load_dwordx4 v3, s[56:59], s11 offen offset:1024 lds
    v_mfma_f32_16x16x32_bf16 v[128:131], a[100:103], a[100:103], v[128:131]
    buffer_load_dwordx4 v4, s[56:59], s11 offen offset:2048 lds
    s_add_u32 s11, s11, 135168
    s_add_u32 s12, s12, 110592
    v_mfma_f32_16x16x32_bf16 v[136:139], a[100:103], v[140:143], v[136:139]
    s_add_u32 m0, s15, 12288
    s_nop 0
    buffer_load_dwordx4 v12, s[60:63], s13 offen lds
    s_add_u32 s13, s13, 110592
    s_waitcnt vmcnt(13) lgkmcnt(0)
    s_barrier
    v_mfma_f32_16x16x32_bf16 v[60:63], a[104:107], v[44:47], v[60:63]
    ds_read_b64_tr_b16 a[112:113], v6 offset:49152
    v_mfma_f32_16x16x32_bf16 v[64:67], a[104:107], v[48:51], v[64:67]
    ds_read_b64_tr_b16 a[114:115], v6 offset:50176
    v_mfma_f32_16x16x32_bf16 v[68:71], a[104:107], v[52:55], v[68:71]
    ds_read_b64_tr_b16 a[116:117], v7 offset:49152
    v_mfma_f32_16x16x32_bf16 v[72:75], a[104:107], v[56:59], v[72:75]
    ds_read_b64_tr_b16 a[118:119], v7 offset:50176
    v_mfma_f32_16x16x32_bf16 v[124:127], a[104:107], a[104:107], v[124:127]
    ds_read_b128 v[28:31], v12 offset:49152
    v_mfma_f32_16x16x32_bf16 v[132:135], a[104:107], v[140:143], v[132:135]
    ds_read_b128 v[32:35], v12 offset:52224
    v_mfma_f32_16x16x32_bf16 v[76:79], a[108:111], v[44:47], v[76:79]
    ds_read_b128 v[36:39], v12 offset:55296
    v_mfma_f32_16x16x32_bf16 v[80:83], a[108:111], v[48:51], v[80:83]
    ds_read_b128 v[40:43], v12 offset:58368
    v_mfma_f32_16x16x32_bf16 v[84:87], a[108:111], v[52:55], v[84:87]
    s_add_u32 m0, s10, 36864
    s_nop 0
    buffer_load_dwordx4 v12, s[60:63], s12 offen lds
    v_mfma_f32_16x16x32_bf16 v[88:91], a[108:111], v[56:59], v[88:91]
    buffer_load_dwordx4 v3, s[56:59], s11 offen offset:1024 lds
    v_mfma_f32_16x16x32_bf16 v[128:131], a[108:111], a[108:111], v[128:131]
    buffer_load_dwordx4 v4, s[56:59], s11 offen offset:2048 lds
    s_add_u32 s11, s11, 135168
    s_add_u32 s12, s12, 110592
    v_mfma_f32_16x16x32_bf16 v[136:139], a[108:111], v[140:143], v[136:139]
    s_add_u32 m0, s15, 13312
    s_nop 0
    buffer_load_dwordx4 v12, s[60:63], s13 offen lds
    s_add_u32 s13, s13, 110592
    s_waitcnt vmcnt(13) lgkmcnt(0)
    s_barrier
    v_mfma_f32_16x16x32_bf16 v[60:63], a[112:115], v[28:31], v[60:63]
    ds_read_b64_tr_b16 a[120:121], v6 offset:0
    v_mfma_f32_16x16x32_bf16 v[64:67], a[112:115], v[32:35], v[64:67]
    ds_read_b64_tr_b16 a[122:123], v6 offset:1024
    v_mfma_f32_16x16x32_bf16 v[68:71], a[112:115], v[36:39], v[68:71]
    ds_read_b64_tr_b16 a[124:125], v7 offset:0
    v_mfma_f32_16x16x32_bf16 v[72:75], a[112:115], v[40:43], v[72:75]
    ds_read_b64_tr_b16 a[126:127], v7 offset:1024
    v_mfma_f32_16x16x32_bf16 v[124:127], a[112:115], a[112:115], v[124:127]
    ds_read_b128 v[44:47], v12 offset:0
    v_mfma_f32_16x16x32_bf16 v[132:135], a[112:115], v[140:143], v[132:135]
    ds_read_b128 v[48:51], v12 offset:3072
    v_mfma_f32_16x16x32_bf16 v[76:79], a[116:119], v[28:31], v[76:79]
    ds_read_b128 v[52:55], v12 offset:6144
    v_mfma_f32_16x16x32_bf16 v[80:83], a[116:119], v[32:35], v[80:83]
    ds_read_b128 v[56:59], v12 offset:9216
    v_mfma_f32_16x16x32_bf16 v[84:87], a[116:119], v[36:39], v[84:87]
    s_add_u32 m0, s10, 49152
    s_nop 0
    buffer_load_dwordx4 v12, s[60:63], s12 offen lds
    v_mfma_f32_16x16x32_bf16 v[88:91], a[116:119], v[40:43], v[88:91]
    buffer_load_dwordx4 v3, s[56:59], s11 offen offset:1024 lds
    v_mfma_f32_16x16x32_bf16 v[128:131], a[116:119], a[116:119], v[128:131]
    buffer_load_dwordx4 v4, s[56:59], s11 offen offset:2048 lds
    s_add_u32 s11, s11, 135168
    s_add_u32 s12, s12, 110592
    v_mfma_f32_16x16x32_bf16 v[136:139], a[116:119], v[140:143], v[136:139]
    s_add_u32 m0, s15, 14336
    s_nop 0
    buffer_load_dwordx4 v12, s[60:63], s13 offen lds
    s_add_u32 s13, s13, 110592
    s_waitcnt vmcnt(13) lgkmcnt(0)
    s_barrier
    v_mfma_f32_16x16x32_bf16 v[60:63], a[120:123], v[44:47], v[60:63]
    ds_read_b64_tr_b16 a[128:129], v6 offset:12288
    v_mfma_f32_16x16x32_bf16 v[64:67], a[120:123], v[48:51], v[64:67]
    ds_read_b64_tr_b16 a[130:131], v6 offset:13312
    v_mfma_f32_16x16x32_bf16 v[68:71], a[120:123], v[52:55], v[68:71]
    ds_read_b64_tr_b16 a[132:133], v7 offset:12288
    v_mfma_f32_16x16x32_bf16 v[72:75], a[120:123], v[56:59], v[72:75]
    ds_read_b64_tr_b16 a[134:135], v7 offset:13312
    v_mfma_f32_16x16x32_bf16 v[124:127], a[120:123], a[120:123], v[124:127]
    ds_read_b128 v[28:31], v12 offset:12288
    v_mfma_f32_16x16x32_bf16 v[132:135], a[120:123], v[140:143], v[132:135]
    ds_read_b128 v[32:35], v12 offset:15360
    v_mfma_f32_16x16x32_bf16 v[76:79], a[124:127], v[44:47], v[76:79]
    ds_read_b128 v[36:39], v12 offset:18432
    v_mfma_f32_16x16x32_bf16 v[80:83], a[124:127], v[48:51], v[80:83]
    ds_read_b128 v[40:43], v12 offset:21504
    v_mfma_f32_16x16x32_bf16 v[84:87], a[124:127], v[52:55], v[84:87]
    s_add_u32 m0, s15, 15360
    s_nop 0
    buffer_load_dwordx4 v12, s[60:63], s13 offen lds
    s_add_u32 s13, s13, 110592
    v_mfma_f32_16x16x32_bf16 v[88:91], a[124:127], v[56:59], v[88:91]
    v_mfma_f32_16x16x32_bf16 v[128:131], a[124:127], a[124:127], v[128:131]
    v_mfma_f32_16x16x32_bf16 v[136:139], a[124:127], v[140:143], v[136:139]
    s_waitcnt vmcnt(10) lgkmcnt(0)
    s_barrier
    v_mfma_f32_16x16x32_bf16 v[60:63], a[128:131], v[28:31], v[60:63]
    ds_read_b64_tr_b16 a[136:137], v6 offset:24576
    v_mfma_f32_16x16x32_bf16 v[64:67], a[128:131], v[32:35], v[64:67]
    ds_read_b64_tr_b16 a[138:139], v6 offset:25600
    v_mfma_f32_16x16x32_bf16 v[68:71], a[128:131], v[36:39], v[68:71]
    ds_read_b64_tr_b16 a[140:141], v7 offset:24576
    v_mfma_f32_16x16x32_bf16 v[72:75], a[128:131], v[40:43], v[72:75]
    ds_read_b64_tr_b16 a[142:143], v7 offset:25600
    v_mfma_f32_16x16x32_bf16 v[124:127], a[128:131], a[128:131], v[124:127]
    ds_read_b128 v[44:47], v12 offset:24576
    v_mfma_f32_16x16x32_bf16 v[132:135], a[128:131], v[140:143], v[132:135]
    ds_read_b128 v[48:51], v12 offset:27648
    v_mfma_f32_16x16x32_bf16 v[76:79], a[132:135], v[28:31], v[76:79]
    ds_read_b128 v[52:55], v12 offset:30720
    v_mfma_f32_16x16x32_bf16 v[80:83], a[132:135], v[32:35], v[80:83]
    ds_read_b128 v[56:59], v12 offset:33792
    v_mfma_f32_16x16x32_bf16 v[84:87], a[132:135], v[36:39], v[84:87]
    s_add_u32 m0, s15, 16384
    s_nop 0
    buffer_load_dwordx4 v12, s[60:63], s13 offen lds
    s_add_u32 s13, s13, 110592
    v_mfma_f32_16x16x32_bf16 v[88:91], a[132:135], v[40:43], v[88:91]
    v_mfma_f32_16x16x32_bf16 v[128:131], a[132:135], a[132:135], v[128:131]
    v_mfma_f32_16x16x32_bf16 v[136:139], a[132:135], v[140:143], v[136:139]
    s_waitcnt vmcnt(7) lgkmcnt(0)
    s_barrier
    v_mfma_f32_16x16x32_bf16 v[60:63], a[136:139], v[44:47], v[60:63]
    ds_read_b64_tr_b16 a[144:145], v6 offset:36864
    v_mfma_f32_16x16x32_bf16 v[64:67], a[136:139], v[48:51], v[64:67]
    ds_read_b64_tr_b16 a[146:147], v6 offset:37888
    v_mfma_f32_16x16x32_bf16 v[68:71], a[136:139], v[52:55], v[68:71]
    ds_read_b64_tr_b16 a[148:149], v7 offset:36864
    v_mfma_f32_16x16x32_bf16 v[72:75], a[136:139], v[56:59], v[72:75]
    ds_read_b64_tr_b16 a[150:151], v7 offset:37888
    v_mfma_f32_16x16x32_bf16 v[124:127], a[136:139], a[136:139], v[124:127]
    ds_read_b128 v[28:31], v12 offset:36864
    v_mfma_f32_16x16x32_bf16 v[132:135], a[136:139], v[140:143], v[132:135]
    ds_read_b128 v[32:35], v12 offset:39936
    v_mfma_f32_16x16x32_bf16 v[76:79], a[140:143], v[44:47], v[76:79]
    ds_read_b128 v[36:39], v12 offset:43008
    v_mfma_f32_16x16x32_bf16 v[80:83], a[140:143], v[48:51], v[80:83]
    ds_read_b128 v[40:43], v12 offset:46080
    v_mfma_f32_16x16x32_bf16 v[84:87], a[140:143], v[52:55], v[84:87]
    s_add_u32 m0, s15, 17408
    s_nop 0
    buffer_load_dwordx4 v12, s[60:63], s13 offen lds
    s_add_u32 s13, s13, 110592
    v_mfma_f32_16x16x32_bf16 v[88:91], a[140:143], v[56:59], v[88:91]
    v_mfma_f32_16x16x32_bf16 v[128:131], a[140:143], a[140:143], v[128:131]
    v_mfma_f32_16x16x32_bf16 v[136:139], a[140:143], v[140:143], v[136:139]
    s_waitcnt vmcnt(4) lgkmcnt(0)
    s_barrier
    v_mfma_f32_16x16x32_bf16 v[60:63], a[144:147], v[28:31], v[60:63]
    ds_read_b64_tr_b16 a[152:153], v6 offset:49152
    v_mfma_f32_16x16x32_bf16 v[64:67], a[144:147], v[32:35], v[64:67]
    ds_read_b64_tr_b16 a[154:155], v6 offset:50176
    v_mfma_f32_16x16x32_bf16 v[68:71], a[144:147], v[36:39], v[68:71]
    ds_read_b64_tr_b16 a[156:157], v7 offset:49152
    v_mfma_f32_16x16x32_bf16 v[72:75], a[144:147], v[40:43], v[72:75]
    ds_read_b64_tr_b16 a[158:159], v7 offset:50176
    v_mfma_f32_16x16x32_bf16 v[124:127], a[144:147], a[144:147], v[124:127]
    ds_read_b128 v[44:47], v12 offset:49152
    v_mfma_f32_16x16x32_bf16 v[132:135], a[144:147], v[140:143], v[132:135]
    ds_read_b128 v[48:51], v12 offset:52224
    v_mfma_f32_16x16x32_bf16 v[76:79], a[148:151], v[28:31], v[76:79]
    ds_read_b128 v[52:55], v12 offset:55296
    v_mfma_f32_16x16x32_bf16 v[80:83], a[148:151], v[32:35], v[80:83]
    ds_read_b128 v[56:59], v12 offset:58368
    v_mfma_f32_16x16x32_bf16 v[84:87], a[148:151], v[36:39], v[84:87]
    s_add_u32 m0, s15, 18432
    s_nop 0
    buffer_load_dwordx4 v12, s[60:63], s13 offen lds
    s_add_u32 s13, s13, 110592
    v_mfma_f32_16x16x32_bf16 v[88:91], a[148:151], v[40:43], v[88:91]
    v_mfma_f32_16x16x32_bf16 v[128:131], a[148:151], a[148:151], v[128:131]
    v_mfma_f32_16x16x32_bf16 v[136:139], a[148:151], v[140:143], v[136:139]
    s_waitcnt lgkmcnt(0)
    v_mfma_f32_16x16x32_bf16 v[60:63], a[152:155], v[44:47], v[60:63]
    s_add_u32 m0, s15, 19456
    s_nop 0
    buffer_load_dwordx4 v12, s[60:63], s13 offen lds
    s_add_u32 s13, s13, 110592
    v_mfma_f32_16x16x32_bf16 v[64:67], a[152:155], v[48:51], v[64:67]
    v_mfma_f32_16x16x32_bf16 v[68:71], a[152:155], v[52:55], v[68:71]
    v_mfma_f32_16x16x32_bf16 v[72:75], a[152:155], v[56:59], v[72:75]
    v_mfma_f32_16x16x32_bf16 v[124:127], a[152:155], a[152:155], v[124:127]
    v_mfma_f32_16x16x32_bf16 v[132:135], a[152:155], v[140:143], v[132:135]
    v_mfma_f32_16x16x32_bf16 v[76:79], a[156:159], v[44:47], v[76:79]
    v_mfma_f32_16x16x32_bf16 v[80:83], a[156:159], v[48:51], v[80:83]
    v_mfma_f32_16x16x32_bf16 v[84:87], a[156:159], v[52:55], v[84:87]
    v_mfma_f32_16x16x32_bf16 v[88:91], a[156:159], v[56:59], v[88:91]
    v_mfma_f32_16x16x32_bf16 v[128:131], a[156:159], a[156:159], v[128:131]
    v_mfma_f32_16x16x32_bf16 v[136:139], a[156:159], v[140:143], v[136:139]
    v_mul_u32_u24 v16, 80, v14
    v_lshlrev_b32 v17, 2, v13
    v_add_u32 v17, 147456, v17
    v_lshlrev_b32 v15, 4, v14
    v_add_u32 v15, 147456, v15
    ds_bpermute_b32 v124, v16, v124 offset:0
    ds_bpermute_b32 v125, v16, v125 offset:4
    ds_bpermute_b32 v126, v16, v126 offset:8
    ds_bpermute_b32 v127, v16, v127 offset:12
    ds_bpermute_b32 v128, v16, v128 offset:0
    ds_bpermute_b32 v129, v16, v129 offset:4
    ds_bpermute_b32 v130, v16, v130 offset:8
    ds_bpermute_b32 v131, v16, v131 offset:12
    ds_read_b32 v144, v17 offset:0
    ds_read_b32 v146, v17 offset:512
    ds_read_b32 v148, v17 offset:64
    ds_read_b32 v150, v17 offset:576
    ds_read_b32 v152, v17 offset:128
    ds_read_b32 v154, v17 offset:640
    ds_read_b32 v156, v17 offset:192
    ds_read_b32 v158, v17 offset:704
    s_waitcnt lgkmcnt(8)
    v_mul_f32 v132, 0x3acccccd, v132
    v_mov_b32 v162, 0x3727c5ac
    v_fmac_f32 v162, 0x3acccccd, v124
    v_fma_f32 v162, -v132, v132, v162
    v_max_f32 v162, 0x3727c5ac, v162
    v_rsq_f32 v124, v162
    s_nop 0
    v_mul_f32 v132, -v132, v124
    v_mul_f32 v133, 0x3acccccd, v133
    v_mov_b32 v163, 0x3727c5ac
    v_fmac_f32 v163, 0x3acccccd, v125
    v_fma_f32 v163, -v133, v133, v163
    v_max_f32 v163, 0x3727c5ac, v163
    v_rsq_f32 v125, v163
    s_nop 0
    v_mul_f32 v133, -v133, v125
    v_mul_f32 v134, 0x3acccccd, v134
    v_mov_b32 v164, 0x3727c5ac
    v_fmac_f32 v164, 0x3acccccd, v126
    v_fma_f32 v164, -v134, v134, v164
    v_max_f32 v164, 0x3727c5ac, v164
    v_rsq_f32 v126, v164
    s_nop 0
    v_mul_f32 v134, -v134, v126
    v_mul_f32 v135, 0x3acccccd, v135
    v_mov_b32 v165, 0x3727c5ac
    v_fmac_f32 v165, 0x3acccccd, v127
    v_fma_f32 v165, -v135, v135, v165
    v_max_f32 v165, 0x3727c5ac, v165
    v_rsq_f32 v127, v165
    s_nop 0
    v_mul_f32 v135, -v135, v127
    v_mul_f32 v136, 0x3acccccd, v136
    v_mov_b32 v162, 0x3727c5ac
    v_fmac_f32 v162, 0x3acccccd, v128
    v_fma_f32 v162, -v136, v136, v162
    v_max_f32 v162, 0x3727c5ac, v162
    v_rsq_f32 v128, v162
    s_nop 0
    v_mul_f32 v136, -v136, v128
    v_mul_f32 v137, 0x3acccccd, v137
    v_mov_b32 v163, 0x3727c5ac
    v_fmac_f32 v163, 0x3acccccd, v129
    v_fma_f32 v163, -v137, v137, v163
    v_max_f32 v163, 0x3727c5ac, v163
    v_rsq_f32 v129, v163
    s_nop 0
    v_mul_f32 v137, -v137, v129
    v_mul_f32 v138, 0x3acccccd, v138
    v_mov_b32 v164, 0x3727c5ac
    v_fmac_f32 v164, 0x3acccccd, v130
    v_fma_f32 v164, -v138, v138, v164
    v_max_f32 v164, 0x3727c5ac, v164
    v_rsq_f32 v130, v164
    s_nop 0
    v_mul_f32 v138, -v138, v130
    v_mul_f32 v139, 0x3acccccd, v139
    v_mov_b32 v165, 0x3727c5ac
    v_fmac_f32 v165, 0x3acccccd, v131
    v_fma_f32 v165, -v139, v139, v165
    v_max_f32 v165, 0x3727c5ac, v165
    v_rsq_f32 v131, v165
    s_nop 0
    v_mul_f32 v139, -v139, v131
    v_and_b32 v18, 3, v13
    v_lshrrev_b32 v19, 2, v13
    v_lshl_add_u32 v19, v19, 4, v13
    v_lshlrev_b32 v19, 2, v19
    v_cmp_eq_u32 s[56:57], 1, v18
    v_cmp_eq_u32 s[58:59], 2, v18
    v_cmp_eq_u32 vcc, 3, v18
    v_cndmask_b32 v20, v124, v125, s[56:57]
    v_cndmask_b32 v20, v20, v126, s[58:59]
    v_cndmask_b32 v20, v20, v127, vcc
    ds_bpermute_b32 v20, v19, v20
    v_cndmask_b32 v22, v132, v133, s[56:57]
    v_cndmask_b32 v22, v22, v134, s[58:59]
    v_cndmask_b32 v22, v22, v135, vcc
    ds_bpermute_b32 v22, v19, v22
    v_cndmask_b32 v24, v128, v129, s[56:57]
    v_cndmask_b32 v24, v24, v130, s[58:59]
    v_cndmask_b32 v24, v24, v131, vcc
    ds_bpermute_b32 v24, v19, v24
    v_cndmask_b32 v26, v136, v137, s[56:57]
    v_cndmask_b32 v26, v26, v138, s[58:59]
    v_cndmask_b32 v26, v26, v139, vcc
    ds_bpermute_b32 v26, v19, v26
    ds_read_b128 v[180:183], v15 offset:256
    ds_read_b128 v[184:187], v15 offset:768
    ds_read_b128 v[188:191], v15 offset:320
    ds_read_b128 v[192:195], v15 offset:832
    ds_read_b128 v[196:199], v15 offset:384
    ds_read_b128 v[200:203], v15 offset:896
    ds_read_b128 v[204:207], v15 offset:448
    ds_read_b128 v[208:211], v15 offset:960
    s_waitcnt lgkmcnt(12)
    v_mov_b32 v145, v144
    v_mov_b32 v147, v146
    v_mov_b32 v149, v148
    v_mov_b32 v151, v150
    v_mov_b32 v153, v152
    v_mov_b32 v155, v154
    v_mov_b32 v157, v156
    v_mov_b32 v159, v158
    v_mov_b32 v28, 0
    v_mov_b32 v29, 0
    v_mov_b32 v30, 0
    v_mov_b32 v31, 0
    v_mov_b32 v32, 0
    v_mov_b32 v33, 0
    v_mov_b32 v34, 0
    v_mov_b32 v35, 0
    v_mov_b32 v36, 0
    v_mov_b32 v37, 0
    v_mov_b32 v38, 0
    v_mov_b32 v39, 0
    v_mov_b32 v40, 0
    v_mov_b32 v41, 0
    v_mov_b32 v42, 0
    v_mov_b32 v43, 0
    s_mul_i32 s3, s9, 54
    s_add_u32 s3, s3, s70
    v_pk_fma_f32 v[162:163], v[144:145], v[132:133], v[146:147]
    v_pk_fma_f32 v[60:61], v[60:61], v[124:125], v[162:163]
    v_pk_fma_f32 v[164:165], v[144:145], v[134:135], v[146:147]
    v_pk_fma_f32 v[62:63], v[62:63], v[126:127], v[164:165]
    v_pk_fma_f32 v[166:167], v[144:145], v[136:137], v[146:147]
    v_pk_fma_f32 v[76:77], v[76:77], v[128:129], v[166:167]
    v_pk_fma_f32 v[168:169], v[144:145], v[138:139], v[146:147]
    v_pk_fma_f32 v[78:79], v[78:79], v[130:131], v[168:169]
    v_pk_mul_f32 v[162:163], v[60:61], v[60:61]
    v_pk_mul_f32 v[164:165], v[62:63], v[62:63]
    v_pk_mul_f32 v[166:167], v[76:77], v[76:77]
    v_pk_mul_f32 v[168:169], v[78:79], v[78:79]
    v_pk_fma_f32 v[162:163], v[162:163], s[72:73], v[176:177]
    v_pk_fma_f32 v[164:165], v[164:165], s[72:73], v[176:177]
    v_pk_fma_f32 v[166:167], v[166:167], s[72:73], v[176:177]
    v_pk_fma_f32 v[168:169], v[168:169], s[72:73], v[176:177]
    v_pk_mul_f32 v[162:163], v[162:163], v[60:61]
    v_pk_mul_f32 v[164:165], v[164:165], v[62:63]
    v_pk_mul_f32 v[166:167], v[166:167], v[76:77]
    v_pk_mul_f32 v[168:169], v[168:169], v[78:79]
    v_exp_f32 v162, v162
    v_exp_f32 v163, v163
    v_exp_f32 v164, v164
    v_exp_f32 v165, v165
    v_exp_f32 v166, v166
    v_exp_f32 v167, v167
    v_exp_f32 v168, v168
    v_exp_f32 v169, v169
    v_pk_add_f32 v[162:163], v[162:163], s[74:75]
    v_pk_add_f32 v[164:165], v[164:165], s[74:75]
    v_pk_add_f32 v[166:167], v[166:167], s[74:75]
    v_pk_add_f32 v[168:169], v[168:169], s[74:75]
    v_rcp_f32 v162, v162
    v_rcp_f32 v163, v163
    v_rcp_f32 v164, v164
    v_rcp_f32 v165, v165
    v_rcp_f32 v166, v166
    v_rcp_f32 v167, v167
    v_rcp_f32 v168, v168
    v_rcp_f32 v169, v169
    v_pk_mul_f32 v[60:61], v[60:61], v[162:163]
    v_pk_mul_f32 v[62:63], v[62:63], v[164:165]
    v_pk_mul_f32 v[76:77], v[76:77], v[166:167]
    v_pk_mul_f32 v[78:79], v[78:79], v[168:169]
    v_cvt_pk_bf16_f32 v44, v60, v61
    v_cvt_pk_bf16_f32 v45, v62, v63
    v_cvt_pk_bf16_f32 v46, v76, v77
    v_cvt_pk_bf16_f32 v47, v78, v79
    s_min_u32 s5, s68, 0
    s_add_u32 s5, s5, s3
    s_lshl_b32 s5, s5, 10
    buffer_store_dwordx4 v[44:47], v12, s[92:95], s5 offen sc1
    s_cmp_eq_u32 s55, 14
    s_cbranch_scc1 kgA_ns0
    v_pk_add_f32 v[28:29], v[28:29], v[60:61]
    v_pk_fma_f32 v[36:37], v[60:61], v[60:61], v[36:37]
    v_pk_add_f32 v[30:31], v[30:31], v[62:63]
    v_pk_fma_f32 v[38:39], v[62:63], v[62:63], v[38:39]
    v_pk_add_f32 v[32:33], v[32:33], v[76:77]
    v_pk_fma_f32 v[40:41], v[76:77], v[76:77], v[40:41]
    v_pk_add_f32 v[34:35], v[34:35], v[78:79]
    v_pk_fma_f32 v[42:43], v[78:79], v[78:79], v[42:43]
kgA_ns0:
    v_pk_fma_f32 v[162:163], v[148:149], v[132:133], v[150:151]
    v_pk_fma_f32 v[64:65], v[64:65], v[124:125], v[162:163]
    v_pk_fma_f32 v[164:165], v[148:149], v[134:135], v[150:151]
    v_pk_fma_f32 v[66:67], v[66:67], v[126:127], v[164:165]
    v_pk_fma_f32 v[166:167], v[148:149], v[136:137], v[150:151]
    v_pk_fma_f32 v[80:81], v[80:81], v[128:129], v[166:167]
    v_pk_fma_f32 v[168:169], v[148:149], v[138:139], v[150:151]
    v_pk_fma_f32 v[82:83], v[82:83], v[130:131], v[168:169]
    v_pk_mul_f32 v[162:163], v[64:65], v[64:65]
    v_pk_mul_f32 v[164:165], v[66:67], v[66:67]
    v_pk_mul_f32 v[166:167], v[80:81], v[80:81]
    v_pk_mul_f32 v[168:169], v[82:83], v[82:83]
    v_pk_fma_f32 v[162:163], v[162:163], s[72:73], v[176:177]
    v_pk_fma_f32 v[164:165], v[164:165], s[72:73], v[176:177]
    v_pk_fma_f32 v[166:167], v[166:167], s[72:73], v[176:177]
    v_pk_fma_f32 v[168:169], v[168:169], s[72:73], v[176:177]
    v_pk_mul_f32 v[162:163], v[162:163], v[64:65]
    v_pk_mul_f32 v[164:165], v[164:165], v[66:67]
    v_pk_mul_f32 v[166:167], v[166:167], v[80:81]
    v_pk_mul_f32 v[168:169], v[168:169], v[82:83]
    v_exp_f32 v162, v162
    v_exp_f32 v163, v163
    v_exp_f32 v164, v164
    v_exp_f32 v165, v165
    v_exp_f32 v166, v166
    v_exp_f32 v167, v167
    v_exp_f32 v168, v168
    v_exp_f32 v169, v169
    v_pk_add_f32 v[162:163], v[162:163], s[74:75]
    v_pk_add_f32 v[164:165], v[164:165], s[74:75]
    v_pk_add_f32 v[166:167], v[166:167], s[74:75]
    v_pk_add_f32 v[168:169], v[168:169], s[74:75]
    v_rcp_f32 v162, v162
    v_rcp_f32 v163, v163
    v_rcp_f32 v164, v164
    v_rcp_f32 v165, v165
    v_rcp_f32 v166, v166
    v_rcp_f32 v167, v167
    v_rcp_f32 v168, v168
    v_rcp_f32 v169, v169
    v_pk_mul_f32 v[64:65], v[64:65], v[162:163]
    v_pk_mul_f32 v[66:67], v[66:67], v[164:165]
    v_pk_mul_f32 v[80:81], v[80:81], v[166:167]
    v_pk_mul_f32 v[82:83], v[82:83], v[168:169]
    v_cvt_pk_bf16_f32 v48, v64, v65
    v_cvt_pk_bf16_f32 v49, v66, v67
    v_cvt_pk_bf16_f32 v50, v80, v81
    v_cvt_pk_bf16_f32 v51, v82, v83
    s_min_u32 s5, s68, 1
    s_add_u32 s5, s5, s3
    s_lshl_b32 s5, s5, 10
    buffer_store_dwordx4 v[48:51], v12, s[92:95], s5 offen sc1
    s_cmp_eq_u32 s55, 14
    s_cbranch_scc1 kgA_ns1
    v_pk_add_f32 v[28:29], v[28:29], v[64:65]
    v_pk_fma_f32 v[36:37], v[64:65], v[64:65], v[36:37]
    v_pk_add_f32 v[30:31], v[30:31], v[66:67]
    v_pk_fma_f32 v[38:39], v[66:67], v[66:67], v[38:39]
    v_pk_add_f32 v[32:33], v[32:33], v[80:81]
    v_pk_fma_f32 v[40:41], v[80:81], v[80:81], v[40:41]
    v_pk_add_f32 v[34:35], v[34:35], v[82:83]
    v_pk_fma_f32 v[42:43], v[82:83], v[82:83], v[42:43]
kgA_ns1:
    v_pk_fma_f32 v[162:163], v[152:153], v[132:133], v[154:155]
    v_pk_fma_f32 v[68:69], v[68:69], v[124:125], v[162:163]
    v_pk_fma_f32 v[164:165], v[152:153], v[134:135], v[154:155]
    v_pk_fma_f32 v[70:71], v[70:71], v[126:127], v[164:165]
    v_pk_fma_f32 v[166:167], v[152:153], v[136:137], v[154:155]
    v_pk_fma_f32 v[84:85], v[84:85], v[128:129], v[166:167]
    v_pk_fma_f32 v[168:169], v[152:153], v[138:139], v[154:155]
    v_pk_fma_f32 v[86:87], v[86:87], v[130:131], v[168:169]
    v_pk_mul_f32 v[162:163], v[68:69], v[68:69]
    v_pk_mul_f32 v[164:165], v[70:71], v[70:71]
    v_pk_mul_f32 v[166:167], v[84:85], v[84:85]
    v_pk_mul_f32 v[168:169], v[86:87], v[86:87]
    v_pk_fma_f32 v[162:163], v[162:163], s[72:73], v[176:177]
    v_pk_fma_f32 v[164:165], v[164:165], s[72:73], v[176:177]
    v_pk_fma_f32 v[166:167], v[166:167], s[72:73], v[176:177]
    v_pk_fma_f32 v[168:169], v[168:169], s[72:73], v[176:177]
    v_pk_mul_f32 v[162:163], v[162:163], v[68:69]
    v_pk_mul_f32 v[164:165], v[164:165], v[70:71]
    v_pk_mul_f32 v[166:167], v[166:167], v[84:85]
    v_pk_mul_f32 v[168:169], v[168:169], v[86:87]
    v_exp_f32 v162, v162
    v_exp_f32 v163, v163
    v_exp_f32 v164, v164
    v_exp_f32 v165, v165
    v_exp_f32 v166, v166
    v_exp_f32 v167, v167
    v_exp_f32 v168, v168
    v_exp_f32 v169, v169
    v_pk_add_f32 v[162:163], v[162:163], s[74:75]
    v_pk_add_f32 v[164:165], v[164:165], s[74:75]
    v_pk_add_f32 v[166:167], v[166:167], s[74:75]
    v_pk_add_f32 v[168:169], v[168:169], s[74:75]
    v_rcp_f32 v162, v162
    v_rcp_f32 v163, v163
    v_rcp_f32 v164, v164
    v_rcp_f32 v165, v165
    v_rcp_f32 v166, v166
    v_rcp_f32 v167, v167
    v_rcp_f32 v168, v168
    v_rcp_f32 v169, v169
    v_pk_mul_f32 v[68:69], v[68:69], v[162:163]
    v_pk_mul_f32 v[70:71], v[70:71], v[164:165]
    v_pk_mul_f32 v[84:85], v[84:85], v[166:167]
    v_pk_mul_f32 v[86:87], v[86:87], v[168:169]
    v_cvt_pk_bf16_f32 v52, v68, v69
    v_cvt_pk_bf16_f32 v53, v70, v71
    v_cvt_pk_bf16_f32 v54, v84, v85
    v_cvt_pk_bf16_f32 v55, v86, v87
    s_min_u32 s5, s68, 2
    s_add_u32 s5, s5, s3
    s_lshl_b32 s5, s5, 10
    buffer_store_dwordx4 v[52:55], v12, s[92:95], s5 offen sc1
    v_pk_add_f32 v[28:29], v[28:29], v[68:69]
    v_pk_fma_f32 v[36:37], v[68:69], v[68:69], v[36:37]
    v_pk_add_f32 v[30:31], v[30:31], v[70:71]
    v_pk_fma_f32 v[38:39], v[70:71], v[70:71], v[38:39]
    v_pk_add_f32 v[32:33], v[32:33], v[84:85]
    v_pk_fma_f32 v[40:41], v[84:85], v[84:85], v[40:41]
    v_pk_add_f32 v[34:35], v[34:35], v[86:87]
    v_pk_fma_f32 v[42:43], v[86:87], v[86:87], v[42:43]
    v_pk_fma_f32 v[162:163], v[156:157], v[132:133], v[158:159]
    v_pk_fma_f32 v[72:73], v[72:73], v[124:125], v[162:163]
    v_pk_fma_f32 v[164:165], v[156:157], v[134:135], v[158:159]
    v_pk_fma_f32 v[74:75], v[74:75], v[126:127], v[164:165]
    v_pk_fma_f32 v[166:167], v[156:157], v[136:137], v[158:159]
    v_pk_fma_f32 v[88:89], v[88:89], v[128:129], v[166:167]
    v_pk_fma_f32 v[168:169], v[156:157], v[138:139], v[158:159]
    v_pk_fma_f32 v[90:91], v[90:91], v[130:131], v[168:169]
    v_pk_mul_f32 v[162:163], v[72:73], v[72:73]
    v_pk_mul_f32 v[164:165], v[74:75], v[74:75]
    v_pk_mul_f32 v[166:167], v[88:89], v[88:89]
    v_pk_mul_f32 v[168:169], v[90:91], v[90:91]
    v_pk_fma_f32 v[162:163], v[162:163], s[72:73], v[176:177]
    v_pk_fma_f32 v[164:165], v[164:165], s[72:73], v[176:177]
    v_pk_fma_f32 v[166:167], v[166:167], s[72:73], v[176:177]
    v_pk_fma_f32 v[168:169], v[168:169], s[72:73], v[176:177]
    v_pk_mul_f32 v[162:163], v[162:163], v[72:73]
    v_pk_mul_f32 v[164:165], v[164:165], v[74:75]
    v_pk_mul_f32 v[166:167], v[166:167], v[88:89]
    v_pk_mul_f32 v[168:169], v[168:169], v[90:91]
    v_exp_f32 v162, v162
    v_exp_f32 v163, v163
    v_exp_f32 v164, v164
    v_exp_f32 v165, v165
    v_exp_f32 v166, v166
    v_exp_f32 v167, v167
    v_exp_f32 v168, v168
    v_exp_f32 v169, v169
    v_pk_add_f32 v[162:163], v[162:163], s[74:75]
    v_pk_add_f32 v[164:165], v[164:165], s[74:75]
    v_pk_add_f32 v[166:167], v[166:167], s[74:75]
    v_pk_add_f32 v[168:169], v[168:169], s[74:75]
    v_rcp_f32 v162, v162
    v_rcp_f32 v163, v163
    v_rcp_f32 v164, v164
    v_rcp_f32 v165, v165
    v_rcp_f32 v166, v166
    v_rcp_f32 v167, v167
    v_rcp_f32 v168, v168
    v_rcp_f32 v169, v169
    v_pk_mul_f32 v[72:73], v[72:73], v[162:163]
    v_pk_mul_f32 v[74:75], v[74:75], v[164:165]
    v_pk_mul_f32 v[88:89], v[88:89], v[166:167]
    v_pk_mul_f32 v[90:91], v[90:91], v[168:169]
    v_cvt_pk_bf16_f32 v56, v72, v73
    v_cvt_pk_bf16_f32 v57, v74, v75
    v_cvt_pk_bf16_f32 v58, v88, v89
    v_cvt_pk_bf16_f32 v59, v90, v91
    s_min_u32 s5, s68, 3
    s_add_u32 s5, s5, s3
    s_lshl_b32 s5, s5, 10
    buffer_store_dwordx4 v[56:59], v12, s[92:95], s5 offen sc1
    s_cmp_eq_u32 s68, 3
    s_cbranch_scc0 kgA_ns3
    v_pk_add_f32 v[28:29], v[28:29], v[72:73]
    v_pk_fma_f32 v[36:37], v[72:73], v[72:73], v[36:37]
    v_pk_add_f32 v[30:31], v[30:31], v[74:75]
    v_pk_fma_f32 v[38:39], v[74:75], v[74:75], v[38:39]
    v_pk_add_f32 v[32:33], v[32:33], v[88:89]
    v_pk_fma_f32 v[40:41], v[88:89], v[88:89], v[40:41]
    v_pk_add_f32 v[34:35], v[34:35], v[90:91]
    v_pk_fma_f32 v[42:43], v[90:91], v[90:91], v[42:43]
kgA_ns3:
    v_add_f32_dpp v28, v28, v28 row_ror:8 row_mask:0xf bank_mask:0xf
    v_add_f32_dpp v29, v29, v29 row_ror:8 row_mask:0xf bank_mask:0xf
    v_add_f32_dpp v30, v30, v30 row_ror:8 row_mask:0xf bank_mask:0xf
    v_add_f32_dpp v31, v31, v31 row_ror:8 row_mask:0xf bank_mask:0xf
    v_add_f32_dpp v32, v32, v32 row_ror:8 row_mask:0xf bank_mask:0xf
    v_add_f32_dpp v33, v33, v33 row_ror:8 row_mask:0xf bank_mask:0xf
    v_add_f32_dpp v34, v34, v34 row_ror:8 row_mask:0xf bank_mask:0xf
    v_add_f32_dpp v35, v35, v35 row_ror:8 row_mask:0xf bank_mask:0xf
    v_add_f32_dpp v36, v36, v36 row_ror:8 row_mask:0xf bank_mask:0xf
    v_add_f32_dpp v37, v37, v37 row_ror:8 row_mask:0xf bank_mask:0xf
    v_add_f32_dpp v38, v38, v38 row_ror:8 row_mask:0xf bank_mask:0xf
    v_add_f32_dpp v39, v39, v39 row_ror:8 row_mask:0xf bank_mask:0xf
    v_add_f32_dpp v40, v40, v40 row_ror:8 row_mask:0xf bank_mask:0xf
    v_add_f32_dpp v41, v41, v41 row_ror:8 row_mask:0xf bank_mask:0xf
    v_add_f32_dpp v42, v42, v42 row_ror:8 row_mask:0xf bank_mask:0xf
    v_add_f32_dpp v43, v43, v43 row_ror:8 row_mask:0xf bank_mask:0xf
    v_add_f32_dpp v28, v28, v28 row_ror:4 row_mask:0xf bank_mask:0xf
    v_add_f32_dpp v29, v29, v29 row_ror:4 row_mask:0xf bank_mask:0xf
    v_add_f32_dpp v30, v30, v30 row_ror:4 row_mask:0xf bank_mask:0xf
    v_add_f32_dpp v31, v31, v31 row_ror:4 row_mask:0xf bank_mask:0xf
    v_add_f32_dpp v32, v32, v32 row_ror:4 row_mask:0xf bank_mask:0xf
    v_add_f32_dpp v33, v33, v33 row_ror:4 row_mask:0xf bank_mask:0xf
    v_add_f32_dpp v34, v34, v34 row_ror:4 row_mask:0xf bank_mask:0xf
    v_add_f32_dpp v35, v35, v35 row_ror:4 row_mask:0xf bank_mask:0xf
    v_add_f32_dpp v36, v36, v36 row_ror:4 row_mask:0xf bank_mask:0xf
    v_add_f32_dpp v37, v37, v37 row_ror:4 row_mask:0xf bank_mask:0xf
    v_add_f32_dpp v38, v38, v38 row_ror:4 row_mask:0xf bank_mask:0xf
    v_add_f32_dpp v39, v39, v39 row_ror:4 row_mask:0xf bank_mask:0xf
    v_add_f32_dpp v40, v40, v40 row_ror:4 row_mask:0xf bank_mask:0xf
    v_add_f32_dpp v41, v41, v41 row_ror:4 row_mask:0xf bank_mask:0xf
    v_add_f32_dpp v42, v42, v42 row_ror:4 row_mask:0xf bank_mask:0xf
    v_add_f32_dpp v43, v43, v43 row_ror:4 row_mask:0xf bank_mask:0xf
    v_add_f32_dpp v28, v28, v28 row_ror:2 row_mask:0xf bank_mask:0xf
    v_add_f32_dpp v29, v29, v29 row_ror:2 row_mask:0xf bank_mask:0xf
    v_add_f32_dpp v30, v30, v30 row_ror:2 row_mask:0xf bank_mask:0xf
    v_add_f32_dpp v31, v31, v31 row_ror:2 row_mask:0xf bank_mask:0xf
    v_add_f32_dpp v32, v32, v32 row_ror:2 row_mask:0xf bank_mask:0xf
    v_add_f32_dpp v33, v33, v33 row_ror:2 row_mask:0xf bank_mask:0xf
    v_add_f32_dpp v34, v34, v34 row_ror:2 row_mask:0xf bank_mask:0xf
    v_add_f32_dpp v35, v35, v35 row_ror:2 row_mask:0xf bank_mask:0xf
    v_add_f32_dpp v36, v36, v36 row_ror:2 row_mask:0xf bank_mask:0xf
    v_add_f32_dpp v37, v37, v37 row_ror:2 row_mask:0xf bank_mask:0xf
    v_add_f32_dpp v38, v38, v38 row_ror:2 row_mask:0xf bank_mask:0xf
    v_add_f32_dpp v39, v39, v39 row_ror:2 row_mask:0xf bank_mask:0xf
    v_add_f32_dpp v40, v40, v40 row_ror:2 row_mask:0xf bank_mask:0xf
    v_add_f32_dpp v41, v41, v41 row_ror:2 row_mask:0xf bank_mask:0xf
    v_add_f32_dpp v42, v42, v42 row_ror:2 row_mask:0xf bank_mask:0xf
    v_add_f32_dpp v43, v43, v43 row_ror:2 row_mask:0xf bank_mask:0xf
    v_add_f32_dpp v28, v28, v28 row_ror:1 row_mask:0xf bank_mask:0xf
    v_add_f32_dpp v29, v29, v29 row_ror:1 row_mask:0xf bank_mask:0xf
    v_add_f32_dpp v30, v30, v30 row_ror:1 row_mask:0xf bank_mask:0xf
    v_add_f32_dpp v31, v31, v31 row_ror:1 row_mask:0xf bank_mask:0xf
    v_add_f32_dpp v32, v32, v32 row_ror:1 row_mask:0xf bank_mask:0xf
    v_add_f32_dpp v33, v33, v33 row_ror:1 row_mask:0xf bank_mask:0xf
    v_add_f32_dpp v34, v34, v34 row_ror:1 row_mask:0xf bank_mask:0xf
    v_add_f32_dpp v35, v35, v35 row_ror:1 row_mask:0xf bank_mask:0xf
    v_add_f32_dpp v36, v36, v36 row_ror:1 row_mask:0xf bank_mask:0xf
    v_add_f32_dpp v37, v37, v37 row_ror:1 row_mask:0xf bank_mask:0xf
    v_add_f32_dpp v38, v38, v38 row_ror:1 row_mask:0xf bank_mask:0xf
    v_add_f32_dpp v39, v39, v39 row_ror:1 row_mask:0xf bank_mask:0xf
    v_add_f32_dpp v40, v40, v40 row_ror:1 row_mask:0xf bank_mask:0xf
    v_add_f32_dpp v41, v41, v41 row_ror:1 row_mask:0xf bank_mask:0xf
    v_add_f32_dpp v42, v42, v42 row_ror:1 row_mask:0xf bank_mask:0xf
    v_add_f32_dpp v43, v43, v43 row_ror:1 row_mask:0xf bank_mask:0xf
    v_mov_b32 v144, v28
    v_mov_b32 v145, v36
    v_mov_b32 v146, v29
    v_mov_b32 v147, v37
    v_mov_b32 v148, v30
    v_mov_b32 v149, v38
    v_mov_b32 v150, v31
    v_mov_b32 v151, v39
    v_mov_b32 v152, v32
    v_mov_b32 v153, v40
    v_mov_b32 v154, v33
    v_mov_b32 v155, v41
    v_mov_b32 v156, v34
    v_mov_b32 v157, v42
    v_mov_b32 v158, v35
    v_mov_b32 v159, v43
    s_lshl_b32 s5, s4, 8
    s_add_u32 s5, s5, 148480
    v_lshlrev_b32 v15, 6, v14
    v_add_u32 v15, s5, v15
    v_lshl_add_u32 v16, v13, 2, v15
    v_cmp_eq_u32 vcc, 0, v13
    s_nop 0
    s_and_saveexec_b64 s[56:57], vcc
    ds_write_b128 v15, v[144:147]
    ds_write_b128 v15, v[148:151] offset:16
    ds_write_b128 v15, v[152:155] offset:32
    ds_write_b128 v15, v[156:159] offset:48
    s_mov_b64 exec, s[56:57]
    s_waitcnt lgkmcnt(0)
    ds_read_b32 v17, v16
    v_lshlrev_b32 v16, 2, v1
    s_lshl_b32 s5, s9, 8
    v_mov_b32 v21, v20
    v_mov_b32 v23, v22
    v_mov_b32 v25, v24
    v_mov_b32 v27, v26
    v_add_u32 v8, 65536, v12
    v_add_u32 v9, 106496, v12
    s_waitcnt lgkmcnt(0)
    buffer_atomic_add_f32 v17, v16, s[76:79], s5 offen sc1
    s_mov_b32 s88, s38
    s_mov_b32 s89, s39
    s_mov_b32 s90, 8388608
    s_mov_b32 s91, 0x00020000
    v_lshrrev_b32 v16, 3, v1
    v_lshrrev_b32 v17, 2, v16
    v_lshlrev_b32 v17, 3, v17
    v_and_b32 v16, 3, v16
    v_add_u32 v17, v17, v16
    v_lshlrev_b32 v17, 12, v17
    v_and_b32 v16, 7, v1
    v_xor_b32 v16, v16, v14
    v_lshl_add_u32 v220, v16, 4, v17
    v_xor_b32 v221, 64, v220
    v_add_u32 v221, 65536, v221
    s_lshl_b32 s96, s4, 13
    s_lshl_b32 s97, s98, 18
    s_lshl_b32 s3, s4, 10
    s_add_u32 s97, s97, s3
    s_lshl_b32 s7, s2, 15
    v_lshlrev_b32 v219, 4, v0
    s_waitcnt vmcnt(5)
    s_barrier
    ds_read_b128 v[28:31], v8 offset:0
    ds_read_b128 v[32:35], v8 offset:20480
    ds_read_b128 v[36:39], v9 offset:0
    ds_read_b128 v[40:43], v9 offset:20480
    s_waitcnt lgkmcnt(0)
    v_mfma_f32_16x16x32_bf16 v[92:95], v[28:31], a[0:3], 0
    ds_read_b128 v[44:47], v8 offset:1024
    v_mfma_f32_16x16x32_bf16 v[96:99], v[32:35], a[0:3], 0
    ds_read_b128 v[48:51], v8 offset:21504
    v_mfma_f32_16x16x32_bf16 v[100:103], v[36:39], a[0:3], 0
    ds_read_b128 v[52:55], v9 offset:1024
    v_mfma_f32_16x16x32_bf16 v[104:107], v[40:43], a[0:3], 0
    ds_read_b128 v[56:59], v9 offset:21504
    v_mfma_f32_16x16x32_bf16 v[108:111], v[28:31], a[4:7], 0
    v_mfma_f32_16x16x32_bf16 v[112:115], v[32:35], a[4:7], 0
    v_mfma_f32_16x16x32_bf16 v[116:119], v[36:39], a[4:7], 0
    v_mfma_f32_16x16x32_bf16 v[120:123], v[40:43], a[4:7], 0
    s_waitcnt lgkmcnt(0)
    v_mfma_f32_16x16x32_bf16 v[92:95], v[44:47], a[8:11], v[92:95]
    ds_read_b128 v[28:31], v8 offset:2048
    v_mfma_f32_16x16x32_bf16 v[96:99], v[48:51], a[8:11], v[96:99]
    ds_read_b128 v[32:35], v8 offset:22528
    v_mfma_f32_16x16x32_bf16 v[100:103], v[52:55], a[8:11], v[100:103]
    ds_read_b128 v[36:39], v9 offset:2048
    v_mfma_f32_16x16x32_bf16 v[104:107], v[56:59], a[8:11], v[104:107]
    ds_read_b128 v[40:43], v9 offset:22528
    v_mfma_f32_16x16x32_bf16 v[108:111], v[44:47], a[12:15], v[108:111]
    v_mfma_f32_16x16x32_bf16 v[112:115], v[48:51], a[12:15], v[112:115]
    v_mfma_f32_16x16x32_bf16 v[116:119], v[52:55], a[12:15], v[116:119]
    v_mfma_f32_16x16x32_bf16 v[120:123], v[56:59], a[12:15], v[120:123]
    s_waitcnt lgkmcnt(0)
    v_mfma_f32_16x16x32_bf16 v[92:95], v[28:31], a[16:19], v[92:95]
    ds_read_b128 v[44:47], v8 offset:3072
    v_mfma_f32_16x16x32_bf16 v[96:99], v[32:35], a[16:19], v[96:99]
    ds_read_b128 v[48:51], v8 offset:23552
    v_mfma_f32_16x16x32_bf16 v[100:103], v[36:39], a[16:19], v[100:103]
    ds_read_b128 v[52:55], v9 offset:3072
    v_mfma_f32_16x16x32_bf16 v[104:107], v[40:43], a[16:19], v[104:107]
    ds_read_b128 v[56:59], v9 offset:23552
    v_mfma_f32_16x16x32_bf16 v[108:111], v[28:31], a[20:23], v[108:111]
    v_mfma_f32_16x16x32_bf16 v[112:115], v[32:35], a[20:23], v[112:115]
    v_mfma_f32_16x16x32_bf16 v[116:119], v[36:39], a[20:23], v[116:119]
    v_mfma_f32_16x16x32_bf16 v[120:123], v[40:43], a[20:23], v[120:123]
    s_waitcnt lgkmcnt(0)
    v_mfma_f32_16x16x32_bf16 v[92:95], v[44:47], a[24:27], v[92:95]
    ds_read_b128 v[28:31], v8 offset:4096
    v_mfma_f32_16x16x32_bf16 v[96:99], v[48:51], a[24:27], v[96:99]
    ds_read_b128 v[32:35], v8 offset:24576
    v_mfma_f32_16x16x32_bf16 v[100:103], v[52:55], a[24:27], v[100:103]
    ds_read_b128 v[36:39], v9 offset:4096
    v_mfma_f32_16x16x32_bf16 v[104:107], v[56:59], a[24:27], v[104:107]
    ds_read_b128 v[40:43], v9 offset:24576
    v_mfma_f32_16x16x32_bf16 v[108:111], v[44:47], a[28:31], v[108:111]
    v_mfma_f32_16x16x32_bf16 v[112:115], v[48:51], a[28:31], v[112:115]
    v_mfma_f32_16x16x32_bf16 v[116:119], v[52:55], a[28:31], v[116:119]
    v_mfma_f32_16x16x32_bf16 v[120:123], v[56:59], a[28:31], v[120:123]
    s_waitcnt lgkmcnt(0)
    v_mfma_f32_16x16x32_bf16 v[92:95], v[28:31], a[32:35], v[92:95]
    ds_read_b128 v[44:47], v8 offset:5120
    v_mfma_f32_16x16x32_bf16 v[96:99], v[32:35], a[32:35], v[96:99]
    ds_read_b128 v[48:51], v8 offset:25600
    v_mfma_f32_16x16x32_bf16 v[100:103], v[36:39], a[32:35], v[100:103]
    ds_read_b128 v[52:55], v9 offset:5120
    v_mfma_f32_16x16x32_bf16 v[104:107], v[40:43], a[32:35], v[104:107]
    ds_read_b128 v[56:59], v9 offset:25600
    v_mfma_f32_16x16x32_bf16 v[108:111], v[28:31], a[36:39], v[108:111]
    v_mfma_f32_16x16x32_bf16 v[112:115], v[32:35], a[36:39], v[112:115]
    v_mfma_f32_16x16x32_bf16 v[116:119], v[36:39], a[36:39], v[116:119]
    v_mfma_f32_16x16x32_bf16 v[120:123], v[40:43], a[36:39], v[120:123]
    s_lshl_b32 s3, s9, 4
    s_add_u32 s3, s3, s55
    s_lshl_b32 s3, s3, 2
    s_waitcnt vmcnt(0)
    v_mov_b32 v15, 0
    v_mov_b32 v16, 1
    s_mov_b64 exec, 1
    buffer_store_dword v16, v15, s[84:87], s3 offen sc1
    s_mov_b64 exec, -1
    s_waitcnt lgkmcnt(0)
    v_mfma_f32_16x16x32_bf16 v[92:95], v[44:47], a[40:43], v[92:95]
    ds_read_b128 v[28:31], v8 offset:6144
    v_mfma_f32_16x16x32_bf16 v[96:99], v[48:51], a[40:43], v[96:99]
    ds_read_b128 v[32:35], v8 offset:26624
    v_mfma_f32_16x16x32_bf16 v[100:103], v[52:55], a[40:43], v[100:103]
    ds_read_b128 v[36:39], v9 offset:6144
    v_mfma_f32_16x16x32_bf16 v[104:107], v[56:59], a[40:43], v[104:107]
    ds_read_b128 v[40:43], v9 offset:26624
    v_mfma_f32_16x16x32_bf16 v[108:111], v[44:47], a[44:47], v[108:111]
    v_mfma_f32_16x16x32_bf16 v[112:115], v[48:51], a[44:47], v[112:115]
    s_add_u32 m0, s96, 0
    s_add_u32 s14, s97, 0
    buffer_load_dwordx4 v220, s[88:91], s14 offen lds
    v_mfma_f32_16x16x32_bf16 v[116:119], v[52:55], a[44:47], v[116:119]
    v_mfma_f32_16x16x32_bf16 v[120:123], v[56:59], a[44:47], v[120:123]
    s_add_u32 m0, s96, 1024
    s_add_u32 s14, s97, 0
    buffer_load_dwordx4 v221, s[88:91], s14 offen lds
    s_waitcnt lgkmcnt(0)
    v_mfma_f32_16x16x32_bf16 v[92:95], v[28:31], a[48:51], v[92:95]
    ds_read_b128 v[44:47], v8 offset:7168
    v_mfma_f32_16x16x32_bf16 v[96:99], v[32:35], a[48:51], v[96:99]
    ds_read_b128 v[48:51], v8 offset:27648
    v_mfma_f32_16x16x32_bf16 v[100:103], v[36:39], a[48:51], v[100:103]
    ds_read_b128 v[52:55], v9 offset:7168
    v_mfma_f32_16x16x32_bf16 v[104:107], v[40:43], a[48:51], v[104:107]
    ds_read_b128 v[56:59], v9 offset:27648
    v_mfma_f32_16x16x32_bf16 v[108:111], v[28:31], a[52:55], v[108:111]
    v_mfma_f32_16x16x32_bf16 v[112:115], v[32:35], a[52:55], v[112:115]
    s_add_u32 m0, s96, 2048
    s_add_u32 s14, s97, 16384
    buffer_load_dwordx4 v220, s[88:91], s14 offen lds
    v_mfma_f32_16x16x32_bf16 v[116:119], v[36:39], a[52:55], v[116:119]
    v_mfma_f32_16x16x32_bf16 v[120:123], v[40:43], a[52:55], v[120:123]
    s_add_u32 m0, s96, 3072
    s_add_u32 s14, s97, 16384
    buffer_load_dwordx4 v221, s[88:91], s14 offen lds
    s_waitcnt lgkmcnt(0)
    v_mfma_f32_16x16x32_bf16 v[92:95], v[44:47], a[56:59], v[92:95]
    ds_read_b128 v[28:31], v8 offset:8192
    v_mfma_f32_16x16x32_bf16 v[96:99], v[48:51], a[56:59], v[96:99]
    ds_read_b128 v[32:35], v8 offset:28672
    v_mfma_f32_16x16x32_bf16 v[100:103], v[52:55], a[56:59], v[100:103]
    ds_read_b128 v[36:39], v9 offset:8192
    v_mfma_f32_16x16x32_bf16 v[104:107], v[56:59], a[56:59], v[104:107]
    ds_read_b128 v[40:43], v9 offset:28672
    v_mfma_f32_16x16x32_bf16 v[108:111], v[44:47], a[60:63], v[108:111]
    v_mfma_f32_16x16x32_bf16 v[112:115], v[48:51], a[60:63], v[112:115]
    s_add_u32 m0, s96, 4096
    s_add_u32 s14, s97, 131072
    buffer_load_dwordx4 v220, s[88:91], s14 offen lds
    v_mfma_f32_16x16x32_bf16 v[116:119], v[52:55], a[60:63], v[116:119]
    v_mfma_f32_16x16x32_bf16 v[120:123], v[56:59], a[60:63], v[120:123]
    s_add_u32 m0, s96, 5120
    s_add_u32 s14, s97, 131072
    buffer_load_dwordx4 v221, s[88:91], s14 offen lds
    s_waitcnt lgkmcnt(0)
    v_mfma_f32_16x16x32_bf16 v[92:95], v[28:31], a[64:67], v[92:95]
    ds_read_b128 v[44:47], v8 offset:9216
    v_mfma_f32_16x16x32_bf16 v[96:99], v[32:35], a[64:67], v[96:99]
    ds_read_b128 v[48:51], v8 offset:29696
    v_mfma_f32_16x16x32_bf16 v[100:103], v[36:39], a[64:67], v[100:103]
    ds_read_b128 v[52:55], v9 offset:9216
    v_mfma_f32_16x16x32_bf16 v[104:107], v[40:43], a[64:67], v[104:107]
    ds_read_b128 v[56:59], v9 offset:29696
    v_mfma_f32_16x16x32_bf16 v[108:111], v[28:31], a[68:71], v[108:111]
    v_mfma_f32_16x16x32_bf16 v[112:115], v[32:35], a[68:71], v[112:115]
    s_add_u32 m0, s96, 6144
    s_add_u32 s14, s97, 147456
    buffer_load_dwordx4 v220, s[88:91], s14 offen lds
    v_mfma_f32_16x16x32_bf16 v[116:119], v[36:39], a[68:71], v[116:119]
    v_mfma_f32_16x16x32_bf16 v[120:123], v[40:43], a[68:71], v[120:123]
    s_add_u32 m0, s96, 7168
    s_add_u32 s14, s97, 147456
    buffer_load_dwordx4 v221, s[88:91], s14 offen lds
    s_waitcnt lgkmcnt(0)
    v_mfma_f32_16x16x32_bf16 v[92:95], v[44:47], a[72:75], v[92:95]
    ds_read_b128 v[28:31], v8 offset:10240
    v_mfma_f32_16x16x32_bf16 v[96:99], v[48:51], a[72:75], v[96:99]
    ds_read_b128 v[32:35], v8 offset:30720
    v_mfma_f32_16x16x32_bf16 v[100:103], v[52:55], a[72:75], v[100:103]
    ds_read_b128 v[36:39], v9 offset:10240
    v_mfma_f32_16x16x32_bf16 v[104:107], v[56:59], a[72:75], v[104:107]
    ds_read_b128 v[40:43], v9 offset:30720
    v_mfma_f32_16x16x32_bf16 v[108:111], v[44:47], a[76:79], v[108:111]
    v_mfma_f32_16x16x32_bf16 v[112:115], v[48:51], a[76:79], v[112:115]
    s_add_u32 m0, s96, 32768
    s_add_u32 s14, s97, 128
    buffer_load_dwordx4 v220, s[88:91], s14 offen lds
    v_mfma_f32_16x16x32_bf16 v[116:119], v[52:55], a[76:79], v[116:119]
    v_mfma_f32_16x16x32_bf16 v[120:123], v[56:59], a[76:79], v[120:123]
    s_add_u32 m0, s96, 33792
    s_add_u32 s14, s97, 128
    buffer_load_dwordx4 v221, s[88:91], s14 offen lds
    s_waitcnt lgkmcnt(0)
    v_mfma_f32_16x16x32_bf16 v[92:95], v[28:31], a[80:83], v[92:95]
    ds_read_b128 v[44:47], v8 offset:11264
    v_mfma_f32_16x16x32_bf16 v[96:99], v[32:35], a[80:83], v[96:99]
    ds_read_b128 v[48:51], v8 offset:31744
    v_mfma_f32_16x16x32_bf16 v[100:103], v[36:39], a[80:83], v[100:103]
    ds_read_b128 v[52:55], v9 offset:11264
    v_mfma_f32_16x16x32_bf16 v[104:107], v[40:43], a[80:83], v[104:107]
    ds_read_b128 v[56:59], v9 offset:31744
    v_mfma_f32_16x16x32_bf16 v[108:111], v[28:31], a[84:87], v[108:111]
    v_mfma_f32_16x16x32_bf16 v[112:115], v[32:35], a[84:87], v[112:115]
    s_add_u32 m0, s96, 34816
    s_add_u32 s14, s97, 16512
    buffer_load_dwordx4 v220, s[88:91], s14 offen lds
    v_mfma_f32_16x16x32_bf16 v[116:119], v[36:39], a[84:87], v[116:119]
    v_mfma_f32_16x16x32_bf16 v[120:123], v[40:43], a[84:87], v[120:123]
    s_add_u32 m0, s96, 35840
    s_add_u32 s14, s97, 16512
    buffer_load_dwordx4 v221, s[88:91], s14 offen lds
    s_waitcnt lgkmcnt(0)
    v_mfma_f32_16x16x32_bf16 v[92:95], v[44:47], a[88:91], v[92:95]
    ds_read_b128 v[28:31], v8 offset:12288
    v_mfma_f32_16x16x32_bf16 v[96:99], v[48:51], a[88:91], v[96:99]
    ds_read_b128 v[32:35], v8 offset:32768
    v_mfma_f32_16x16x32_bf16 v[100:103], v[52:55], a[88:91], v[100:103]
    ds_read_b128 v[36:39], v9 offset:12288
    v_mfma_f32_16x16x32_bf16 v[104:107], v[56:59], a[88:91], v[104:107]
    ds_read_b128 v[40:43], v9 offset:32768
    v_mfma_f32_16x16x32_bf16 v[108:111], v[44:47], a[92:95], v[108:111]
    v_mfma_f32_16x16x32_bf16 v[112:115], v[48:51], a[92:95], v[112:115]
    s_add_u32 m0, s96, 36864
    s_add_u32 s14, s97, 131200
    buffer_load_dwordx4 v220, s[88:91], s14 offen lds
    v_mfma_f32_16x16x32_bf16 v[116:119], v[52:55], a[92:95], v[116:119]
    v_mfma_f32_16x16x32_bf16 v[120:123], v[56:59], a[92:95], v[120:123]
    s_add_u32 m0, s96, 37888
    s_add_u32 s14, s97, 131200
    buffer_load_dwordx4 v221, s[88:91], s14 offen lds
    s_waitcnt lgkmcnt(0)
    v_mfma_f32_16x16x32_bf16 v[92:95], v[28:31], a[96:99], v[92:95]
    ds_read_b128 v[44:47], v8 offset:13312
    v_mfma_f32_16x16x32_bf16 v[96:99], v[32:35], a[96:99], v[96:99]
    ds_read_b128 v[48:51], v8 offset:33792
    v_mfma_f32_16x16x32_bf16 v[100:103], v[36:39], a[96:99], v[100:103]
    ds_read_b128 v[52:55], v9 offset:13312
    v_mfma_f32_16x16x32_bf16 v[104:107], v[40:43], a[96:99], v[104:107]
    ds_read_b128 v[56:59], v9 offset:33792
    v_mfma_f32_16x16x32_bf16 v[108:111], v[28:31], a[100:103], v[108:111]
    v_mfma_f32_16x16x32_bf16 v[112:115], v[32:35], a[100:103], v[112:115]
    s_add_u32 m0, s96, 38912
    s_add_u32 s14, s97, 147584
    buffer_load_dwordx4 v220, s[88:91], s14 offen lds
    v_mfma_f32_16x16x32_bf16 v[116:119], v[36:39], a[100:103], v[116:119]
    v_mfma_f32_16x16x32_bf16 v[120:123], v[40:43], a[100:103], v[120:123]
    s_add_u32 m0, s96, 39936
    s_add_u32 s14, s97, 147584
    buffer_load_dwordx4 v221, s[88:91], s14 offen lds
    s_waitcnt lgkmcnt(0)
    v_mfma_f32_16x16x32_bf16 v[92:95], v[44:47], a[104:107], v[92:95]
    ds_read_b128 v[28:31], v8 offset:14336
    v_mfma_f32_16x16x32_bf16 v[96:99], v[48:51], a[104:107], v[96:99]
    ds_read_b128 v[32:35], v8 offset:34816
    v_mfma_f32_16x16x32_bf16 v[100:103], v[52:55], a[104:107], v[100:103]
    ds_read_b128 v[36:39], v9 offset:14336
    v_mfma_f32_16x16x32_bf16 v[104:107], v[56:59], a[104:107], v[104:107]
    ds_read_b128 v[40:43], v9 offset:34816
    v_mfma_f32_16x16x32_bf16 v[108:111], v[44:47], a[108:111], v[108:111]
    v_mfma_f32_16x16x32_bf16 v[112:115], v[48:51], a[108:111], v[112:115]
    v_mfma_f32_16x16x32_bf16 v[116:119], v[52:55], a[108:111], v[116:119]
    v_mfma_f32_16x16x32_bf16 v[120:123], v[56:59], a[108:111], v[120:123]
    s_waitcnt lgkmcnt(0)
    v_mfma_f32_16x16x32_bf16 v[92:95], v[28:31], a[112:115], v[92:95]
    ds_read_b128 v[44:47], v8 offset:15360
    v_mfma_f32_16x16x32_bf16 v[96:99], v[32:35], a[112:115], v[96:99]
    ds_read_b128 v[48:51], v8 offset:35840
    v_mfma_f32_16x16x32_bf16 v[100:103], v[36:39], a[112:115], v[100:103]
    ds_read_b128 v[52:55], v9 offset:15360
    v_mfma_f32_16x16x32_bf16 v[104:107], v[40:43], a[112:115], v[104:107]
    ds_read_b128 v[56:59], v9 offset:35840
    v_mfma_f32_16x16x32_bf16 v[108:111], v[28:31], a[116:119], v[108:111]
    v_mfma_f32_16x16x32_bf16 v[112:115], v[32:35], a[116:119], v[112:115]
    v_mfma_f32_16x16x32_bf16 v[116:119], v[36:39], a[116:119], v[116:119]
    v_mfma_f32_16x16x32_bf16 v[120:123], v[40:43], a[116:119], v[120:123]
    s_waitcnt lgkmcnt(0)
    v_mfma_f32_16x16x32_bf16 v[92:95], v[44:47], a[120:123], v[92:95]
    ds_read_b128 v[28:31], v8 offset:16384
    v_mfma_f32_16x16x32_bf16 v[96:99], v[48:51], a[120:123], v[96:99]
    ds_read_b128 v[32:35], v8 offset:36864
    v_mfma_f32_16x16x32_bf16 v[100:103], v[52:55], a[120:123], v[100:103]
    ds_read_b128 v[36:39], v9 offset:16384
    v_mfma_f32_16x16x32_bf16 v[104:107], v[56:59], a[120:123], v[104:107]
    ds_read_b128 v[40:43], v9 offset:36864
    v_mfma_f32_16x16x32_bf16 v[108:111], v[44:47], a[124:127], v[108:111]
    v_mfma_f32_16x16x32_bf16 v[112:115], v[48:51], a[124:127], v[112:115]
    v_mfma_f32_16x16x32_bf16 v[116:119], v[52:55], a[124:127], v[116:119]
    v_mfma_f32_16x16x32_bf16 v[120:123], v[56:59], a[124:127], v[120:123]
    s_waitcnt lgkmcnt(0)
    v_mfma_f32_16x16x32_bf16 v[92:95], v[28:31], a[128:131], v[92:95]
    ds_read_b128 v[44:47], v8 offset:17408
    v_mfma_f32_16x16x32_bf16 v[96:99], v[32:35], a[128:131], v[96:99]
    ds_read_b128 v[48:51], v8 offset:37888
    v_mfma_f32_16x16x32_bf16 v[100:103], v[36:39], a[128:131], v[100:103]
    ds_read_b128 v[52:55], v9 offset:17408
    v_mfma_f32_16x16x32_bf16 v[104:107], v[40:43], a[128:131], v[104:107]
    ds_read_b128 v[56:59], v9 offset:37888
    v_mfma_f32_16x16x32_bf16 v[108:111], v[28:31], a[132:135], v[108:111]
    v_mfma_f32_16x16x32_bf16 v[112:115], v[32:35], a[132:135], v[112:115]
    v_mfma_f32_16x16x32_bf16 v[116:119], v[36:39], a[132:135], v[116:119]
    v_mfma_f32_16x16x32_bf16 v[120:123], v[40:43], a[132:135], v[120:123]
    s_waitcnt lgkmcnt(0)
    v_mfma_f32_16x16x32_bf16 v[92:95], v[44:47], a[136:139], v[92:95]
    ds_read_b128 v[28:31], v8 offset:18432
    v_mfma_f32_16x16x32_bf16 v[96:99], v[48:51], a[136:139], v[96:99]
    ds_read_b128 v[32:35], v8 offset:38912
    v_mfma_f32_16x16x32_bf16 v[100:103], v[52:55], a[136:139], v[100:103]
    ds_read_b128 v[36:39], v9 offset:18432
    v_mfma_f32_16x16x32_bf16 v[104:107], v[56:59], a[136:139], v[104:107]
    ds_read_b128 v[40:43], v9 offset:38912
    v_mfma_f32_16x16x32_bf16 v[108:111], v[44:47], a[140:143], v[108:111]
    v_mfma_f32_16x16x32_bf16 v[112:115], v[48:51], a[140:143], v[112:115]
    v_mfma_f32_16x16x32_bf16 v[116:119], v[52:55], a[140:143], v[116:119]
    v_mfma_f32_16x16x32_bf16 v[120:123], v[56:59], a[140:143], v[120:123]
    s_waitcnt lgkmcnt(0)
    v_mfma_f32_16x16x32_bf16 v[92:95], v[28:31], a[144:147], v[92:95]
    ds_read_b128 v[44:47], v8 offset:19456
    v_mfma_f32_16x16x32_bf16 v[96:99], v[32:35], a[144:147], v[96:99]
    ds_read_b128 v[48:51], v8 offset:39936
    v_mfma_f32_16x16x32_bf16 v[100:103], v[36:39], a[144:147], v[100:103]
    ds_read_b128 v[52:55], v9 offset:19456
    v_mfma_f32_16x16x32_bf16 v[104:107], v[40:43], a[144:147], v[104:107]
    ds_read_b128 v[56:59], v9 offset:39936
    v_mfma_f32_16x16x32_bf16 v[108:111], v[28:31], a[148:151], v[108:111]
    v_mfma_f32_16x16x32_bf16 v[112:115], v[32:35], a[148:151], v[112:115]
    v_mfma_f32_16x16x32_bf16 v[116:119], v[36:39], a[148:151], v[116:119]
    v_mfma_f32_16x16x32_bf16 v[120:123], v[40:43], a[148:151], v[120:123]
    s_waitcnt lgkmcnt(0)
    v_mfma_f32_16x16x32_bf16 v[92:95], v[44:47], a[152:155], v[92:95]
    v_mfma_f32_16x16x32_bf16 v[96:99], v[48:51], a[152:155], v[96:99]
    v_mfma_f32_16x16x32_bf16 v[100:103], v[52:55], a[152:155], v[100:103]
    v_mfma_f32_16x16x32_bf16 v[104:107], v[56:59], a[152:155], v[104:107]
    v_mfma_f32_16x16x32_bf16 v[108:111], v[44:47], a[156:159], v[108:111]
    v_mfma_f32_16x16x32_bf16 v[112:115], v[48:51], a[156:159], v[112:115]
    v_mfma_f32_16x16x32_bf16 v[116:119], v[52:55], a[156:159], v[116:119]
    v_mfma_f32_16x16x32_bf16 v[120:123], v[56:59], a[156:159], v[120:123]
    s_barrier
    v_pk_fma_f32 v[162:163], v[180:181], v[22:23], v[184:185]
    v_pk_fma_f32 v[92:93], v[92:93], v[20:21], v[162:163]
    v_pk_fma_f32 v[164:165], v[182:183], v[22:23], v[186:187]
    v_pk_fma_f32 v[94:95], v[94:95], v[20:21], v[164:165]
    v_pk_fma_f32 v[166:167], v[180:181], v[26:27], v[184:185]
    v_pk_fma_f32 v[108:109], v[108:109], v[24:25], v[166:167]
    v_pk_fma_f32 v[168:169], v[182:183], v[26:27], v[186:187]
    v_pk_fma_f32 v[110:111], v[110:111], v[24:25], v[168:169]
    v_pk_mul_f32 v[162:163], v[92:93], v[92:93]
    v_pk_mul_f32 v[164:165], v[94:95], v[94:95]
    v_pk_mul_f32 v[166:167], v[108:109], v[108:109]
    v_pk_mul_f32 v[168:169], v[110:111], v[110:111]
    v_pk_fma_f32 v[162:163], v[162:163], s[72:73], v[176:177]
    v_pk_fma_f32 v[164:165], v[164:165], s[72:73], v[176:177]
    v_pk_fma_f32 v[166:167], v[166:167], s[72:73], v[176:177]
    v_pk_fma_f32 v[168:169], v[168:169], s[72:73], v[176:177]
    v_pk_mul_f32 v[162:163], v[162:163], v[92:93]
    v_pk_mul_f32 v[164:165], v[164:165], v[94:95]
    v_pk_mul_f32 v[166:167], v[166:167], v[108:109]
    v_pk_mul_f32 v[168:169], v[168:169], v[110:111]
    v_exp_f32 v162, v162
    v_exp_f32 v163, v163
    v_exp_f32 v164, v164
    v_exp_f32 v165, v165
    v_exp_f32 v166, v166
    v_exp_f32 v167, v167
    v_exp_f32 v168, v168
    v_exp_f32 v169, v169
    v_pk_add_f32 v[162:163], v[162:163], s[74:75]
    v_pk_add_f32 v[164:165], v[164:165], s[74:75]
    v_pk_add_f32 v[166:167], v[166:167], s[74:75]
    v_pk_add_f32 v[168:169], v[168:169], s[74:75]
    v_rcp_f32 v162, v162
    v_rcp_f32 v163, v163
    v_rcp_f32 v164, v164
    v_rcp_f32 v165, v165
    v_rcp_f32 v166, v166
    v_rcp_f32 v167, v167
    v_rcp_f32 v168, v168
    v_rcp_f32 v169, v169
    v_pk_mul_f32 v[92:93], v[92:93], v[162:163]
    v_pk_mul_f32 v[94:95], v[94:95], v[164:165]
    v_pk_mul_f32 v[108:109], v[108:109], v[166:167]
    v_pk_mul_f32 v[110:111], v[110:111], v[168:169]
    s_min_u32 s3, s69, 0
    s_add_u32 s3, s3, s71
    s_lshl_b32 s3, s3, 16
    v_cvt_pk_bf16_f32 v92, v92, v93
    v_cvt_pk_bf16_f32 v93, v94, v95
    buffer_store_dwordx2 v[92:93], v218, s[80:83], s3 offen offset:0 sc1
    v_cvt_pk_bf16_f32 v108, v108, v109
    v_cvt_pk_bf16_f32 v109, v110, v111
    buffer_store_dwordx2 v[108:109], v218, s[80:83], s3 offen offset:512 sc1
    v_pk_fma_f32 v[162:163], v[188:189], v[22:23], v[192:193]
    v_pk_fma_f32 v[96:97], v[96:97], v[20:21], v[162:163]
    v_pk_fma_f32 v[164:165], v[190:191], v[22:23], v[194:195]
    v_pk_fma_f32 v[98:99], v[98:99], v[20:21], v[164:165]
    v_pk_fma_f32 v[166:167], v[188:189], v[26:27], v[192:193]
    v_pk_fma_f32 v[112:113], v[112:113], v[24:25], v[166:167]
    v_pk_fma_f32 v[168:169], v[190:191], v[26:27], v[194:195]
    v_pk_fma_f32 v[114:115], v[114:115], v[24:25], v[168:169]
    v_pk_mul_f32 v[162:163], v[96:97], v[96:97]
    v_pk_mul_f32 v[164:165], v[98:99], v[98:99]
    v_pk_mul_f32 v[166:167], v[112:113], v[112:113]
    v_pk_mul_f32 v[168:169], v[114:115], v[114:115]
    v_pk_fma_f32 v[162:163], v[162:163], s[72:73], v[176:177]
    v_pk_fma_f32 v[164:165], v[164:165], s[72:73], v[176:177]
    v_pk_fma_f32 v[166:167], v[166:167], s[72:73], v[176:177]
    v_pk_fma_f32 v[168:169], v[168:169], s[72:73], v[176:177]
    v_pk_mul_f32 v[162:163], v[162:163], v[96:97]
    v_pk_mul_f32 v[164:165], v[164:165], v[98:99]
    v_pk_mul_f32 v[166:167], v[166:167], v[112:113]
    v_pk_mul_f32 v[168:169], v[168:169], v[114:115]
    v_exp_f32 v162, v162
    v_exp_f32 v163, v163
    v_exp_f32 v164, v164
    v_exp_f32 v165, v165
    v_exp_f32 v166, v166
    v_exp_f32 v167, v167
    v_exp_f32 v168, v168
    v_exp_f32 v169, v169
    v_pk_add_f32 v[162:163], v[162:163], s[74:75]
    v_pk_add_f32 v[164:165], v[164:165], s[74:75]
    v_pk_add_f32 v[166:167], v[166:167], s[74:75]
    v_pk_add_f32 v[168:169], v[168:169], s[74:75]
    v_rcp_f32 v162, v162
    v_rcp_f32 v163, v163
    v_rcp_f32 v164, v164
    v_rcp_f32 v165, v165
    v_rcp_f32 v166, v166
    v_rcp_f32 v167, v167
    v_rcp_f32 v168, v168
    v_rcp_f32 v169, v169
    v_pk_mul_f32 v[96:97], v[96:97], v[162:163]
    v_pk_mul_f32 v[98:99], v[98:99], v[164:165]
    v_pk_mul_f32 v[112:113], v[112:113], v[166:167]
    v_pk_mul_f32 v[114:115], v[114:115], v[168:169]
    s_min_u32 s3, s69, 1
    s_add_u32 s3, s3, s71
    s_lshl_b32 s3, s3, 16
    v_cvt_pk_bf16_f32 v96, v96, v97
    v_cvt_pk_bf16_f32 v97, v98, v99
    buffer_store_dwordx2 v[96:97], v218, s[80:83], s3 offen offset:0 sc1
    v_cvt_pk_bf16_f32 v112, v112, v113
    v_cvt_pk_bf16_f32 v113, v114, v115
    buffer_store_dwordx2 v[112:113], v218, s[80:83], s3 offen offset:512 sc1
    v_pk_fma_f32 v[162:163], v[196:197], v[22:23], v[200:201]
    v_pk_fma_f32 v[100:101], v[100:101], v[20:21], v[162:163]
    v_pk_fma_f32 v[164:165], v[198:199], v[22:23], v[202:203]
    v_pk_fma_f32 v[102:103], v[102:103], v[20:21], v[164:165]
    v_pk_fma_f32 v[166:167], v[196:197], v[26:27], v[200:201]
    v_pk_fma_f32 v[116:117], v[116:117], v[24:25], v[166:167]
    v_pk_fma_f32 v[168:169], v[198:199], v[26:27], v[202:203]
    v_pk_fma_f32 v[118:119], v[118:119], v[24:25], v[168:169]
    v_pk_mul_f32 v[162:163], v[100:101], v[100:101]
    v_pk_mul_f32 v[164:165], v[102:103], v[102:103]
    v_pk_mul_f32 v[166:167], v[116:117], v[116:117]
    v_pk_mul_f32 v[168:169], v[118:119], v[118:119]
    v_pk_fma_f32 v[162:163], v[162:163], s[72:73], v[176:177]
    v_pk_fma_f32 v[164:165], v[164:165], s[72:73], v[176:177]
    v_pk_fma_f32 v[166:167], v[166:167], s[72:73], v[176:177]
    v_pk_fma_f32 v[168:169], v[168:169], s[72:73], v[176:177]
    v_pk_mul_f32 v[162:163], v[162:163], v[100:101]
    v_pk_mul_f32 v[164:165], v[164:165], v[102:103]
    v_pk_mul_f32 v[166:167], v[166:167], v[116:117]
    v_pk_mul_f32 v[168:169], v[168:169], v[118:119]
    v_exp_f32 v162, v162
    v_exp_f32 v163, v163
    v_exp_f32 v164, v164
    v_exp_f32 v165, v165
    v_exp_f32 v166, v166
    v_exp_f32 v167, v167
    v_exp_f32 v168, v168
    v_exp_f32 v169, v169
    v_pk_add_f32 v[162:163], v[162:163], s[74:75]
    v_pk_add_f32 v[164:165], v[164:165], s[74:75]
    v_pk_add_f32 v[166:167], v[166:167], s[74:75]
    v_pk_add_f32 v[168:169], v[168:169], s[74:75]
    v_rcp_f32 v162, v162
    v_rcp_f32 v163, v163
    v_rcp_f32 v164, v164
    v_rcp_f32 v165, v165
    v_rcp_f32 v166, v166
    v_rcp_f32 v167, v167
    v_rcp_f32 v168, v168
    v_rcp_f32 v169, v169
    v_pk_mul_f32 v[100:101], v[100:101], v[162:163]
    v_pk_mul_f32 v[102:103], v[102:103], v[164:165]
    v_pk_mul_f32 v[116:117], v[116:117], v[166:167]
    v_pk_mul_f32 v[118:119], v[118:119], v[168:169]
    s_min_u32 s3, s69, 2
    s_add_u32 s3, s3, s71
    s_lshl_b32 s3, s3, 16
    v_cvt_pk_bf16_f32 v100, v100, v101
    v_cvt_pk_bf16_f32 v101, v102, v103
    buffer_store_dwordx2 v[100:101], v218, s[80:83], s3 offen offset:0 sc1
    v_cvt_pk_bf16_f32 v116, v116, v117
    v_cvt_pk_bf16_f32 v117, v118, v119
    buffer_store_dwordx2 v[116:117], v218, s[80:83], s3 offen offset:512 sc1
    v_pk_fma_f32 v[162:163], v[204:205], v[22:23], v[208:209]
    v_pk_fma_f32 v[104:105], v[104:105], v[20:21], v[162:163]
    v_pk_fma_f32 v[164:165], v[206:207], v[22:23], v[210:211]
    v_pk_fma_f32 v[106:107], v[106:107], v[20:21], v[164:165]
    v_pk_fma_f32 v[166:167], v[204:205], v[26:27], v[208:209]
    v_pk_fma_f32 v[120:121], v[120:121], v[24:25], v[166:167]
    v_pk_fma_f32 v[168:169], v[206:207], v[26:27], v[210:211]
    v_pk_fma_f32 v[122:123], v[122:123], v[24:25], v[168:169]
    v_pk_mul_f32 v[162:163], v[104:105], v[104:105]
    v_pk_mul_f32 v[164:165], v[106:107], v[106:107]
    v_pk_mul_f32 v[166:167], v[120:121], v[120:121]
    v_pk_mul_f32 v[168:169], v[122:123], v[122:123]
    v_pk_fma_f32 v[162:163], v[162:163], s[72:73], v[176:177]
    v_pk_fma_f32 v[164:165], v[164:165], s[72:73], v[176:177]
    v_pk_fma_f32 v[166:167], v[166:167], s[72:73], v[176:177]
    v_pk_fma_f32 v[168:169], v[168:169], s[72:73], v[176:177]
    v_pk_mul_f32 v[162:163], v[162:163], v[104:105]
    v_pk_mul_f32 v[164:165], v[164:165], v[106:107]
    v_pk_mul_f32 v[166:167], v[166:167], v[120:121]
    v_pk_mul_f32 v[168:169], v[168:169], v[122:123]
    v_exp_f32 v162, v162
    v_exp_f32 v163, v163
    v_exp_f32 v164, v164
    v_exp_f32 v165, v165
    v_exp_f32 v166, v166
    v_exp_f32 v167, v167
    v_exp_f32 v168, v168
    v_exp_f32 v169, v169
    v_pk_add_f32 v[162:163], v[162:163], s[74:75]
    v_pk_add_f32 v[164:165], v[164:165], s[74:75]
    v_pk_add_f32 v[166:167], v[166:167], s[74:75]
    v_pk_add_f32 v[168:169], v[168:169], s[74:75]
    v_rcp_f32 v162, v162
    v_rcp_f32 v163, v163
    v_rcp_f32 v164, v164
    v_rcp_f32 v165, v165
    v_rcp_f32 v166, v166
    v_rcp_f32 v167, v167
    v_rcp_f32 v168, v168
    v_rcp_f32 v169, v169
    v_pk_mul_f32 v[104:105], v[104:105], v[162:163]
    v_pk_mul_f32 v[106:107], v[106:107], v[164:165]
    v_pk_mul_f32 v[120:121], v[120:121], v[166:167]
    v_pk_mul_f32 v[122:123], v[122:123], v[168:169]
    s_min_u32 s3, s69, 3
    s_add_u32 s3, s3, s71
    s_lshl_b32 s3, s3, 16
    v_cvt_pk_bf16_f32 v104, v104, v105
    v_cvt_pk_bf16_f32 v105, v106, v107
    buffer_store_dwordx2 v[104:105], v218, s[80:83], s3 offen offset:0 sc1
    v_cvt_pk_bf16_f32 v120, v120, v121
    v_cvt_pk_bf16_f32 v121, v122, v123
    buffer_store_dwordx2 v[120:121], v218, s[80:83], s3 offen offset:512 sc1
    s_cmp_eq_u32 s55, 0
    s_cbranch_scc0 kgA_nd0
    s_mov_b32 s3, 0
    buffer_store_dwordx4 a[0:3], v5, s[64:67], s3 offen sc1
    buffer_store_dwordx4 a[4:7], v5, s[64:67], s3 offen offset:1024 sc1
kgA_nd0:
    s_cmp_eq_u32 s55, 1
    s_cbranch_scc0 kgA_nd1
    s_mov_b32 s3, 131072
    buffer_store_dwordx4 a[8:11], v5, s[64:67], s3 offen sc1
    buffer_store_dwordx4 a[12:15], v5, s[64:67], s3 offen offset:1024 sc1
kgA_nd1:
    s_cmp_eq_u32 s55, 2
    s_cbranch_scc0 kgA_nd2
    s_mov_b32 s3, 262144
    buffer_store_dwordx4 a[16:19], v5, s[64:67], s3 offen sc1
    buffer_store_dwordx4 a[20:23], v5, s[64:67], s3 offen offset:1024 sc1
kgA_nd2:
    s_cmp_eq_u32 s55, 3
    s_cbranch_scc0 kgA_nd3
    s_mov_b32 s3, 393216
    buffer_store_dwordx4 a[24:27], v5, s[64:67], s3 offen sc1
    buffer_store_dwordx4 a[28:31], v5, s[64:67], s3 offen offset:1024 sc1
kgA_nd3:
    s_cmp_eq_u32 s55, 4
    s_cbranch_scc0 kgA_nd4
    s_mov_b32 s3, 524288
    buffer_store_dwordx4 a[32:35], v5, s[64:67], s3 offen sc1
    buffer_store_dwordx4 a[36:39], v5, s[64:67], s3 offen offset:1024 sc1
kgA_nd4:
    s_cmp_eq_u32 s55, 5
    s_cbranch_scc0 kgA_nd5
    s_mov_b32 s3, 655360
    buffer_store_dwordx4 a[40:43], v5, s[64:67], s3 offen sc1
    buffer_store_dwordx4 a[44:47], v5, s[64:67], s3 offen offset:1024 sc1
kgA_nd5:
    s_cmp_eq_u32 s55, 6
    s_cbranch_scc0 kgA_nd6
    s_mov_b32 s3, 786432
    buffer_store_dwordx4 a[48:51], v5, s[64:67], s3 offen sc1
    buffer_store_dwordx4 a[52:55], v5, s[64:67], s3 offen offset:1024 sc1
kgA_nd6:
    s_cmp_eq_u32 s55, 7
    s_cbranch_scc0 kgA_nd7
    s_mov_b32 s3, 917504
    buffer_store_dwordx4 a[56:59], v5, s[64:67], s3 offen sc1
    buffer_store_dwordx4 a[60:63], v5, s[64:67], s3 offen offset:1024 sc1
kgA_nd7:
    s_cmp_eq_u32 s55, 8
    s_cbranch_scc0 kgA_nd8
    s_mov_b32 s3, 1048576
    buffer_store_dwordx4 a[64:67], v5, s[64:67], s3 offen sc1
    buffer_store_dwordx4 a[68:71], v5, s[64:67], s3 offen offset:1024 sc1
kgA_nd8:
    s_cmp_eq_u32 s55, 9
    s_cbranch_scc0 kgA_nd9
    s_mov_b32 s3, 1179648
    buffer_store_dwordx4 a[72:75], v5, s[64:67], s3 offen sc1
    buffer_store_dwordx4 a[76:79], v5, s[64:67], s3 offen offset:1024 sc1
kgA_nd9:
    s_cmp_eq_u32 s55, 10
    s_cbranch_scc0 kgA_nd10
    s_mov_b32 s3, 1310720
    buffer_store_dwordx4 a[80:83], v5, s[64:67], s3 offen sc1
    buffer_store_dwordx4 a[84:87], v5, s[64:67], s3 offen offset:1024 sc1
kgA_nd10:
    s_cmp_eq_u32 s55, 11
    s_cbranch_scc0 kgA_nd11
    s_mov_b32 s3, 1441792
    buffer_store_dwordx4 a[88:91], v5, s[64:67], s3 offen sc1
    buffer_store_dwordx4 a[92:95], v5, s[64:67], s3 offen offset:1024 sc1
kgA_nd11:
    s_cmp_eq_u32 s55, 12
    s_cbranch_scc0 kgA_nd12
    s_mov_b32 s3, 1572864
    buffer_store_dwordx4 a[96:99], v5, s[64:67], s3 offen sc1
    buffer_store_dwordx4 a[100:103], v5, s[64:67], s3 offen offset:1024 sc1
kgA_nd12:
    s_cmp_eq_u32 s55, 13
    s_cbranch_scc0 kgA_nd13
    s_mov_b32 s3, 1703936
    buffer_store_dwordx4 a[104:107], v5, s[64:67], s3 offen sc1
    buffer_store_dwordx4 a[108:111], v5, s[64:67], s3 offen offset:1024 sc1
kgA_nd13:
    s_cmp_eq_u32 s55, 14
    s_cbranch_scc0 kgA_nd14
    s_mov_b32 s3, 1835008
    buffer_store_dwordx4 a[112:115], v5, s[64:67], s3 offen sc1
    buffer_store_dwordx4 a[116:119], v5, s[64:67], s3 offen offset:1024 sc1
kgA_nd14:
    s_cmp_eq_u32 s55, 15
    s_cbranch_scc0 kgA_nd15
    s_mov_b32 s3, 1966080
    buffer_store_dwordx4 a[120:123], v5, s[64:67], s3 offen sc1
    buffer_store_dwordx4 a[124:127], v5, s[64:67], s3 offen offset:1024 sc1
kgA_nd15:
    s_cmp_eq_u32 s55, 0
    s_cbranch_scc0 kgA_nd16
    s_mov_b32 s3, 2097152
    buffer_store_dwordx4 a[128:131], v5, s[64:67], s3 offen sc1
    buffer_store_dwordx4 a[132:135], v5, s[64:67], s3 offen offset:1024 sc1
kgA_nd16:
    s_cmp_eq_u32 s55, 1
    s_cbranch_scc0 kgA_nd17
    s_mov_b32 s3, 2228224
    buffer_store_dwordx4 a[136:139], v5, s[64:67], s3 offen sc1
    buffer_store_dwordx4 a[140:143], v5, s[64:67], s3 offen offset:1024 sc1
kgA_nd17:
    s_cmp_eq_u32 s55, 2
    s_cbranch_scc0 kgA_nd18
    s_mov_b32 s3, 2359296
    buffer_store_dwordx4 a[144:147], v5, s[64:67], s3 offen sc1
    buffer_store_dwordx4 a[148:151], v5, s[64:67], s3 offen offset:1024 sc1
kgA_nd18:
    s_cmp_eq_u32 s55, 3
    s_cbranch_scc0 kgA_nd19
    s_mov_b32 s3, 2490368
    buffer_store_dwordx4 a[152:155], v5, s[64:67], s3 offen sc1
    buffer_store_dwordx4 a[156:159], v5, s[64:67], s3 offen offset:1024 sc1
kgA_nd19:
    s_lshl_b32 s54, s9, 4
    s_add_u32 s54, s54, s55
    s_lshl_b32 s54, s54, 2
    s_add_u32 s54, s54, 8192
    s_add_u32 s60, s52, 20234240
    s_addc_u32 s61, s53, 0
    s_mov_b32 s62, 3538944
    s_mov_b32 s63, 0x00020000
    s_add_u32 s64, s52, 16695296
    s_addc_u32 s65, s53, 0
    s_mov_b32 s66, 3538944
    s_mov_b32 s67, 0x00020000
    s_add_u32 s68, s52, 23773184
    s_addc_u32 s69, s53, 0
    s_mov_b32 s70, 3538944
    s_mov_b32 s71, 0x00020000
    s_mov_b32 s72, s40
    s_mov_b32 s73, s41
    s_mov_b32 s74, 4096
    s_mov_b32 s75, 0x00020000
    s_mul_i32 s8, s99, 7
    s_min_u32 s8, s8, 47
    v_add_u32 v3, 4096, v12
    v_lshrrev_b32 v8, 2, v13
    v_lshlrev_b32 v8, 3, v8
    v_and_b32 v9, 3, v13
    v_add_u32 v8, v8, v9
    v_lshrrev_b32 v11, 1, v13
    v_xor_b32 v11, v11, v14
    v_lshlrev_b32 v11, 4, v11
    v_lshl_add_u32 v6, v13, 7, v11
    v_add_u32 v6, s96, v6
    v_xor_b32 v7, 64, v6
    v_add_u32 v222, 65536, v6
    v_add_u32 v223, 65536, v7
    s_mul_i32 s12, s4, 864
    s_add_u32 s12, s12, s8
    s_lshl_b32 s12, s12, 10
    s_lshl_b32 s9, s98, 2
    s_add_u32 s9, s9, s4
    s_lshl_b32 s13, s9, 10
    v_add_u32 v10, s13, v12
    v_lshrrev_b32 v217, 1, v10
    s_lshr_b32 s13, s4, 1
    s_lshl_b32 s13, s13, 5
    s_and_b32 s15, s4, 1
    s_lshl_b32 s15, s15, 2
    s_add_u32 s13, s13, s15
    s_lshl_b32 s15, s98, 6
    s_add_u32 s13, s13, s15
    s_lshl_b32 s13, s13, 1
    v_lshlrev_b32 v9, 1, v8
    buffer_load_ushort v206, v9, s[72:75], s13 offen
    s_lshl_b32 s10, s4, 12
    s_add_u32 s10, s10, 98304
    v_lshlrev_b32 v4, 5, v14
    v_add_u32 v4, s10, v4
    v_lshlrev_b32 v5, 4, v14
    v_mov_b32 v16, 114688
    s_add_u32 s5, s10, 2048
    v_mov_b32 v17, s5
    v_cmp_eq_u32 vcc, 0, v13
    s_nop 1
    v_cndmask_b32 v16, v16, v17, vcc
    v_add_u32 v17, 1024, v17
    v_cmp_eq_u32 vcc, 1, v13
    s_nop 1
    v_cndmask_b32 v16, v16, v17, vcc
    v_add_u32 v5, v5, v16
    v_mov_b32 v16, 0
    v_mov_b32 v17, 0
    v_mov_b32 v18, 0
    v_mov_b32 v19, 0
    v_add_u32 v15, 114688, v12
    ds_write_b128 v15, v[16:19]
    s_lshl_b32 s5, s4, 10
    s_lshr_b32 s6, s9, 1
    s_lshl_b32 s6, s6, 6
    s_lshl_b32 s7, s99, 3
    s_add_u32 s6, s6, s7
    v_and_b32 v2, 1, v1
    v_lshlrev_b32 v2, 2, v2
    s_waitcnt lgkmcnt(0)
    s_add_u32 s11, s6, 8192
    s_mov_b32 s3, 0
kg_pollB:
    buffer_load_dwordx4 v[48:51], v12, s[84:87], s5 offen sc1
    s_waitcnt vmcnt(0)
    v_min_u32 v48, v48, v49
    v_min3_u32 v48, v48, v50, v51
    v_cmp_eq_u32 vcc, 0, v48
    s_nop 0
    s_cmp_eq_u64 vcc, 0
    s_cbranch_scc1 kg_rdyB
    s_add_u32 s3, s3, 1
    s_cmp_lt_u32 s3, 100000
    s_cbranch_scc0 kg_rdyB
    s_sleep 32
    s_branch kg_pollB
kg_rdyB:
    v_mov_b32 v15, 0
    v_mov_b32 v16, 1
    s_mov_b64 exec, 1
    buffer_store_dword v16, v15, s[84:87], s54 offen sc1
    s_mov_b64 exec, -1
    ds_read_b128 v[16:19], v6 offset:0
    ds_read_b128 v[20:23], v6 offset:2048
    ds_read_b128 v[24:27], v6 offset:4096
    ds_read_b128 v[28:31], v6 offset:6144
    s_lshl_b32 s5, s4, 12
    v_lshlrev_b32 v15, 6, v1
    buffer_load_dwordx4 v[132:135], v15, s[76:79], s5 offen offset:0 sc1
    buffer_load_dwordx4 v[136:139], v15, s[76:79], s5 offen offset:16 sc1
    buffer_load_dwordx4 v[140:143], v15, s[76:79], s5 offen offset:32 sc1
    buffer_load_dwordx4 v[144:147], v15, s[76:79], s5 offen offset:48 sc1
    buffer_load_dwordx4 v[48:51], v12, s[60:63], s12 offen offset:0 sc1
    buffer_load_dwordx4 v[52:55], v12, s[60:63], s12 offen offset:1024 sc1
    buffer_load_dwordx4 v[56:59], v12, s[60:63], s12 offen offset:2048 sc1
    buffer_load_dwordx4 v[60:63], v12, s[60:63], s12 offen offset:3072 sc1
    buffer_load_dwordx4 v[64:67], v3, s[60:63], s12 offen offset:0 sc1
    buffer_load_dwordx4 v[68:71], v3, s[60:63], s12 offen offset:1024 sc1
    buffer_load_dwordx4 v[72:75], v3, s[60:63], s12 offen offset:2048 sc1
    s_add_u32 s12, s12, 55296
    buffer_load_dwordx4 v[76:79], v12, s[60:63], s12 offen offset:0 sc1
    buffer_load_dwordx4 v[80:83], v12, s[60:63], s12 offen offset:1024 sc1
    buffer_load_dwordx4 v[84:87], v12, s[60:63], s12 offen offset:2048 sc1
    buffer_load_dwordx4 v[88:91], v12, s[60:63], s12 offen offset:3072 sc1
    buffer_load_dwordx4 v[92:95], v3, s[60:63], s12 offen offset:0 sc1
    buffer_load_dwordx4 v[96:99], v3, s[60:63], s12 offen offset:1024 sc1
    buffer_load_dwordx4 v[100:103], v3, s[60:63], s12 offen offset:2048 sc1
    s_add_u32 s12, s12, 55296
    s_waitcnt vmcnt(14)
    v_mul_f32 v132, 0x3a97b426, v132
    v_mov_b32 v15, 0x3727c5ac
    v_fmac_f32 v15, 0x3a97b426, v133
    v_fma_f32 v15, -v132, v132, v15
    v_max_f32 v15, 0x3727c5ac, v15
    v_rsq_f32 v148, v15
    v_mul_f32 v134, 0x3a97b426, v134
    v_mov_b32 v15, 0x3727c5ac
    v_fmac_f32 v15, 0x3a97b426, v135
    v_fma_f32 v15, -v134, v134, v15
    v_max_f32 v15, 0x3727c5ac, v15
    v_rsq_f32 v149, v15
    v_mul_f32 v136, 0x3a97b426, v136
    v_mov_b32 v15, 0x3727c5ac
    v_fmac_f32 v15, 0x3a97b426, v137
    v_fma_f32 v15, -v136, v136, v15
    v_max_f32 v15, 0x3727c5ac, v15
    v_rsq_f32 v150, v15
    v_mul_f32 v138, 0x3a97b426, v138
    v_mov_b32 v15, 0x3727c5ac
    v_fmac_f32 v15, 0x3a97b426, v139
    v_fma_f32 v15, -v138, v138, v15
    v_max_f32 v15, 0x3727c5ac, v15
    v_rsq_f32 v151, v15
    v_mul_f32 v140, 0x3a97b426, v140
    v_mov_b32 v15, 0x3727c5ac
    v_fmac_f32 v15, 0x3a97b426, v141
    v_fma_f32 v15, -v140, v140, v15
    v_max_f32 v15, 0x3727c5ac, v15
    v_rsq_f32 v152, v15
    v_mul_f32 v142, 0x3a97b426, v142
    v_mov_b32 v15, 0x3727c5ac
    v_fmac_f32 v15, 0x3a97b426, v143
    v_fma_f32 v15, -v142, v142, v15
    v_max_f32 v15, 0x3727c5ac, v15
    v_rsq_f32 v153, v15
    v_mul_f32 v144, 0x3a97b426, v144
    v_mov_b32 v15, 0x3727c5ac
    v_fmac_f32 v15, 0x3a97b426, v145
    v_fma_f32 v15, -v144, v144, v15
    v_max_f32 v15, 0x3727c5ac, v15
    v_rsq_f32 v154, v15
    v_mul_f32 v146, 0x3a97b426, v146
    v_mov_b32 v15, 0x3727c5ac
    v_fmac_f32 v15, 0x3a97b426, v147
    v_fma_f32 v15, -v146, v146, v15
    v_max_f32 v15, 0x3727c5ac, v15
    v_rsq_f32 v155, v15
    v_cvt_pk_bf16_f32 v156, v132, v134
    v_lshlrev_b32 v133, 16, v156
    v_and_b32 v135, 0xffff0000, v156
    v_sub_f32 v132, v132, v133
    v_sub_f32 v134, v134, v135
    v_cvt_pk_bf16_f32 v184, v132, v134
    v_cvt_pk_bf16_f32 v157, v136, v138
    v_lshlrev_b32 v137, 16, v157
    v_and_b32 v139, 0xffff0000, v157
    v_sub_f32 v136, v136, v137
    v_sub_f32 v138, v138, v139
    v_cvt_pk_bf16_f32 v185, v136, v138
    v_cvt_pk_bf16_f32 v158, v140, v142
    v_lshlrev_b32 v141, 16, v158
    v_and_b32 v143, 0xffff0000, v158
    v_sub_f32 v140, v140, v141
    v_sub_f32 v142, v142, v143
    v_cvt_pk_bf16_f32 v186, v140, v142
    v_cvt_pk_bf16_f32 v159, v144, v146
    v_lshlrev_b32 v145, 16, v159
    v_and_b32 v147, 0xffff0000, v159
    v_sub_f32 v144, v144, v145
    v_sub_f32 v146, v146, v147
    v_cvt_pk_bf16_f32 v187, v144, v146
    v_lshlrev_b32 v15, 5, v1
    v_add_u32 v15, s10, v15
    ds_write_b128 v15, v[148:151]
    ds_write_b128 v15, v[152:155] offset:16
    v_add_u32 v15, s10, v12
    ds_write_b128 v15, v[156:159] offset:2048
    ds_write_b128 v15, v[184:187] offset:3072
    s_waitcnt lgkmcnt(0)
    ds_read_b128 v[160:163], v4 offset:0
    ds_read_b128 v[164:167], v4 offset:16
    ds_read_b128 v[176:179], v5 offset:0
    s_waitcnt lgkmcnt(0)
    v_lshlrev_b32 v184, 16, v16
    v_and_b32 v185, 0xffff0000, v16
    v_pk_mul_f32 v[184:185], v[184:185], v[160:161]
    v_cvt_pk_bf16_f32 v16, v184, v185
    v_lshlrev_b32 v186, 16, v17
    v_and_b32 v187, 0xffff0000, v17
    v_pk_mul_f32 v[186:187], v[186:187], v[162:163]
    v_cvt_pk_bf16_f32 v17, v186, v187
    v_lshlrev_b32 v188, 16, v18
    v_and_b32 v189, 0xffff0000, v18
    v_pk_mul_f32 v[188:189], v[188:189], v[164:165]
    v_cvt_pk_bf16_f32 v18, v188, v189
    v_lshlrev_b32 v190, 16, v19
    v_and_b32 v191, 0xffff0000, v19
    v_pk_mul_f32 v[190:191], v[190:191], v[166:167]
    v_cvt_pk_bf16_f32 v19, v190, v191
    v_lshlrev_b32 v184, 16, v20
    v_and_b32 v185, 0xffff0000, v20
    v_pk_mul_f32 v[184:185], v[184:185], v[160:161]
    v_cvt_pk_bf16_f32 v20, v184, v185
    v_lshlrev_b32 v186, 16, v21
    v_and_b32 v187, 0xffff0000, v21
    v_pk_mul_f32 v[186:187], v[186:187], v[162:163]
    v_cvt_pk_bf16_f32 v21, v186, v187
    v_lshlrev_b32 v188, 16, v22
    v_and_b32 v189, 0xffff0000, v22
    v_pk_mul_f32 v[188:189], v[188:189], v[164:165]
    v_cvt_pk_bf16_f32 v22, v188, v189
    v_lshlrev_b32 v190, 16, v23
    v_and_b32 v191, 0xffff0000, v23
    v_pk_mul_f32 v[190:191], v[190:191], v[166:167]
    v_cvt_pk_bf16_f32 v23, v190, v191
    v_lshlrev_b32 v184, 16, v24
    v_and_b32 v185, 0xffff0000, v24
    v_pk_mul_f32 v[184:185], v[184:185], v[160:161]
    v_cvt_pk_bf16_f32 v24, v184, v185
    v_lshlrev_b32 v186, 16, v25
    v_and_b32 v187, 0xffff0000, v25
    v_pk_mul_f32 v[186:187], v[186:187], v[162:163]
    v_cvt_pk_bf16_f32 v25, v186, v187
    v_lshlrev_b32 v188, 16, v26
    v_and_b32 v189, 0xffff0000, v26
    v_pk_mul_f32 v[188:189], v[188:189], v[164:165]
    v_cvt_pk_bf16_f32 v26, v188, v189
    v_lshlrev_b32 v190, 16, v27
    v_and_b32 v191, 0xffff0000, v27
    v_pk_mul_f32 v[190:191], v[190:191], v[166:167]
    v_cvt_pk_bf16_f32 v27, v190, v191
    v_lshlrev_b32 v184, 16, v28
    v_and_b32 v185, 0xffff0000, v28
    v_pk_mul_f32 v[184:185], v[184:185], v[160:161]
    v_cvt_pk_bf16_f32 v28, v184, v185
    v_lshlrev_b32 v186, 16, v29
    v_and_b32 v187, 0xffff0000, v29
    v_pk_mul_f32 v[186:187], v[186:187], v[162:163]
    v_cvt_pk_bf16_f32 v29, v186, v187
    v_lshlrev_b32 v188, 16, v30
    v_and_b32 v189, 0xffff0000, v30
    v_pk_mul_f32 v[188:189], v[188:189], v[164:165]
    v_cvt_pk_bf16_f32 v30, v188, v189
    v_lshlrev_b32 v190, 16, v31
    v_and_b32 v191, 0xffff0000, v31
    v_pk_mul_f32 v[190:191], v[190:191], v[166:167]
    v_cvt_pk_bf16_f32 v31, v190, v191
    s_waitcnt vmcnt(7)
    v_mfma_f32_16x16x32_bf16 a[0:3], v[48:51], v[16:19], 0
    ds_read_b128 v[32:35], v7 offset:0
    v_mfma_f32_16x16x32_bf16 a[4:7], v[52:55], v[16:19], 0
    ds_read_b128 v[36:39], v7 offset:2048
    v_mfma_f32_16x16x32_bf16 a[8:11], v[56:59], v[16:19], 0
    ds_read_b128 v[40:43], v7 offset:4096
    v_mfma_f32_16x16x32_bf16 a[12:15], v[60:63], v[16:19], 0
    ds_read_b128 v[44:47], v7 offset:6144
    v_mfma_f32_16x16x32_bf16 a[16:19], v[64:67], v[16:19], 0
    ds_read_b128 v[168:171], v4 offset:128
    v_mfma_f32_16x16x32_bf16 a[20:23], v[68:71], v[16:19], 0
    ds_read_b128 v[172:175], v4 offset:144
    v_mfma_f32_16x16x32_bf16 a[24:27], v[72:75], v[16:19], 0
    ds_read_b128 v[180:183], v5 offset:64
    v_mfma_f32_16x16x32_bf16 a[112:115], v[176:179], v[16:19], 0
    buffer_load_dwordx4 v[104:107], v12, s[60:63], s12 offen offset:0 sc1
    v_mfma_f32_16x16x32_bf16 a[28:31], v[48:51], v[20:23], 0
    buffer_load_dwordx4 v[108:111], v12, s[60:63], s12 offen offset:1024 sc1
    v_mfma_f32_16x16x32_bf16 a[32:35], v[52:55], v[20:23], 0
    buffer_load_dwordx4 v[112:115], v12, s[60:63], s12 offen offset:2048 sc1
    v_mfma_f32_16x16x32_bf16 a[36:39], v[56:59], v[20:23], 0
    buffer_load_dwordx4 v[116:119], v12, s[60:63], s12 offen offset:3072 sc1
    v_mfma_f32_16x16x32_bf16 a[40:43], v[60:63], v[20:23], 0
    buffer_load_dwordx4 v[120:123], v3, s[60:63], s12 offen offset:0 sc1
    v_mfma_f32_16x16x32_bf16 a[44:47], v[64:67], v[20:23], 0
    buffer_load_dwordx4 v[124:127], v3, s[60:63], s12 offen offset:1024 sc1
    v_mfma_f32_16x16x32_bf16 a[48:51], v[68:71], v[20:23], 0
    buffer_load_dwordx4 v[128:131], v3, s[60:63], s12 offen offset:2048 sc1
    s_add_u32 s12, s12, 55296
    s_waitcnt lgkmcnt(0)
    v_mfma_f32_16x16x32_bf16 a[52:55], v[72:75], v[20:23], 0
    buffer_load_dwordx4 v[132:135], v12, s[60:63], s12 offen offset:0 sc1
    v_lshlrev_b32 v184, 16, v32
    v_and_b32 v185, 0xffff0000, v32
    v_pk_mul_f32 v[184:185], v[184:185], v[168:169]
    v_cvt_pk_bf16_f32 v32, v184, v185
    v_mfma_f32_16x16x32_bf16 a[116:119], v[176:179], v[20:23], 0
    buffer_load_dwordx4 v[136:139], v12, s[60:63], s12 offen offset:1024 sc1
    v_lshlrev_b32 v186, 16, v33
    v_and_b32 v187, 0xffff0000, v33
    v_pk_mul_f32 v[186:187], v[186:187], v[170:171]
    v_cvt_pk_bf16_f32 v33, v186, v187
    v_mfma_f32_16x16x32_bf16 a[56:59], v[48:51], v[24:27], 0
    buffer_load_dwordx4 v[140:143], v12, s[60:63], s12 offen offset:2048 sc1
    v_lshlrev_b32 v188, 16, v34
    v_and_b32 v189, 0xffff0000, v34
    v_pk_mul_f32 v[188:189], v[188:189], v[172:173]
    v_cvt_pk_bf16_f32 v34, v188, v189
    v_mfma_f32_16x16x32_bf16 a[60:63], v[52:55], v[24:27], 0
    buffer_load_dwordx4 v[144:147], v12, s[60:63], s12 offen offset:3072 sc1
    v_lshlrev_b32 v190, 16, v35
    v_and_b32 v191, 0xffff0000, v35
    v_pk_mul_f32 v[190:191], v[190:191], v[174:175]
    v_cvt_pk_bf16_f32 v35, v190, v191
    v_mfma_f32_16x16x32_bf16 a[64:67], v[56:59], v[24:27], 0
    buffer_load_dwordx4 v[148:151], v3, s[60:63], s12 offen offset:0 sc1
    v_lshlrev_b32 v184, 16, v36
    v_and_b32 v185, 0xffff0000, v36
    v_pk_mul_f32 v[184:185], v[184:185], v[168:169]
    v_cvt_pk_bf16_f32 v36, v184, v185
    v_mfma_f32_16x16x32_bf16 a[68:71], v[60:63], v[24:27], 0
    buffer_load_dwordx4 v[152:155], v3, s[60:63], s12 offen offset:1024 sc1
    v_lshlrev_b32 v186, 16, v37
    v_and_b32 v187, 0xffff0000, v37
    v_pk_mul_f32 v[186:187], v[186:187], v[170:171]
    v_cvt_pk_bf16_f32 v37, v186, v187
    v_mfma_f32_16x16x32_bf16 a[72:75], v[64:67], v[24:27], 0
    buffer_load_dwordx4 v[156:159], v3, s[60:63], s12 offen offset:2048 sc1
    s_add_u32 s12, s12, 55296
    v_lshlrev_b32 v188, 16, v38
    v_and_b32 v189, 0xffff0000, v38
    v_pk_mul_f32 v[188:189], v[188:189], v[172:173]
    v_cvt_pk_bf16_f32 v38, v188, v189
    v_mfma_f32_16x16x32_bf16 a[76:79], v[68:71], v[24:27], 0
    s_add_u32 m0, s96, 65536
    s_add_u32 s14, s97, 256
    buffer_load_dwordx4 v220, s[88:91], s14 offen lds
    v_lshlrev_b32 v190, 16, v39
    v_and_b32 v191, 0xffff0000, v39
    v_pk_mul_f32 v[190:191], v[190:191], v[174:175]
    v_cvt_pk_bf16_f32 v39, v190, v191
    v_mfma_f32_16x16x32_bf16 a[80:83], v[72:75], v[24:27], 0
    s_add_u32 m0, s96, 66560
    s_add_u32 s14, s97, 256
    buffer_load_dwordx4 v221, s[88:91], s14 offen lds
    v_lshlrev_b32 v184, 16, v40
    v_and_b32 v185, 0xffff0000, v40
    v_pk_mul_f32 v[184:185], v[184:185], v[168:169]
    v_cvt_pk_bf16_f32 v40, v184, v185
    v_mfma_f32_16x16x32_bf16 a[120:123], v[176:179], v[24:27], 0
    s_add_u32 m0, s96, 67584
    s_add_u32 s14, s97, 16640
    buffer_load_dwordx4 v220, s[88:91], s14 offen lds
    v_lshlrev_b32 v186, 16, v41
    v_and_b32 v187, 0xffff0000, v41
    v_pk_mul_f32 v[186:187], v[186:187], v[170:171]
    v_cvt_pk_bf16_f32 v41, v186, v187
    v_mfma_f32_16x16x32_bf16 a[84:87], v[48:51], v[28:31], 0
    s_add_u32 m0, s96, 68608
    s_add_u32 s14, s97, 16640
    buffer_load_dwordx4 v221, s[88:91], s14 offen lds
    v_lshlrev_b32 v188, 16, v42
    v_and_b32 v189, 0xffff0000, v42
    v_pk_mul_f32 v[188:189], v[188:189], v[172:173]
    v_mfma_f32_16x16x32_bf16 a[88:91], v[52:55], v[28:31], 0
    s_add_u32 m0, s96, 69632
    s_add_u32 s14, s97, 131328
    buffer_load_dwordx4 v220, s[88:91], s14 offen lds
    v_cvt_pk_bf16_f32 v42, v188, v189
    v_lshlrev_b32 v190, 16, v43
    v_and_b32 v191, 0xffff0000, v43
    v_mfma_f32_16x16x32_bf16 a[92:95], v[56:59], v[28:31], 0
    s_add_u32 m0, s96, 70656
    s_add_u32 s14, s97, 131328
    buffer_load_dwordx4 v221, s[88:91], s14 offen lds
    v_pk_mul_f32 v[190:191], v[190:191], v[174:175]
    v_cvt_pk_bf16_f32 v43, v190, v191
    v_lshlrev_b32 v184, 16, v44
    v_mfma_f32_16x16x32_bf16 a[96:99], v[60:63], v[28:31], 0
    s_add_u32 m0, s96, 71680
    s_add_u32 s14, s97, 147712
    buffer_load_dwordx4 v220, s[88:91], s14 offen lds
    v_and_b32 v185, 0xffff0000, v44
    v_pk_mul_f32 v[184:185], v[184:185], v[168:169]
    v_cvt_pk_bf16_f32 v44, v184, v185
    v_mfma_f32_16x16x32_bf16 a[100:103], v[64:67], v[28:31], 0
    s_add_u32 m0, s96, 72704
    s_add_u32 s14, s97, 147712
    buffer_load_dwordx4 v221, s[88:91], s14 offen lds
    v_lshlrev_b32 v186, 16, v45
    v_and_b32 v187, 0xffff0000, v45
    v_pk_mul_f32 v[186:187], v[186:187], v[170:171]
    v_mfma_f32_16x16x32_bf16 a[104:107], v[68:71], v[28:31], 0
    v_cvt_pk_bf16_f32 v45, v186, v187
    v_lshlrev_b32 v188, 16, v46
    v_and_b32 v189, 0xffff0000, v46
    v_mfma_f32_16x16x32_bf16 a[108:111], v[72:75], v[28:31], 0
    v_pk_mul_f32 v[188:189], v[188:189], v[172:173]
    v_cvt_pk_bf16_f32 v46, v188, v189
    v_lshlrev_b32 v190, 16, v47
    v_mfma_f32_16x16x32_bf16 a[124:127], v[176:179], v[28:31], 0
    v_and_b32 v191, 0xffff0000, v47
    v_pk_mul_f32 v[190:191], v[190:191], v[174:175]
    v_cvt_pk_bf16_f32 v47, v190, v191
    s_waitcnt vmcnt(22)
    v_mfma_f32_16x16x32_bf16 a[0:3], v[76:79], v[32:35], a[0:3]
    ds_read_b128 v[16:19], v6 offset:32768
    v_mfma_f32_16x16x32_bf16 a[4:7], v[80:83], v[32:35], a[4:7]
    ds_read_b128 v[20:23], v6 offset:34816
    v_mfma_f32_16x16x32_bf16 a[8:11], v[84:87], v[32:35], a[8:11]
    ds_read_b128 v[24:27], v6 offset:36864
    v_mfma_f32_16x16x32_bf16 a[12:15], v[88:91], v[32:35], a[12:15]
    ds_read_b128 v[28:31], v6 offset:38912
    v_mfma_f32_16x16x32_bf16 a[16:19], v[92:95], v[32:35], a[16:19]
    ds_read_b128 v[160:163], v4 offset:256
    v_mfma_f32_16x16x32_bf16 a[20:23], v[96:99], v[32:35], a[20:23]
    ds_read_b128 v[164:167], v4 offset:272
    v_mfma_f32_16x16x32_bf16 a[24:27], v[100:103], v[32:35], a[24:27]
    ds_read_b128 v[176:179], v5 offset:128
    v_mfma_f32_16x16x32_bf16 a[112:115], v[180:183], v[32:35], a[112:115]
    buffer_load_dwordx4 v[48:51], v12, s[60:63], s12 offen offset:0 sc1
    v_mfma_f32_16x16x32_bf16 a[28:31], v[76:79], v[36:39], a[28:31]
    buffer_load_dwordx4 v[52:55], v12, s[60:63], s12 offen offset:1024 sc1
    v_mfma_f32_16x16x32_bf16 a[32:35], v[80:83], v[36:39], a[32:35]
    buffer_load_dwordx4 v[56:59], v12, s[60:63], s12 offen offset:2048 sc1
    v_mfma_f32_16x16x32_bf16 a[36:39], v[84:87], v[36:39], a[36:39]
    buffer_load_dwordx4 v[60:63], v12, s[60:63], s12 offen offset:3072 sc1
    v_mfma_f32_16x16x32_bf16 a[40:43], v[88:91], v[36:39], a[40:43]
    buffer_load_dwordx4 v[64:67], v3, s[60:63], s12 offen offset:0 sc1
    v_mfma_f32_16x16x32_bf16 a[44:47], v[92:95], v[36:39], a[44:47]
    buffer_load_dwordx4 v[68:71], v3, s[60:63], s12 offen offset:1024 sc1
    v_mfma_f32_16x16x32_bf16 a[48:51], v[96:99], v[36:39], a[48:51]
    buffer_load_dwordx4 v[72:75], v3, s[60:63], s12 offen offset:2048 sc1
    s_add_u32 s12, s12, 55296
    s_waitcnt lgkmcnt(0)
    v_mfma_f32_16x16x32_bf16 a[52:55], v[100:103], v[36:39], a[52:55]
    v_lshlrev_b32 v184, 16, v16
    v_and_b32 v185, 0xffff0000, v16
    v_pk_mul_f32 v[184:185], v[184:185], v[160:161]
    v_cvt_pk_bf16_f32 v16, v184, v185
    v_mfma_f32_16x16x32_bf16 a[116:119], v[180:183], v[36:39], a[116:119]
    v_lshlrev_b32 v186, 16, v17
    v_and_b32 v187, 0xffff0000, v17
    v_pk_mul_f32 v[186:187], v[186:187], v[162:163]
    v_cvt_pk_bf16_f32 v17, v186, v187
    v_mfma_f32_16x16x32_bf16 a[56:59], v[76:79], v[40:43], a[56:59]
    v_lshlrev_b32 v188, 16, v18
    v_and_b32 v189, 0xffff0000, v18
    v_pk_mul_f32 v[188:189], v[188:189], v[164:165]
    v_cvt_pk_bf16_f32 v18, v188, v189
    v_mfma_f32_16x16x32_bf16 a[60:63], v[80:83], v[40:43], a[60:63]
    v_lshlrev_b32 v190, 16, v19
    v_and_b32 v191, 0xffff0000, v19
    v_pk_mul_f32 v[190:191], v[190:191], v[166:167]
    v_cvt_pk_bf16_f32 v19, v190, v191
    v_mfma_f32_16x16x32_bf16 a[64:67], v[84:87], v[40:43], a[64:67]
    v_lshlrev_b32 v184, 16, v20
    v_and_b32 v185, 0xffff0000, v20
    v_pk_mul_f32 v[184:185], v[184:185], v[160:161]
    v_cvt_pk_bf16_f32 v20, v184, v185
    v_mfma_f32_16x16x32_bf16 a[68:71], v[88:91], v[40:43], a[68:71]
    v_lshlrev_b32 v186, 16, v21
    v_and_b32 v187, 0xffff0000, v21
    v_pk_mul_f32 v[186:187], v[186:187], v[162:163]
    v_cvt_pk_bf16_f32 v21, v186, v187
    v_mfma_f32_16x16x32_bf16 a[72:75], v[92:95], v[40:43], a[72:75]
    v_lshlrev_b32 v188, 16, v22
    v_and_b32 v189, 0xffff0000, v22
    v_pk_mul_f32 v[188:189], v[188:189], v[164:165]
    v_cvt_pk_bf16_f32 v22, v188, v189
    v_mfma_f32_16x16x32_bf16 a[76:79], v[96:99], v[40:43], a[76:79]
    v_lshlrev_b32 v190, 16, v23
    v_and_b32 v191, 0xffff0000, v23
    v_pk_mul_f32 v[190:191], v[190:191], v[166:167]
    v_cvt_pk_bf16_f32 v23, v190, v191
    v_mfma_f32_16x16x32_bf16 a[80:83], v[100:103], v[40:43], a[80:83]
    v_lshlrev_b32 v184, 16, v24
    v_and_b32 v185, 0xffff0000, v24
    v_pk_mul_f32 v[184:185], v[184:185], v[160:161]
    v_cvt_pk_bf16_f32 v24, v184, v185
    v_mfma_f32_16x16x32_bf16 a[120:123], v[180:183], v[40:43], a[120:123]
    v_lshlrev_b32 v186, 16, v25
    v_and_b32 v187, 0xffff0000, v25
    v_pk_mul_f32 v[186:187], v[186:187], v[162:163]
    v_cvt_pk_bf16_f32 v25, v186, v187
    v_mfma_f32_16x16x32_bf16 a[84:87], v[76:79], v[44:47], a[84:87]
    v_lshlrev_b32 v188, 16, v26
    v_and_b32 v189, 0xffff0000, v26
    v_pk_mul_f32 v[188:189], v[188:189], v[164:165]
    v_mfma_f32_16x16x32_bf16 a[88:91], v[80:83], v[44:47], a[88:91]
    v_cvt_pk_bf16_f32 v26, v188, v189
    v_lshlrev_b32 v190, 16, v27
    v_and_b32 v191, 0xffff0000, v27
    v_mfma_f32_16x16x32_bf16 a[92:95], v[84:87], v[44:47], a[92:95]
    v_pk_mul_f32 v[190:191], v[190:191], v[166:167]
    v_cvt_pk_bf16_f32 v27, v190, v191
    v_lshlrev_b32 v184, 16, v28
    v_mfma_f32_16x16x32_bf16 a[96:99], v[88:91], v[44:47], a[96:99]
    v_and_b32 v185, 0xffff0000, v28
    v_pk_mul_f32 v[184:185], v[184:185], v[160:161]
    v_cvt_pk_bf16_f32 v28, v184, v185
    v_mfma_f32_16x16x32_bf16 a[100:103], v[92:95], v[44:47], a[100:103]
    v_lshlrev_b32 v186, 16, v29
    v_and_b32 v187, 0xffff0000, v29
    v_pk_mul_f32 v[186:187], v[186:187], v[162:163]
    v_mfma_f32_16x16x32_bf16 a[104:107], v[96:99], v[44:47], a[104:107]
    v_cvt_pk_bf16_f32 v29, v186, v187
    v_lshlrev_b32 v188, 16, v30
    v_and_b32 v189, 0xffff0000, v30
    v_mfma_f32_16x16x32_bf16 a[108:111], v[100:103], v[44:47], a[108:111]
    v_pk_mul_f32 v[188:189], v[188:189], v[164:165]
    v_cvt_pk_bf16_f32 v30, v188, v189
    v_lshlrev_b32 v190, 16, v31
    v_mfma_f32_16x16x32_bf16 a[124:127], v[180:183], v[44:47], a[124:127]
    v_and_b32 v191, 0xffff0000, v31
    v_pk_mul_f32 v[190:191], v[190:191], v[166:167]
    v_cvt_pk_bf16_f32 v31, v190, v191
    s_waitcnt vmcnt(22)
    v_mfma_f32_16x16x32_bf16 a[0:3], v[104:107], v[16:19], a[0:3]
    ds_read_b128 v[32:35], v7 offset:32768
    v_mfma_f32_16x16x32_bf16 a[4:7], v[108:111], v[16:19], a[4:7]
    ds_read_b128 v[36:39], v7 offset:34816
    v_mfma_f32_16x16x32_bf16 a[8:11], v[112:115], v[16:19], a[8:11]
    ds_read_b128 v[40:43], v7 offset:36864
    v_mfma_f32_16x16x32_bf16 a[12:15], v[116:119], v[16:19], a[12:15]
    ds_read_b128 v[44:47], v7 offset:38912
    v_mfma_f32_16x16x32_bf16 a[16:19], v[120:123], v[16:19], a[16:19]
    ds_read_b128 v[168:171], v4 offset:384
    v_mfma_f32_16x16x32_bf16 a[20:23], v[124:127], v[16:19], a[20:23]
    ds_read_b128 v[172:175], v4 offset:400
    v_mfma_f32_16x16x32_bf16 a[24:27], v[128:131], v[16:19], a[24:27]
    ds_read_b128 v[180:183], v5 offset:192
    v_mfma_f32_16x16x32_bf16 a[112:115], v[176:179], v[16:19], a[112:115]
    buffer_load_dwordx4 v[76:79], v12, s[60:63], s12 offen offset:0 sc1
    v_mfma_f32_16x16x32_bf16 a[28:31], v[104:107], v[20:23], a[28:31]
    buffer_load_dwordx4 v[80:83], v12, s[60:63], s12 offen offset:1024 sc1
    v_mfma_f32_16x16x32_bf16 a[32:35], v[108:111], v[20:23], a[32:35]
    buffer_load_dwordx4 v[84:87], v12, s[60:63], s12 offen offset:2048 sc1
    v_mfma_f32_16x16x32_bf16 a[36:39], v[112:115], v[20:23], a[36:39]
    buffer_load_dwordx4 v[88:91], v12, s[60:63], s12 offen offset:3072 sc1
    v_mfma_f32_16x16x32_bf16 a[40:43], v[116:119], v[20:23], a[40:43]
    buffer_load_dwordx4 v[92:95], v3, s[60:63], s12 offen offset:0 sc1
    v_mfma_f32_16x16x32_bf16 a[44:47], v[120:123], v[20:23], a[44:47]
    buffer_load_dwordx4 v[96:99], v3, s[60:63], s12 offen offset:1024 sc1
    v_mfma_f32_16x16x32_bf16 a[48:51], v[124:127], v[20:23], a[48:51]
    buffer_load_dwordx4 v[100:103], v3, s[60:63], s12 offen offset:2048 sc1
    s_add_u32 s12, s12, 55296
    s_waitcnt lgkmcnt(0)
    v_mfma_f32_16x16x32_bf16 a[52:55], v[128:131], v[20:23], a[52:55]
    s_add_u32 m0, s96, 0
    s_add_u32 s14, s97, 384
    buffer_load_dwordx4 v220, s[88:91], s14 offen lds
    v_lshlrev_b32 v184, 16, v32
    v_and_b32 v185, 0xffff0000, v32
    v_pk_mul_f32 v[184:185], v[184:185], v[168:169]
    v_cvt_pk_bf16_f32 v32, v184, v185
    v_mfma_f32_16x16x32_bf16 a[116:119], v[176:179], v[20:23], a[116:119]
    s_add_u32 m0, s96, 1024
    s_add_u32 s14, s97, 384
    buffer_load_dwordx4 v221, s[88:91], s14 offen lds
    v_lshlrev_b32 v186, 16, v33
    v_and_b32 v187, 0xffff0000, v33
    v_pk_mul_f32 v[186:187], v[186:187], v[170:171]
    v_cvt_pk_bf16_f32 v33, v186, v187
    v_mfma_f32_16x16x32_bf16 a[56:59], v[104:107], v[24:27], a[56:59]
    s_add_u32 m0, s96, 2048
    s_add_u32 s14, s97, 16768
    buffer_load_dwordx4 v220, s[88:91], s14 offen lds
    v_lshlrev_b32 v188, 16, v34
    v_and_b32 v189, 0xffff0000, v34
    v_pk_mul_f32 v[188:189], v[188:189], v[172:173]
    v_cvt_pk_bf16_f32 v34, v188, v189
    v_mfma_f32_16x16x32_bf16 a[60:63], v[108:111], v[24:27], a[60:63]
    s_add_u32 m0, s96, 3072
    s_add_u32 s14, s97, 16768
    buffer_load_dwordx4 v221, s[88:91], s14 offen lds
    v_lshlrev_b32 v190, 16, v35
    v_and_b32 v191, 0xffff0000, v35
    v_pk_mul_f32 v[190:191], v[190:191], v[174:175]
    v_cvt_pk_bf16_f32 v35, v190, v191
    v_mfma_f32_16x16x32_bf16 a[64:67], v[112:115], v[24:27], a[64:67]
    s_add_u32 m0, s96, 4096
    s_add_u32 s14, s97, 131456
    buffer_load_dwordx4 v220, s[88:91], s14 offen lds
    v_lshlrev_b32 v184, 16, v36
    v_and_b32 v185, 0xffff0000, v36
    v_pk_mul_f32 v[184:185], v[184:185], v[168:169]
    v_cvt_pk_bf16_f32 v36, v184, v185
    v_mfma_f32_16x16x32_bf16 a[68:71], v[116:119], v[24:27], a[68:71]
    s_add_u32 m0, s96, 5120
    s_add_u32 s14, s97, 131456
    buffer_load_dwordx4 v221, s[88:91], s14 offen lds
    v_lshlrev_b32 v186, 16, v37
    v_and_b32 v187, 0xffff0000, v37
    v_pk_mul_f32 v[186:187], v[186:187], v[170:171]
    v_cvt_pk_bf16_f32 v37, v186, v187
    v_mfma_f32_16x16x32_bf16 a[72:75], v[120:123], v[24:27], a[72:75]
    s_add_u32 m0, s96, 6144
    s_add_u32 s14, s97, 147840
    buffer_load_dwordx4 v220, s[88:91], s14 offen lds
    v_lshlrev_b32 v188, 16, v38
    v_and_b32 v189, 0xffff0000, v38
    v_pk_mul_f32 v[188:189], v[188:189], v[172:173]
    v_cvt_pk_bf16_f32 v38, v188, v189
    v_mfma_f32_16x16x32_bf16 a[76:79], v[124:127], v[24:27], a[76:79]
    s_add_u32 m0, s96, 7168
    s_add_u32 s14, s97, 147840
    buffer_load_dwordx4 v221, s[88:91], s14 offen lds
    v_lshlrev_b32 v190, 16, v39
    v_and_b32 v191, 0xffff0000, v39
    v_pk_mul_f32 v[190:191], v[190:191], v[174:175]
    v_cvt_pk_bf16_f32 v39, v190, v191
    v_mfma_f32_16x16x32_bf16 a[80:83], v[128:131], v[24:27], a[80:83]
    v_lshlrev_b32 v184, 16, v40
    v_and_b32 v185, 0xffff0000, v40
    v_pk_mul_f32 v[184:185], v[184:185], v[168:169]
    v_cvt_pk_bf16_f32 v40, v184, v185
    v_mfma_f32_16x16x32_bf16 a[120:123], v[176:179], v[24:27], a[120:123]
    v_lshlrev_b32 v186, 16, v41
    v_and_b32 v187, 0xffff0000, v41
    v_pk_mul_f32 v[186:187], v[186:187], v[170:171]
    v_cvt_pk_bf16_f32 v41, v186, v187
    v_mfma_f32_16x16x32_bf16 a[84:87], v[104:107], v[28:31], a[84:87]
    v_lshlrev_b32 v188, 16, v42
    v_and_b32 v189, 0xffff0000, v42
    v_pk_mul_f32 v[188:189], v[188:189], v[172:173]
    v_mfma_f32_16x16x32_bf16 a[88:91], v[108:111], v[28:31], a[88:91]
    v_cvt_pk_bf16_f32 v42, v188, v189
    v_lshlrev_b32 v190, 16, v43
    v_and_b32 v191, 0xffff0000, v43
    v_mfma_f32_16x16x32_bf16 a[92:95], v[112:115], v[28:31], a[92:95]
    v_pk_mul_f32 v[190:191], v[190:191], v[174:175]
    v_cvt_pk_bf16_f32 v43, v190, v191
    v_lshlrev_b32 v184, 16, v44
    v_mfma_f32_16x16x32_bf16 a[96:99], v[116:119], v[28:31], a[96:99]
    v_and_b32 v185, 0xffff0000, v44
    v_pk_mul_f32 v[184:185], v[184:185], v[168:169]
    v_cvt_pk_bf16_f32 v44, v184, v185
    v_mfma_f32_16x16x32_bf16 a[100:103], v[120:123], v[28:31], a[100:103]
    v_lshlrev_b32 v186, 16, v45
    v_and_b32 v187, 0xffff0000, v45
    v_pk_mul_f32 v[186:187], v[186:187], v[170:171]
    v_mfma_f32_16x16x32_bf16 a[104:107], v[124:127], v[28:31], a[104:107]
    v_cvt_pk_bf16_f32 v45, v186, v187
    v_lshlrev_b32 v188, 16, v46
    v_and_b32 v189, 0xffff0000, v46
    v_mfma_f32_16x16x32_bf16 a[108:111], v[128:131], v[28:31], a[108:111]
    v_pk_mul_f32 v[188:189], v[188:189], v[172:173]
    v_cvt_pk_bf16_f32 v46, v188, v189
    v_lshlrev_b32 v190, 16, v47
    v_mfma_f32_16x16x32_bf16 a[124:127], v[176:179], v[28:31], a[124:127]
    v_and_b32 v191, 0xffff0000, v47
    v_pk_mul_f32 v[190:191], v[190:191], v[174:175]
    v_cvt_pk_bf16_f32 v47, v190, v191
    s_waitcnt vmcnt(22)
    v_mfma_f32_16x16x32_bf16 a[0:3], v[132:135], v[32:35], a[0:3]
    ds_read_b128 v[16:19], v222 offset:0
    v_mfma_f32_16x16x32_bf16 a[4:7], v[136:139], v[32:35], a[4:7]
    ds_read_b128 v[20:23], v222 offset:2048
    v_mfma_f32_16x16x32_bf16 a[8:11], v[140:143], v[32:35], a[8:11]
    ds_read_b128 v[24:27], v222 offset:4096
    v_mfma_f32_16x16x32_bf16 a[12:15], v[144:147], v[32:35], a[12:15]
    ds_read_b128 v[28:31], v222 offset:6144
    v_mfma_f32_16x16x32_bf16 a[16:19], v[148:151], v[32:35], a[16:19]
    ds_read_b128 v[160:163], v4 offset:512
    v_mfma_f32_16x16x32_bf16 a[20:23], v[152:155], v[32:35], a[20:23]
    ds_read_b128 v[164:167], v4 offset:528
    v_mfma_f32_16x16x32_bf16 a[24:27], v[156:159], v[32:35], a[24:27]
    ds_read_b128 v[176:179], v5 offset:256
    v_mfma_f32_16x16x32_bf16 a[112:115], v[180:183], v[32:35], a[112:115]
    buffer_load_dwordx4 v[104:107], v12, s[60:63], s12 offen offset:0 sc1
    v_mfma_f32_16x16x32_bf16 a[28:31], v[132:135], v[36:39], a[28:31]
    buffer_load_dwordx4 v[108:111], v12, s[60:63], s12 offen offset:1024 sc1
    v_mfma_f32_16x16x32_bf16 a[32:35], v[136:139], v[36:39], a[32:35]
    buffer_load_dwordx4 v[112:115], v12, s[60:63], s12 offen offset:2048 sc1
    v_mfma_f32_16x16x32_bf16 a[36:39], v[140:143], v[36:39], a[36:39]
    buffer_load_dwordx4 v[116:119], v12, s[60:63], s12 offen offset:3072 sc1
    v_mfma_f32_16x16x32_bf16 a[40:43], v[144:147], v[36:39], a[40:43]
    buffer_load_dwordx4 v[120:123], v3, s[60:63], s12 offen offset:0 sc1
    v_mfma_f32_16x16x32_bf16 a[44:47], v[148:151], v[36:39], a[44:47]
    buffer_load_dwordx4 v[124:127], v3, s[60:63], s12 offen offset:1024 sc1
    v_mfma_f32_16x16x32_bf16 a[48:51], v[152:155], v[36:39], a[48:51]
    buffer_load_dwordx4 v[128:131], v3, s[60:63], s12 offen offset:2048 sc1
    s_add_u32 s12, s12, 55296
    s_waitcnt lgkmcnt(0)
    v_mfma_f32_16x16x32_bf16 a[52:55], v[156:159], v[36:39], a[52:55]
    v_lshlrev_b32 v184, 16, v16
    v_and_b32 v185, 0xffff0000, v16
    v_pk_mul_f32 v[184:185], v[184:185], v[160:161]
    v_cvt_pk_bf16_f32 v16, v184, v185
    v_mfma_f32_16x16x32_bf16 a[116:119], v[180:183], v[36:39], a[116:119]
    v_lshlrev_b32 v186, 16, v17
    v_and_b32 v187, 0xffff0000, v17
    v_pk_mul_f32 v[186:187], v[186:187], v[162:163]
    v_cvt_pk_bf16_f32 v17, v186, v187
    v_mfma_f32_16x16x32_bf16 a[56:59], v[132:135], v[40:43], a[56:59]
    v_lshlrev_b32 v188, 16, v18
    v_and_b32 v189, 0xffff0000, v18
    v_pk_mul_f32 v[188:189], v[188:189], v[164:165]
    v_cvt_pk_bf16_f32 v18, v188, v189
    v_mfma_f32_16x16x32_bf16 a[60:63], v[136:139], v[40:43], a[60:63]
    v_lshlrev_b32 v190, 16, v19
    v_and_b32 v191, 0xffff0000, v19
    v_pk_mul_f32 v[190:191], v[190:191], v[166:167]
    v_cvt_pk_bf16_f32 v19, v190, v191
    v_mfma_f32_16x16x32_bf16 a[64:67], v[140:143], v[40:43], a[64:67]
    v_lshlrev_b32 v184, 16, v20
    v_and_b32 v185, 0xffff0000, v20
    v_pk_mul_f32 v[184:185], v[184:185], v[160:161]
    v_cvt_pk_bf16_f32 v20, v184, v185
    v_mfma_f32_16x16x32_bf16 a[68:71], v[144:147], v[40:43], a[68:71]
    v_lshlrev_b32 v186, 16, v21
    v_and_b32 v187, 0xffff0000, v21
    v_pk_mul_f32 v[186:187], v[186:187], v[162:163]
    v_cvt_pk_bf16_f32 v21, v186, v187
    v_mfma_f32_16x16x32_bf16 a[72:75], v[148:151], v[40:43], a[72:75]
    v_lshlrev_b32 v188, 16, v22
    v_and_b32 v189, 0xffff0000, v22
    v_pk_mul_f32 v[188:189], v[188:189], v[164:165]
    v_cvt_pk_bf16_f32 v22, v188, v189
    v_mfma_f32_16x16x32_bf16 a[76:79], v[152:155], v[40:43], a[76:79]
    v_lshlrev_b32 v190, 16, v23
    v_and_b32 v191, 0xffff0000, v23
    v_pk_mul_f32 v[190:191], v[190:191], v[166:167]
    v_cvt_pk_bf16_f32 v23, v190, v191
    v_mfma_f32_16x16x32_bf16 a[80:83], v[156:159], v[40:43], a[80:83]
    v_lshlrev_b32 v184, 16, v24
    v_and_b32 v185, 0xffff0000, v24
    v_pk_mul_f32 v[184:185], v[184:185], v[160:161]
    v_cvt_pk_bf16_f32 v24, v184, v185
    v_mfma_f32_16x16x32_bf16 a[120:123], v[180:183], v[40:43], a[120:123]
    v_lshlrev_b32 v186, 16, v25
    v_and_b32 v187, 0xffff0000, v25
    v_pk_mul_f32 v[186:187], v[186:187], v[162:163]
    v_cvt_pk_bf16_f32 v25, v186, v187
    v_mfma_f32_16x16x32_bf16 a[84:87], v[132:135], v[44:47], a[84:87]
    v_lshlrev_b32 v188, 16, v26
    v_and_b32 v189, 0xffff0000, v26
    v_pk_mul_f32 v[188:189], v[188:189], v[164:165]
    v_mfma_f32_16x16x32_bf16 a[88:91], v[136:139], v[44:47], a[88:91]
    v_cvt_pk_bf16_f32 v26, v188, v189
    v_lshlrev_b32 v190, 16, v27
    v_and_b32 v191, 0xffff0000, v27
    v_mfma_f32_16x16x32_bf16 a[92:95], v[140:143], v[44:47], a[92:95]
    v_pk_mul_f32 v[190:191], v[190:191], v[166:167]
    v_cvt_pk_bf16_f32 v27, v190, v191
    v_lshlrev_b32 v184, 16, v28
    v_mfma_f32_16x16x32_bf16 a[96:99], v[144:147], v[44:47], a[96:99]
    v_and_b32 v185, 0xffff0000, v28
    v_pk_mul_f32 v[184:185], v[184:185], v[160:161]
    v_cvt_pk_bf16_f32 v28, v184, v185
    v_mfma_f32_16x16x32_bf16 a[100:103], v[148:151], v[44:47], a[100:103]
    v_lshlrev_b32 v186, 16, v29
    v_and_b32 v187, 0xffff0000, v29
    v_pk_mul_f32 v[186:187], v[186:187], v[162:163]
    v_mfma_f32_16x16x32_bf16 a[104:107], v[152:155], v[44:47], a[104:107]
    v_cvt_pk_bf16_f32 v29, v186, v187
    v_lshlrev_b32 v188, 16, v30
    v_and_b32 v189, 0xffff0000, v30
    v_mfma_f32_16x16x32_bf16 a[108:111], v[156:159], v[44:47], a[108:111]
    v_pk_mul_f32 v[188:189], v[188:189], v[164:165]
    v_cvt_pk_bf16_f32 v30, v188, v189
    v_lshlrev_b32 v190, 16, v31
    v_mfma_f32_16x16x32_bf16 a[124:127], v[180:183], v[44:47], a[124:127]
    v_and_b32 v191, 0xffff0000, v31
    v_pk_mul_f32 v[190:191], v[190:191], v[166:167]
    v_cvt_pk_bf16_f32 v31, v190, v191
    s_waitcnt vmcnt(22)
    v_mfma_f32_16x16x32_bf16 a[0:3], v[48:51], v[16:19], a[0:3]
    ds_read_b128 v[32:35], v223 offset:0
    v_mfma_f32_16x16x32_bf16 a[4:7], v[52:55], v[16:19], a[4:7]
    ds_read_b128 v[36:39], v223 offset:2048
    v_mfma_f32_16x16x32_bf16 a[8:11], v[56:59], v[16:19], a[8:11]
    ds_read_b128 v[40:43], v223 offset:4096
    v_mfma_f32_16x16x32_bf16 a[12:15], v[60:63], v[16:19], a[12:15]
    ds_read_b128 v[44:47], v223 offset:6144
    v_mfma_f32_16x16x32_bf16 a[16:19], v[64:67], v[16:19], a[16:19]
    ds_read_b128 v[168:171], v4 offset:640
    v_mfma_f32_16x16x32_bf16 a[20:23], v[68:71], v[16:19], a[20:23]
    ds_read_b128 v[172:175], v4 offset:656
    v_mfma_f32_16x16x32_bf16 a[24:27], v[72:75], v[16:19], a[24:27]
    ds_read_b128 v[180:183], v5 offset:320
    v_mfma_f32_16x16x32_bf16 a[112:115], v[176:179], v[16:19], a[112:115]
    buffer_load_dwordx4 v[132:135], v12, s[60:63], s12 offen offset:0 sc1
    v_mfma_f32_16x16x32_bf16 a[28:31], v[48:51], v[20:23], a[28:31]
    buffer_load_dwordx4 v[136:139], v12, s[60:63], s12 offen offset:1024 sc1
    v_mfma_f32_16x16x32_bf16 a[32:35], v[52:55], v[20:23], a[32:35]
    buffer_load_dwordx4 v[140:143], v12, s[60:63], s12 offen offset:2048 sc1
    v_mfma_f32_16x16x32_bf16 a[36:39], v[56:59], v[20:23], a[36:39]
    buffer_load_dwordx4 v[144:147], v12, s[60:63], s12 offen offset:3072 sc1
    v_mfma_f32_16x16x32_bf16 a[40:43], v[60:63], v[20:23], a[40:43]
    buffer_load_dwordx4 v[148:151], v3, s[60:63], s12 offen offset:0 sc1
    v_mfma_f32_16x16x32_bf16 a[44:47], v[64:67], v[20:23], a[44:47]
    buffer_load_dwordx4 v[152:155], v3, s[60:63], s12 offen offset:1024 sc1
    v_mfma_f32_16x16x32_bf16 a[48:51], v[68:71], v[20:23], a[48:51]
    buffer_load_dwordx4 v[156:159], v3, s[60:63], s12 offen offset:2048 sc1
    s_add_u32 s12, s12, 55296
    s_waitcnt lgkmcnt(0)
    v_mfma_f32_16x16x32_bf16 a[52:55], v[72:75], v[20:23], a[52:55]
    s_add_u32 m0, s96, 32768
    s_add_u32 s14, s97, 512
    buffer_load_dwordx4 v220, s[88:91], s14 offen lds
    v_lshlrev_b32 v184, 16, v32
    v_and_b32 v185, 0xffff0000, v32
    v_pk_mul_f32 v[184:185], v[184:185], v[168:169]
    v_cvt_pk_bf16_f32 v32, v184, v185
    v_mfma_f32_16x16x32_bf16 a[116:119], v[176:179], v[20:23], a[116:119]
    s_add_u32 m0, s96, 33792
    s_add_u32 s14, s97, 512
    buffer_load_dwordx4 v221, s[88:91], s14 offen lds
    v_lshlrev_b32 v186, 16, v33
    v_and_b32 v187, 0xffff0000, v33
    v_pk_mul_f32 v[186:187], v[186:187], v[170:171]
    v_cvt_pk_bf16_f32 v33, v186, v187
    v_mfma_f32_16x16x32_bf16 a[56:59], v[48:51], v[24:27], a[56:59]
    s_add_u32 m0, s96, 34816
    s_add_u32 s14, s97, 16896
    buffer_load_dwordx4 v220, s[88:91], s14 offen lds
    v_lshlrev_b32 v188, 16, v34
    v_and_b32 v189, 0xffff0000, v34
    v_pk_mul_f32 v[188:189], v[188:189], v[172:173]
    v_cvt_pk_bf16_f32 v34, v188, v189
    v_mfma_f32_16x16x32_bf16 a[60:63], v[52:55], v[24:27], a[60:63]
    s_add_u32 m0, s96, 35840
    s_add_u32 s14, s97, 16896
    buffer_load_dwordx4 v221, s[88:91], s14 offen lds
    v_lshlrev_b32 v190, 16, v35
    v_and_b32 v191, 0xffff0000, v35
    v_pk_mul_f32 v[190:191], v[190:191], v[174:175]
    v_cvt_pk_bf16_f32 v35, v190, v191
    v_mfma_f32_16x16x32_bf16 a[64:67], v[56:59], v[24:27], a[64:67]
    s_add_u32 m0, s96, 36864
    s_add_u32 s14, s97, 131584
    buffer_load_dwordx4 v220, s[88:91], s14 offen lds
    v_lshlrev_b32 v184, 16, v36
    v_and_b32 v185, 0xffff0000, v36
    v_pk_mul_f32 v[184:185], v[184:185], v[168:169]
    v_cvt_pk_bf16_f32 v36, v184, v185
    v_mfma_f32_16x16x32_bf16 a[68:71], v[60:63], v[24:27], a[68:71]
    s_add_u32 m0, s96, 37888
    s_add_u32 s14, s97, 131584
    buffer_load_dwordx4 v221, s[88:91], s14 offen lds
    v_lshlrev_b32 v186, 16, v37
    v_and_b32 v187, 0xffff0000, v37
    v_pk_mul_f32 v[186:187], v[186:187], v[170:171]
    v_cvt_pk_bf16_f32 v37, v186, v187
    v_mfma_f32_16x16x32_bf16 a[72:75], v[64:67], v[24:27], a[72:75]
    s_add_u32 m0, s96, 38912
    s_add_u32 s14, s97, 147968
    buffer_load_dwordx4 v220, s[88:91], s14 offen lds
    v_lshlrev_b32 v188, 16, v38
    v_and_b32 v189, 0xffff0000, v38
    v_pk_mul_f32 v[188:189], v[188:189], v[172:173]
    v_cvt_pk_bf16_f32 v38, v188, v189
    v_mfma_f32_16x16x32_bf16 a[76:79], v[68:71], v[24:27], a[76:79]
    s_add_u32 m0, s96, 39936
    s_add_u32 s14, s97, 147968
    buffer_load_dwordx4 v221, s[88:91], s14 offen lds
    v_lshlrev_b32 v190, 16, v39
    v_and_b32 v191, 0xffff0000, v39
    v_pk_mul_f32 v[190:191], v[190:191], v[174:175]
    v_cvt_pk_bf16_f32 v39, v190, v191
    v_mfma_f32_16x16x32_bf16 a[80:83], v[72:75], v[24:27], a[80:83]
    v_lshlrev_b32 v184, 16, v40
    v_and_b32 v185, 0xffff0000, v40
    v_pk_mul_f32 v[184:185], v[184:185], v[168:169]
    v_cvt_pk_bf16_f32 v40, v184, v185
    v_mfma_f32_16x16x32_bf16 a[120:123], v[176:179], v[24:27], a[120:123]
    v_lshlrev_b32 v186, 16, v41
    v_and_b32 v187, 0xffff0000, v41
    v_pk_mul_f32 v[186:187], v[186:187], v[170:171]
    v_cvt_pk_bf16_f32 v41, v186, v187
    v_mfma_f32_16x16x32_bf16 a[84:87], v[48:51], v[28:31], a[84:87]
    v_lshlrev_b32 v188, 16, v42
    v_and_b32 v189, 0xffff0000, v42
    v_pk_mul_f32 v[188:189], v[188:189], v[172:173]
    v_mfma_f32_16x16x32_bf16 a[88:91], v[52:55], v[28:31], a[88:91]
    v_cvt_pk_bf16_f32 v42, v188, v189
    v_lshlrev_b32 v190, 16, v43
    v_and_b32 v191, 0xffff0000, v43
    v_mfma_f32_16x16x32_bf16 a[92:95], v[56:59], v[28:31], a[92:95]
    v_pk_mul_f32 v[190:191], v[190:191], v[174:175]
    v_cvt_pk_bf16_f32 v43, v190, v191
    v_lshlrev_b32 v184, 16, v44
    v_mfma_f32_16x16x32_bf16 a[96:99], v[60:63], v[28:31], a[96:99]
    v_and_b32 v185, 0xffff0000, v44
    v_pk_mul_f32 v[184:185], v[184:185], v[168:169]
    v_cvt_pk_bf16_f32 v44, v184, v185
    v_mfma_f32_16x16x32_bf16 a[100:103], v[64:67], v[28:31], a[100:103]
    v_lshlrev_b32 v186, 16, v45
    v_and_b32 v187, 0xffff0000, v45
    v_pk_mul_f32 v[186:187], v[186:187], v[170:171]
    v_mfma_f32_16x16x32_bf16 a[104:107], v[68:71], v[28:31], a[104:107]
    v_cvt_pk_bf16_f32 v45, v186, v187
    v_lshlrev_b32 v188, 16, v46
    v_and_b32 v189, 0xffff0000, v46
    v_mfma_f32_16x16x32_bf16 a[108:111], v[72:75], v[28:31], a[108:111]
    v_pk_mul_f32 v[188:189], v[188:189], v[172:173]
    v_cvt_pk_bf16_f32 v46, v188, v189
    v_lshlrev_b32 v190, 16, v47
    v_mfma_f32_16x16x32_bf16 a[124:127], v[176:179], v[28:31], a[124:127]
    v_and_b32 v191, 0xffff0000, v47
    v_pk_mul_f32 v[190:191], v[190:191], v[174:175]
    v_cvt_pk_bf16_f32 v47, v190, v191
    s_waitcnt vmcnt(22)
    v_mfma_f32_16x16x32_bf16 a[0:3], v[76:79], v[32:35], a[0:3]
    ds_read_b128 v[16:19], v6 offset:0
    v_mfma_f32_16x16x32_bf16 a[4:7], v[80:83], v[32:35], a[4:7]
    ds_read_b128 v[20:23], v6 offset:2048
    v_mfma_f32_16x16x32_bf16 a[8:11], v[84:87], v[32:35], a[8:11]
    ds_read_b128 v[24:27], v6 offset:4096
    v_mfma_f32_16x16x32_bf16 a[12:15], v[88:91], v[32:35], a[12:15]
    ds_read_b128 v[28:31], v6 offset:6144
    v_mfma_f32_16x16x32_bf16 a[16:19], v[92:95], v[32:35], a[16:19]
    ds_read_b128 v[160:163], v4 offset:768
    v_mfma_f32_16x16x32_bf16 a[20:23], v[96:99], v[32:35], a[20:23]
    ds_read_b128 v[164:167], v4 offset:784
    v_mfma_f32_16x16x32_bf16 a[24:27], v[100:103], v[32:35], a[24:27]
    ds_read_b128 v[176:179], v5 offset:384
    v_mfma_f32_16x16x32_bf16 a[112:115], v[180:183], v[32:35], a[112:115]
    buffer_load_dwordx4 v[48:51], v12, s[60:63], s12 offen offset:0 sc1
    v_mfma_f32_16x16x32_bf16 a[28:31], v[76:79], v[36:39], a[28:31]
    buffer_load_dwordx4 v[52:55], v12, s[60:63], s12 offen offset:1024 sc1
    v_mfma_f32_16x16x32_bf16 a[32:35], v[80:83], v[36:39], a[32:35]
    buffer_load_dwordx4 v[56:59], v12, s[60:63], s12 offen offset:2048 sc1
    v_mfma_f32_16x16x32_bf16 a[36:39], v[84:87], v[36:39], a[36:39]
    buffer_load_dwordx4 v[60:63], v12, s[60:63], s12 offen offset:3072 sc1
    v_mfma_f32_16x16x32_bf16 a[40:43], v[88:91], v[36:39], a[40:43]
    buffer_load_dwordx4 v[64:67], v3, s[60:63], s12 offen offset:0 sc1
    v_mfma_f32_16x16x32_bf16 a[44:47], v[92:95], v[36:39], a[44:47]
    buffer_load_dwordx4 v[68:71], v3, s[60:63], s12 offen offset:1024 sc1
    v_mfma_f32_16x16x32_bf16 a[48:51], v[96:99], v[36:39], a[48:51]
    buffer_load_dwordx4 v[72:75], v3, s[60:63], s12 offen offset:2048 sc1
    s_add_u32 s12, s12, 55296
    s_waitcnt lgkmcnt(0)
    v_mfma_f32_16x16x32_bf16 a[52:55], v[100:103], v[36:39], a[52:55]
    v_lshlrev_b32 v184, 16, v16
    v_and_b32 v185, 0xffff0000, v16
    v_pk_mul_f32 v[184:185], v[184:185], v[160:161]
    v_cvt_pk_bf16_f32 v16, v184, v185
    v_mfma_f32_16x16x32_bf16 a[116:119], v[180:183], v[36:39], a[116:119]
    v_lshlrev_b32 v186, 16, v17
    v_and_b32 v187, 0xffff0000, v17
    v_pk_mul_f32 v[186:187], v[186:187], v[162:163]
    v_cvt_pk_bf16_f32 v17, v186, v187
    v_mfma_f32_16x16x32_bf16 a[56:59], v[76:79], v[40:43], a[56:59]
    v_lshlrev_b32 v188, 16, v18
    v_and_b32 v189, 0xffff0000, v18
    v_pk_mul_f32 v[188:189], v[188:189], v[164:165]
    v_cvt_pk_bf16_f32 v18, v188, v189
    v_mfma_f32_16x16x32_bf16 a[60:63], v[80:83], v[40:43], a[60:63]
    v_lshlrev_b32 v190, 16, v19
    v_and_b32 v191, 0xffff0000, v19
    v_pk_mul_f32 v[190:191], v[190:191], v[166:167]
    v_cvt_pk_bf16_f32 v19, v190, v191
    v_mfma_f32_16x16x32_bf16 a[64:67], v[84:87], v[40:43], a[64:67]
    v_lshlrev_b32 v184, 16, v20
    v_and_b32 v185, 0xffff0000, v20
    v_pk_mul_f32 v[184:185], v[184:185], v[160:161]
    v_cvt_pk_bf16_f32 v20, v184, v185
    v_mfma_f32_16x16x32_bf16 a[68:71], v[88:91], v[40:43], a[68:71]
    v_lshlrev_b32 v186, 16, v21
    v_and_b32 v187, 0xffff0000, v21
    v_pk_mul_f32 v[186:187], v[186:187], v[162:163]
    v_cvt_pk_bf16_f32 v21, v186, v187
    v_mfma_f32_16x16x32_bf16 a[72:75], v[92:95], v[40:43], a[72:75]
    v_lshlrev_b32 v188, 16, v22
    v_and_b32 v189, 0xffff0000, v22
    v_pk_mul_f32 v[188:189], v[188:189], v[164:165]
    v_cvt_pk_bf16_f32 v22, v188, v189
    v_mfma_f32_16x16x32_bf16 a[76:79], v[96:99], v[40:43], a[76:79]
    v_lshlrev_b32 v190, 16, v23
    v_and_b32 v191, 0xffff0000, v23
    v_pk_mul_f32 v[190:191], v[190:191], v[166:167]
    v_cvt_pk_bf16_f32 v23, v190, v191
    v_mfma_f32_16x16x32_bf16 a[80:83], v[100:103], v[40:43], a[80:83]
    v_lshlrev_b32 v184, 16, v24
    v_and_b32 v185, 0xffff0000, v24
    v_pk_mul_f32 v[184:185], v[184:185], v[160:161]
    v_cvt_pk_bf16_f32 v24, v184, v185
    v_mfma_f32_16x16x32_bf16 a[120:123], v[180:183], v[40:43], a[120:123]
    v_lshlrev_b32 v186, 16, v25
    v_and_b32 v187, 0xffff0000, v25
    v_pk_mul_f32 v[186:187], v[186:187], v[162:163]
    v_cvt_pk_bf16_f32 v25, v186, v187
    v_mfma_f32_16x16x32_bf16 a[84:87], v[76:79], v[44:47], a[84:87]
    v_lshlrev_b32 v188, 16, v26
    v_and_b32 v189, 0xffff0000, v26
    v_pk_mul_f32 v[188:189], v[188:189], v[164:165]
    v_mfma_f32_16x16x32_bf16 a[88:91], v[80:83], v[44:47], a[88:91]
    v_cvt_pk_bf16_f32 v26, v188, v189
    v_lshlrev_b32 v190, 16, v27
    v_and_b32 v191, 0xffff0000, v27
    v_mfma_f32_16x16x32_bf16 a[92:95], v[84:87], v[44:47], a[92:95]
    v_pk_mul_f32 v[190:191], v[190:191], v[166:167]
    v_cvt_pk_bf16_f32 v27, v190, v191
    v_lshlrev_b32 v184, 16, v28
    v_mfma_f32_16x16x32_bf16 a[96:99], v[88:91], v[44:47], a[96:99]
    v_and_b32 v185, 0xffff0000, v28
    v_pk_mul_f32 v[184:185], v[184:185], v[160:161]
    v_cvt_pk_bf16_f32 v28, v184, v185
    v_mfma_f32_16x16x32_bf16 a[100:103], v[92:95], v[44:47], a[100:103]
    v_lshlrev_b32 v186, 16, v29
    v_and_b32 v187, 0xffff0000, v29
    v_pk_mul_f32 v[186:187], v[186:187], v[162:163]
    v_mfma_f32_16x16x32_bf16 a[104:107], v[96:99], v[44:47], a[104:107]
    v_cvt_pk_bf16_f32 v29, v186, v187
    v_lshlrev_b32 v188, 16, v30
    v_and_b32 v189, 0xffff0000, v30
    v_mfma_f32_16x16x32_bf16 a[108:111], v[100:103], v[44:47], a[108:111]
    v_pk_mul_f32 v[188:189], v[188:189], v[164:165]
    v_cvt_pk_bf16_f32 v30, v188, v189
    v_lshlrev_b32 v190, 16, v31
    v_mfma_f32_16x16x32_bf16 a[124:127], v[180:183], v[44:47], a[124:127]
    v_and_b32 v191, 0xffff0000, v31
    v_pk_mul_f32 v[190:191], v[190:191], v[166:167]
    v_cvt_pk_bf16_f32 v31, v190, v191
    s_waitcnt vmcnt(22)
    v_mfma_f32_16x16x32_bf16 a[0:3], v[104:107], v[16:19], a[0:3]
    ds_read_b128 v[32:35], v7 offset:0
    v_mfma_f32_16x16x32_bf16 a[4:7], v[108:111], v[16:19], a[4:7]
    ds_read_b128 v[36:39], v7 offset:2048
    v_mfma_f32_16x16x32_bf16 a[8:11], v[112:115], v[16:19], a[8:11]
    ds_read_b128 v[40:43], v7 offset:4096
    v_mfma_f32_16x16x32_bf16 a[12:15], v[116:119], v[16:19], a[12:15]
    ds_read_b128 v[44:47], v7 offset:6144
    v_mfma_f32_16x16x32_bf16 a[16:19], v[120:123], v[16:19], a[16:19]
    ds_read_b128 v[168:171], v4 offset:896
    v_mfma_f32_16x16x32_bf16 a[20:23], v[124:127], v[16:19], a[20:23]
    ds_read_b128 v[172:175], v4 offset:912
    v_mfma_f32_16x16x32_bf16 a[24:27], v[128:131], v[16:19], a[24:27]
    ds_read_b128 v[180:183], v5 offset:448
    v_mfma_f32_16x16x32_bf16 a[112:115], v[176:179], v[16:19], a[112:115]
    buffer_load_dwordx4 v[76:79], v12, s[60:63], s12 offen offset:0 sc1
    v_mfma_f32_16x16x32_bf16 a[28:31], v[104:107], v[20:23], a[28:31]
    buffer_load_dwordx4 v[80:83], v12, s[60:63], s12 offen offset:1024 sc1
    v_mfma_f32_16x16x32_bf16 a[32:35], v[108:111], v[20:23], a[32:35]
    buffer_load_dwordx4 v[84:87], v12, s[60:63], s12 offen offset:2048 sc1
    v_mfma_f32_16x16x32_bf16 a[36:39], v[112:115], v[20:23], a[36:39]
    buffer_load_dwordx4 v[88:91], v12, s[60:63], s12 offen offset:3072 sc1
    v_mfma_f32_16x16x32_bf16 a[40:43], v[116:119], v[20:23], a[40:43]
    buffer_load_dwordx4 v[92:95], v3, s[60:63], s12 offen offset:0 sc1
    v_mfma_f32_16x16x32_bf16 a[44:47], v[120:123], v[20:23], a[44:47]
    buffer_load_dwordx4 v[96:99], v3, s[60:63], s12 offen offset:1024 sc1
    v_mfma_f32_16x16x32_bf16 a[48:51], v[124:127], v[20:23], a[48:51]
    buffer_load_dwordx4 v[100:103], v3, s[60:63], s12 offen offset:2048 sc1
    s_add_u32 s12, s12, 55296
    s_waitcnt lgkmcnt(0)
    v_mfma_f32_16x16x32_bf16 a[52:55], v[128:131], v[20:23], a[52:55]
    s_add_u32 m0, s96, 65536
    s_add_u32 s14, s97, 640
    buffer_load_dwordx4 v220, s[88:91], s14 offen lds
    v_lshlrev_b32 v184, 16, v32
    v_and_b32 v185, 0xffff0000, v32
    v_pk_mul_f32 v[184:185], v[184:185], v[168:169]
    v_cvt_pk_bf16_f32 v32, v184, v185
    v_mfma_f32_16x16x32_bf16 a[116:119], v[176:179], v[20:23], a[116:119]
    s_add_u32 m0, s96, 66560
    s_add_u32 s14, s97, 640
    buffer_load_dwordx4 v221, s[88:91], s14 offen lds
    v_lshlrev_b32 v186, 16, v33
    v_and_b32 v187, 0xffff0000, v33
    v_pk_mul_f32 v[186:187], v[186:187], v[170:171]
    v_cvt_pk_bf16_f32 v33, v186, v187
    v_mfma_f32_16x16x32_bf16 a[56:59], v[104:107], v[24:27], a[56:59]
    s_add_u32 m0, s96, 67584
    s_add_u32 s14, s97, 17024
    buffer_load_dwordx4 v220, s[88:91], s14 offen lds
    v_lshlrev_b32 v188, 16, v34
    v_and_b32 v189, 0xffff0000, v34
    v_pk_mul_f32 v[188:189], v[188:189], v[172:173]
    v_cvt_pk_bf16_f32 v34, v188, v189
    v_mfma_f32_16x16x32_bf16 a[60:63], v[108:111], v[24:27], a[60:63]
    s_add_u32 m0, s96, 68608
    s_add_u32 s14, s97, 17024
    buffer_load_dwordx4 v221, s[88:91], s14 offen lds
    v_lshlrev_b32 v190, 16, v35
    v_and_b32 v191, 0xffff0000, v35
    v_pk_mul_f32 v[190:191], v[190:191], v[174:175]
    v_cvt_pk_bf16_f32 v35, v190, v191
    v_mfma_f32_16x16x32_bf16 a[64:67], v[112:115], v[24:27], a[64:67]
    s_add_u32 m0, s96, 69632
    s_add_u32 s14, s97, 131712
    buffer_load_dwordx4 v220, s[88:91], s14 offen lds
    v_lshlrev_b32 v184, 16, v36
    v_and_b32 v185, 0xffff0000, v36
    v_pk_mul_f32 v[184:185], v[184:185], v[168:169]
    v_cvt_pk_bf16_f32 v36, v184, v185
    v_mfma_f32_16x16x32_bf16 a[68:71], v[116:119], v[24:27], a[68:71]
    s_add_u32 m0, s96, 70656
    s_add_u32 s14, s97, 131712
    buffer_load_dwordx4 v221, s[88:91], s14 offen lds
    v_lshlrev_b32 v186, 16, v37
    v_and_b32 v187, 0xffff0000, v37
    v_pk_mul_f32 v[186:187], v[186:187], v[170:171]
    v_cvt_pk_bf16_f32 v37, v186, v187
    v_mfma_f32_16x16x32_bf16 a[72:75], v[120:123], v[24:27], a[72:75]
    s_add_u32 m0, s96, 71680
    s_add_u32 s14, s97, 148096
    buffer_load_dwordx4 v220, s[88:91], s14 offen lds
    v_lshlrev_b32 v188, 16, v38
    v_and_b32 v189, 0xffff0000, v38
    v_pk_mul_f32 v[188:189], v[188:189], v[172:173]
    v_cvt_pk_bf16_f32 v38, v188, v189
    v_mfma_f32_16x16x32_bf16 a[76:79], v[124:127], v[24:27], a[76:79]
    s_add_u32 m0, s96, 72704
    s_add_u32 s14, s97, 148096
    buffer_load_dwordx4 v221, s[88:91], s14 offen lds
    v_lshlrev_b32 v190, 16, v39
    v_and_b32 v191, 0xffff0000, v39
    v_pk_mul_f32 v[190:191], v[190:191], v[174:175]
    v_cvt_pk_bf16_f32 v39, v190, v191
    v_mfma_f32_16x16x32_bf16 a[80:83], v[128:131], v[24:27], a[80:83]
    v_lshlrev_b32 v184, 16, v40
    v_and_b32 v185, 0xffff0000, v40
    v_pk_mul_f32 v[184:185], v[184:185], v[168:169]
    v_cvt_pk_bf16_f32 v40, v184, v185
    v_mfma_f32_16x16x32_bf16 a[120:123], v[176:179], v[24:27], a[120:123]
    v_lshlrev_b32 v186, 16, v41
    v_and_b32 v187, 0xffff0000, v41
    v_pk_mul_f32 v[186:187], v[186:187], v[170:171]
    v_cvt_pk_bf16_f32 v41, v186, v187
    v_mfma_f32_16x16x32_bf16 a[84:87], v[104:107], v[28:31], a[84:87]
    v_lshlrev_b32 v188, 16, v42
    v_and_b32 v189, 0xffff0000, v42
    v_pk_mul_f32 v[188:189], v[188:189], v[172:173]
    v_mfma_f32_16x16x32_bf16 a[88:91], v[108:111], v[28:31], a[88:91]
    v_cvt_pk_bf16_f32 v42, v188, v189
    v_lshlrev_b32 v190, 16, v43
    v_and_b32 v191, 0xffff0000, v43
    v_mfma_f32_16x16x32_bf16 a[92:95], v[112:115], v[28:31], a[92:95]
    v_pk_mul_f32 v[190:191], v[190:191], v[174:175]
    v_cvt_pk_bf16_f32 v43, v190, v191
    v_lshlrev_b32 v184, 16, v44
    v_mfma_f32_16x16x32_bf16 a[96:99], v[116:119], v[28:31], a[96:99]
    v_and_b32 v185, 0xffff0000, v44
    v_pk_mul_f32 v[184:185], v[184:185], v[168:169]
    v_cvt_pk_bf16_f32 v44, v184, v185
    v_mfma_f32_16x16x32_bf16 a[100:103], v[120:123], v[28:31], a[100:103]
    v_lshlrev_b32 v186, 16, v45
    v_and_b32 v187, 0xffff0000, v45
    v_pk_mul_f32 v[186:187], v[186:187], v[170:171]
    v_mfma_f32_16x16x32_bf16 a[104:107], v[124:127], v[28:31], a[104:107]
    v_cvt_pk_bf16_f32 v45, v186, v187
    v_lshlrev_b32 v188, 16, v46
    v_and_b32 v189, 0xffff0000, v46
    v_mfma_f32_16x16x32_bf16 a[108:111], v[128:131], v[28:31], a[108:111]
    v_pk_mul_f32 v[188:189], v[188:189], v[172:173]
    v_cvt_pk_bf16_f32 v46, v188, v189
    v_lshlrev_b32 v190, 16, v47
    v_mfma_f32_16x16x32_bf16 a[124:127], v[176:179], v[28:31], a[124:127]
    v_and_b32 v191, 0xffff0000, v47
    v_pk_mul_f32 v[190:191], v[190:191], v[174:175]
    v_cvt_pk_bf16_f32 v47, v190, v191
    s_waitcnt vmcnt(22)
    v_mfma_f32_16x16x32_bf16 a[0:3], v[132:135], v[32:35], a[0:3]
    ds_read_b128 v[16:19], v6 offset:32768
    v_mfma_f32_16x16x32_bf16 a[4:7], v[136:139], v[32:35], a[4:7]
    ds_read_b128 v[20:23], v6 offset:34816
    v_mfma_f32_16x16x32_bf16 a[8:11], v[140:143], v[32:35], a[8:11]
    ds_read_b128 v[24:27], v6 offset:36864
    v_mfma_f32_16x16x32_bf16 a[12:15], v[144:147], v[32:35], a[12:15]
    ds_read_b128 v[28:31], v6 offset:38912
    v_mfma_f32_16x16x32_bf16 a[16:19], v[148:151], v[32:35], a[16:19]
    ds_read_b128 v[160:163], v4 offset:1024
    v_mfma_f32_16x16x32_bf16 a[20:23], v[152:155], v[32:35], a[20:23]
    ds_read_b128 v[164:167], v4 offset:1040
    v_mfma_f32_16x16x32_bf16 a[24:27], v[156:159], v[32:35], a[24:27]
    ds_read_b128 v[176:179], v5 offset:512
    v_mfma_f32_16x16x32_bf16 a[112:115], v[180:183], v[32:35], a[112:115]
    buffer_load_dwordx4 v[104:107], v12, s[60:63], s12 offen offset:0 sc1
    v_mfma_f32_16x16x32_bf16 a[28:31], v[132:135], v[36:39], a[28:31]
    buffer_load_dwordx4 v[108:111], v12, s[60:63], s12 offen offset:1024 sc1
    v_mfma_f32_16x16x32_bf16 a[32:35], v[136:139], v[36:39], a[32:35]
    buffer_load_dwordx4 v[112:115], v12, s[60:63], s12 offen offset:2048 sc1
    v_mfma_f32_16x16x32_bf16 a[36:39], v[140:143], v[36:39], a[36:39]
    buffer_load_dwordx4 v[116:119], v12, s[60:63], s12 offen offset:3072 sc1
    v_mfma_f32_16x16x32_bf16 a[40:43], v[144:147], v[36:39], a[40:43]
    buffer_load_dwordx4 v[120:123], v3, s[60:63], s12 offen offset:0 sc1
    v_mfma_f32_16x16x32_bf16 a[44:47], v[148:151], v[36:39], a[44:47]
    buffer_load_dwordx4 v[124:127], v3, s[60:63], s12 offen offset:1024 sc1
    v_mfma_f32_16x16x32_bf16 a[48:51], v[152:155], v[36:39], a[48:51]
    buffer_load_dwordx4 v[128:131], v3, s[60:63], s12 offen offset:2048 sc1
    s_add_u32 s12, s12, 55296
    s_waitcnt lgkmcnt(0)
    v_mfma_f32_16x16x32_bf16 a[52:55], v[156:159], v[36:39], a[52:55]
    v_lshlrev_b32 v184, 16, v16
    v_and_b32 v185, 0xffff0000, v16
    v_pk_mul_f32 v[184:185], v[184:185], v[160:161]
    v_cvt_pk_bf16_f32 v16, v184, v185
    v_mfma_f32_16x16x32_bf16 a[116:119], v[180:183], v[36:39], a[116:119]
    v_lshlrev_b32 v186, 16, v17
    v_and_b32 v187, 0xffff0000, v17
    v_pk_mul_f32 v[186:187], v[186:187], v[162:163]
    v_cvt_pk_bf16_f32 v17, v186, v187
    v_mfma_f32_16x16x32_bf16 a[56:59], v[132:135], v[40:43], a[56:59]
    v_lshlrev_b32 v188, 16, v18
    v_and_b32 v189, 0xffff0000, v18
    v_pk_mul_f32 v[188:189], v[188:189], v[164:165]
    v_cvt_pk_bf16_f32 v18, v188, v189
    v_mfma_f32_16x16x32_bf16 a[60:63], v[136:139], v[40:43], a[60:63]
    v_lshlrev_b32 v190, 16, v19
    v_and_b32 v191, 0xffff0000, v19
    v_pk_mul_f32 v[190:191], v[190:191], v[166:167]
    v_cvt_pk_bf16_f32 v19, v190, v191
    v_mfma_f32_16x16x32_bf16 a[64:67], v[140:143], v[40:43], a[64:67]
    v_lshlrev_b32 v184, 16, v20
    v_and_b32 v185, 0xffff0000, v20
    v_pk_mul_f32 v[184:185], v[184:185], v[160:161]
    v_cvt_pk_bf16_f32 v20, v184, v185
    v_mfma_f32_16x16x32_bf16 a[68:71], v[144:147], v[40:43], a[68:71]
    v_lshlrev_b32 v186, 16, v21
    v_and_b32 v187, 0xffff0000, v21
    v_pk_mul_f32 v[186:187], v[186:187], v[162:163]
    v_cvt_pk_bf16_f32 v21, v186, v187
    v_mfma_f32_16x16x32_bf16 a[72:75], v[148:151], v[40:43], a[72:75]
    v_lshlrev_b32 v188, 16, v22
    v_and_b32 v189, 0xffff0000, v22
    v_pk_mul_f32 v[188:189], v[188:189], v[164:165]
    v_cvt_pk_bf16_f32 v22, v188, v189
    v_mfma_f32_16x16x32_bf16 a[76:79], v[152:155], v[40:43], a[76:79]
    v_lshlrev_b32 v190, 16, v23
    v_and_b32 v191, 0xffff0000, v23
    v_pk_mul_f32 v[190:191], v[190:191], v[166:167]
    v_cvt_pk_bf16_f32 v23, v190, v191
    v_mfma_f32_16x16x32_bf16 a[80:83], v[156:159], v[40:43], a[80:83]
    v_lshlrev_b32 v184, 16, v24
    v_and_b32 v185, 0xffff0000, v24
    v_pk_mul_f32 v[184:185], v[184:185], v[160:161]
    v_cvt_pk_bf16_f32 v24, v184, v185
    v_mfma_f32_16x16x32_bf16 a[120:123], v[180:183], v[40:43], a[120:123]
    v_lshlrev_b32 v186, 16, v25
    v_and_b32 v187, 0xffff0000, v25
    v_pk_mul_f32 v[186:187], v[186:187], v[162:163]
    v_cvt_pk_bf16_f32 v25, v186, v187
    v_mfma_f32_16x16x32_bf16 a[84:87], v[132:135], v[44:47], a[84:87]
    v_lshlrev_b32 v188, 16, v26
    v_and_b32 v189, 0xffff0000, v26
    v_pk_mul_f32 v[188:189], v[188:189], v[164:165]
    v_mfma_f32_16x16x32_bf16 a[88:91], v[136:139], v[44:47], a[88:91]
    v_cvt_pk_bf16_f32 v26, v188, v189
    v_lshlrev_b32 v190, 16, v27
    v_and_b32 v191, 0xffff0000, v27
    v_mfma_f32_16x16x32_bf16 a[92:95], v[140:143], v[44:47], a[92:95]
    v_pk_mul_f32 v[190:191], v[190:191], v[166:167]
    v_cvt_pk_bf16_f32 v27, v190, v191
    v_lshlrev_b32 v184, 16, v28
    v_mfma_f32_16x16x32_bf16 a[96:99], v[144:147], v[44:47], a[96:99]
    v_and_b32 v185, 0xffff0000, v28
    v_pk_mul_f32 v[184:185], v[184:185], v[160:161]
    v_cvt_pk_bf16_f32 v28, v184, v185
    v_mfma_f32_16x16x32_bf16 a[100:103], v[148:151], v[44:47], a[100:103]
    v_lshlrev_b32 v186, 16, v29
    v_and_b32 v187, 0xffff0000, v29
    v_pk_mul_f32 v[186:187], v[186:187], v[162:163]
    v_mfma_f32_16x16x32_bf16 a[104:107], v[152:155], v[44:47], a[104:107]
    v_cvt_pk_bf16_f32 v29, v186, v187
    v_lshlrev_b32 v188, 16, v30
    v_and_b32 v189, 0xffff0000, v30
    v_mfma_f32_16x16x32_bf16 a[108:111], v[156:159], v[44:47], a[108:111]
    v_pk_mul_f32 v[188:189], v[188:189], v[164:165]
    v_cvt_pk_bf16_f32 v30, v188, v189
    v_lshlrev_b32 v190, 16, v31
    v_mfma_f32_16x16x32_bf16 a[124:127], v[180:183], v[44:47], a[124:127]
    v_and_b32 v191, 0xffff0000, v31
    v_pk_mul_f32 v[190:191], v[190:191], v[166:167]
    v_cvt_pk_bf16_f32 v31, v190, v191
    s_waitcnt vmcnt(22)
    v_mfma_f32_16x16x32_bf16 a[0:3], v[48:51], v[16:19], a[0:3]
    ds_read_b128 v[32:35], v7 offset:32768
    v_mfma_f32_16x16x32_bf16 a[4:7], v[52:55], v[16:19], a[4:7]
    ds_read_b128 v[36:39], v7 offset:34816
    v_mfma_f32_16x16x32_bf16 a[8:11], v[56:59], v[16:19], a[8:11]
    ds_read_b128 v[40:43], v7 offset:36864
    v_mfma_f32_16x16x32_bf16 a[12:15], v[60:63], v[16:19], a[12:15]
    ds_read_b128 v[44:47], v7 offset:38912
    v_mfma_f32_16x16x32_bf16 a[16:19], v[64:67], v[16:19], a[16:19]
    ds_read_b128 v[168:171], v4 offset:1152
    v_mfma_f32_16x16x32_bf16 a[20:23], v[68:71], v[16:19], a[20:23]
    ds_read_b128 v[172:175], v4 offset:1168
    v_mfma_f32_16x16x32_bf16 a[24:27], v[72:75], v[16:19], a[24:27]
    ds_read_b128 v[180:183], v5 offset:576
    v_mfma_f32_16x16x32_bf16 a[112:115], v[176:179], v[16:19], a[112:115]
    buffer_load_dwordx4 v[132:135], v12, s[60:63], s12 offen offset:0 sc1
    v_mfma_f32_16x16x32_bf16 a[28:31], v[48:51], v[20:23], a[28:31]
    buffer_load_dwordx4 v[136:139], v12, s[60:63], s12 offen offset:1024 sc1
    v_mfma_f32_16x16x32_bf16 a[32:35], v[52:55], v[20:23], a[32:35]
    buffer_load_dwordx4 v[140:143], v12, s[60:63], s12 offen offset:2048 sc1
    v_mfma_f32_16x16x32_bf16 a[36:39], v[56:59], v[20:23], a[36:39]
    buffer_load_dwordx4 v[144:147], v12, s[60:63], s12 offen offset:3072 sc1
    v_mfma_f32_16x16x32_bf16 a[40:43], v[60:63], v[20:23], a[40:43]
    buffer_load_dwordx4 v[148:151], v3, s[60:63], s12 offen offset:0 sc1
    v_mfma_f32_16x16x32_bf16 a[44:47], v[64:67], v[20:23], a[44:47]
    buffer_load_dwordx4 v[152:155], v3, s[60:63], s12 offen offset:1024 sc1
    v_mfma_f32_16x16x32_bf16 a[48:51], v[68:71], v[20:23], a[48:51]
    buffer_load_dwordx4 v[156:159], v3, s[60:63], s12 offen offset:2048 sc1
    s_add_u32 s12, s12, 55296
    s_waitcnt lgkmcnt(0)
    v_mfma_f32_16x16x32_bf16 a[52:55], v[72:75], v[20:23], a[52:55]
    s_add_u32 m0, s96, 0
    s_add_u32 s14, s97, 768
    buffer_load_dwordx4 v220, s[88:91], s14 offen lds
    v_lshlrev_b32 v184, 16, v32
    v_and_b32 v185, 0xffff0000, v32
    v_pk_mul_f32 v[184:185], v[184:185], v[168:169]
    v_cvt_pk_bf16_f32 v32, v184, v185
    v_mfma_f32_16x16x32_bf16 a[116:119], v[176:179], v[20:23], a[116:119]
    s_add_u32 m0, s96, 1024
    s_add_u32 s14, s97, 768
    buffer_load_dwordx4 v221, s[88:91], s14 offen lds
    v_lshlrev_b32 v186, 16, v33
    v_and_b32 v187, 0xffff0000, v33
    v_pk_mul_f32 v[186:187], v[186:187], v[170:171]
    v_cvt_pk_bf16_f32 v33, v186, v187
    v_mfma_f32_16x16x32_bf16 a[56:59], v[48:51], v[24:27], a[56:59]
    s_add_u32 m0, s96, 2048
    s_add_u32 s14, s97, 17152
    buffer_load_dwordx4 v220, s[88:91], s14 offen lds
    v_lshlrev_b32 v188, 16, v34
    v_and_b32 v189, 0xffff0000, v34
    v_pk_mul_f32 v[188:189], v[188:189], v[172:173]
    v_cvt_pk_bf16_f32 v34, v188, v189
    v_mfma_f32_16x16x32_bf16 a[60:63], v[52:55], v[24:27], a[60:63]
    s_add_u32 m0, s96, 3072
    s_add_u32 s14, s97, 17152
    buffer_load_dwordx4 v221, s[88:91], s14 offen lds
    v_lshlrev_b32 v190, 16, v35
    v_and_b32 v191, 0xffff0000, v35
    v_pk_mul_f32 v[190:191], v[190:191], v[174:175]
    v_cvt_pk_bf16_f32 v35, v190, v191
    v_mfma_f32_16x16x32_bf16 a[64:67], v[56:59], v[24:27], a[64:67]
    s_add_u32 m0, s96, 4096
    s_add_u32 s14, s97, 131840
    buffer_load_dwordx4 v220, s[88:91], s14 offen lds
    v_lshlrev_b32 v184, 16, v36
    v_and_b32 v185, 0xffff0000, v36
    v_pk_mul_f32 v[184:185], v[184:185], v[168:169]
    v_cvt_pk_bf16_f32 v36, v184, v185
    v_mfma_f32_16x16x32_bf16 a[68:71], v[60:63], v[24:27], a[68:71]
    s_add_u32 m0, s96, 5120
    s_add_u32 s14, s97, 131840
    buffer_load_dwordx4 v221, s[88:91], s14 offen lds
    v_lshlrev_b32 v186, 16, v37
    v_and_b32 v187, 0xffff0000, v37
    v_pk_mul_f32 v[186:187], v[186:187], v[170:171]
    v_cvt_pk_bf16_f32 v37, v186, v187
    v_mfma_f32_16x16x32_bf16 a[72:75], v[64:67], v[24:27], a[72:75]
    s_add_u32 m0, s96, 6144
    s_add_u32 s14, s97, 148224
    buffer_load_dwordx4 v220, s[88:91], s14 offen lds
    v_lshlrev_b32 v188, 16, v38
    v_and_b32 v189, 0xffff0000, v38
    v_pk_mul_f32 v[188:189], v[188:189], v[172:173]
    v_cvt_pk_bf16_f32 v38, v188, v189
    v_mfma_f32_16x16x32_bf16 a[76:79], v[68:71], v[24:27], a[76:79]
    s_add_u32 m0, s96, 7168
    s_add_u32 s14, s97, 148224
    buffer_load_dwordx4 v221, s[88:91], s14 offen lds
    v_lshlrev_b32 v190, 16, v39
    v_and_b32 v191, 0xffff0000, v39
    v_pk_mul_f32 v[190:191], v[190:191], v[174:175]
    v_cvt_pk_bf16_f32 v39, v190, v191
    v_mfma_f32_16x16x32_bf16 a[80:83], v[72:75], v[24:27], a[80:83]
    v_lshlrev_b32 v184, 16, v40
    v_and_b32 v185, 0xffff0000, v40
    v_pk_mul_f32 v[184:185], v[184:185], v[168:169]
    v_cvt_pk_bf16_f32 v40, v184, v185
    v_mfma_f32_16x16x32_bf16 a[120:123], v[176:179], v[24:27], a[120:123]
    v_lshlrev_b32 v186, 16, v41
    v_and_b32 v187, 0xffff0000, v41
    v_pk_mul_f32 v[186:187], v[186:187], v[170:171]
    v_cvt_pk_bf16_f32 v41, v186, v187
    v_mfma_f32_16x16x32_bf16 a[84:87], v[48:51], v[28:31], a[84:87]
    v_lshlrev_b32 v188, 16, v42
    v_and_b32 v189, 0xffff0000, v42
    v_pk_mul_f32 v[188:189], v[188:189], v[172:173]
    v_mfma_f32_16x16x32_bf16 a[88:91], v[52:55], v[28:31], a[88:91]
    v_cvt_pk_bf16_f32 v42, v188, v189
    v_lshlrev_b32 v190, 16, v43
    v_and_b32 v191, 0xffff0000, v43
    v_mfma_f32_16x16x32_bf16 a[92:95], v[56:59], v[28:31], a[92:95]
    v_pk_mul_f32 v[190:191], v[190:191], v[174:175]
    v_cvt_pk_bf16_f32 v43, v190, v191
    v_lshlrev_b32 v184, 16, v44
    v_mfma_f32_16x16x32_bf16 a[96:99], v[60:63], v[28:31], a[96:99]
    v_and_b32 v185, 0xffff0000, v44
    v_pk_mul_f32 v[184:185], v[184:185], v[168:169]
    v_cvt_pk_bf16_f32 v44, v184, v185
    v_mfma_f32_16x16x32_bf16 a[100:103], v[64:67], v[28:31], a[100:103]
    v_lshlrev_b32 v186, 16, v45
    v_and_b32 v187, 0xffff0000, v45
    v_pk_mul_f32 v[186:187], v[186:187], v[170:171]
    v_mfma_f32_16x16x32_bf16 a[104:107], v[68:71], v[28:31], a[104:107]
    v_cvt_pk_bf16_f32 v45, v186, v187
    v_lshlrev_b32 v188, 16, v46
    v_and_b32 v189, 0xffff0000, v46
    v_mfma_f32_16x16x32_bf16 a[108:111], v[72:75], v[28:31], a[108:111]
    v_pk_mul_f32 v[188:189], v[188:189], v[172:173]
    v_cvt_pk_bf16_f32 v46, v188, v189
    v_lshlrev_b32 v190, 16, v47
    v_mfma_f32_16x16x32_bf16 a[124:127], v[176:179], v[28:31], a[124:127]
    v_and_b32 v191, 0xffff0000, v47
    v_pk_mul_f32 v[190:191], v[190:191], v[174:175]
    v_cvt_pk_bf16_f32 v47, v190, v191
    s_waitcnt vmcnt(22)
    v_mfma_f32_16x16x32_bf16 a[0:3], v[76:79], v[32:35], a[0:3]
    ds_read_b128 v[16:19], v222 offset:0
    v_mfma_f32_16x16x32_bf16 a[4:7], v[80:83], v[32:35], a[4:7]
    ds_read_b128 v[20:23], v222 offset:2048
    v_mfma_f32_16x16x32_bf16 a[8:11], v[84:87], v[32:35], a[8:11]
    ds_read_b128 v[24:27], v222 offset:4096
    v_mfma_f32_16x16x32_bf16 a[12:15], v[88:91], v[32:35], a[12:15]
    ds_read_b128 v[28:31], v222 offset:6144
    v_mfma_f32_16x16x32_bf16 a[16:19], v[92:95], v[32:35], a[16:19]
    ds_read_b128 v[160:163], v4 offset:1280
    v_mfma_f32_16x16x32_bf16 a[20:23], v[96:99], v[32:35], a[20:23]
    ds_read_b128 v[164:167], v4 offset:1296
    v_mfma_f32_16x16x32_bf16 a[24:27], v[100:103], v[32:35], a[24:27]
    ds_read_b128 v[176:179], v5 offset:640
    v_mfma_f32_16x16x32_bf16 a[112:115], v[180:183], v[32:35], a[112:115]
    buffer_load_dwordx4 v[48:51], v12, s[60:63], s12 offen offset:0 sc1
    v_mfma_f32_16x16x32_bf16 a[28:31], v[76:79], v[36:39], a[28:31]
    buffer_load_dwordx4 v[52:55], v12, s[60:63], s12 offen offset:1024 sc1
    v_mfma_f32_16x16x32_bf16 a[32:35], v[80:83], v[36:39], a[32:35]
    buffer_load_dwordx4 v[56:59], v12, s[60:63], s12 offen offset:2048 sc1
    v_mfma_f32_16x16x32_bf16 a[36:39], v[84:87], v[36:39], a[36:39]
    buffer_load_dwordx4 v[60:63], v12, s[60:63], s12 offen offset:3072 sc1
    v_mfma_f32_16x16x32_bf16 a[40:43], v[88:91], v[36:39], a[40:43]
    buffer_load_dwordx4 v[64:67], v3, s[60:63], s12 offen offset:0 sc1
    v_mfma_f32_16x16x32_bf16 a[44:47], v[92:95], v[36:39], a[44:47]
    buffer_load_dwordx4 v[68:71], v3, s[60:63], s12 offen offset:1024 sc1
    v_mfma_f32_16x16x32_bf16 a[48:51], v[96:99], v[36:39], a[48:51]
    buffer_load_dwordx4 v[72:75], v3, s[60:63], s12 offen offset:2048 sc1
    s_add_u32 s12, s12, 55296
    s_waitcnt lgkmcnt(0)
    v_mfma_f32_16x16x32_bf16 a[52:55], v[100:103], v[36:39], a[52:55]
    v_lshlrev_b32 v184, 16, v16
    v_and_b32 v185, 0xffff0000, v16
    v_pk_mul_f32 v[184:185], v[184:185], v[160:161]
    v_cvt_pk_bf16_f32 v16, v184, v185
    v_mfma_f32_16x16x32_bf16 a[116:119], v[180:183], v[36:39], a[116:119]
    v_lshlrev_b32 v186, 16, v17
    v_and_b32 v187, 0xffff0000, v17
    v_pk_mul_f32 v[186:187], v[186:187], v[162:163]
    v_cvt_pk_bf16_f32 v17, v186, v187
    v_mfma_f32_16x16x32_bf16 a[56:59], v[76:79], v[40:43], a[56:59]
    v_lshlrev_b32 v188, 16, v18
    v_and_b32 v189, 0xffff0000, v18
    v_pk_mul_f32 v[188:189], v[188:189], v[164:165]
    v_cvt_pk_bf16_f32 v18, v188, v189
    v_mfma_f32_16x16x32_bf16 a[60:63], v[80:83], v[40:43], a[60:63]
    v_lshlrev_b32 v190, 16, v19
    v_and_b32 v191, 0xffff0000, v19
    v_pk_mul_f32 v[190:191], v[190:191], v[166:167]
    v_cvt_pk_bf16_f32 v19, v190, v191
    v_mfma_f32_16x16x32_bf16 a[64:67], v[84:87], v[40:43], a[64:67]
    v_lshlrev_b32 v184, 16, v20
    v_and_b32 v185, 0xffff0000, v20
    v_pk_mul_f32 v[184:185], v[184:185], v[160:161]
    v_cvt_pk_bf16_f32 v20, v184, v185
    v_mfma_f32_16x16x32_bf16 a[68:71], v[88:91], v[40:43], a[68:71]
    v_lshlrev_b32 v186, 16, v21
    v_and_b32 v187, 0xffff0000, v21
    v_pk_mul_f32 v[186:187], v[186:187], v[162:163]
    v_cvt_pk_bf16_f32 v21, v186, v187
    v_mfma_f32_16x16x32_bf16 a[72:75], v[92:95], v[40:43], a[72:75]
    v_lshlrev_b32 v188, 16, v22
    v_and_b32 v189, 0xffff0000, v22
    v_pk_mul_f32 v[188:189], v[188:189], v[164:165]
    v_cvt_pk_bf16_f32 v22, v188, v189
    v_mfma_f32_16x16x32_bf16 a[76:79], v[96:99], v[40:43], a[76:79]
    v_lshlrev_b32 v190, 16, v23
    v_and_b32 v191, 0xffff0000, v23
    v_pk_mul_f32 v[190:191], v[190:191], v[166:167]
    v_cvt_pk_bf16_f32 v23, v190, v191
    v_mfma_f32_16x16x32_bf16 a[80:83], v[100:103], v[40:43], a[80:83]
    v_lshlrev_b32 v184, 16, v24
    v_and_b32 v185, 0xffff0000, v24
    v_pk_mul_f32 v[184:185], v[184:185], v[160:161]
    v_cvt_pk_bf16_f32 v24, v184, v185
    v_mfma_f32_16x16x32_bf16 a[120:123], v[180:183], v[40:43], a[120:123]
    v_lshlrev_b32 v186, 16, v25
    v_and_b32 v187, 0xffff0000, v25
    v_pk_mul_f32 v[186:187], v[186:187], v[162:163]
    v_cvt_pk_bf16_f32 v25, v186, v187
    v_mfma_f32_16x16x32_bf16 a[84:87], v[76:79], v[44:47], a[84:87]
    v_lshlrev_b32 v188, 16, v26
    v_and_b32 v189, 0xffff0000, v26
    v_pk_mul_f32 v[188:189], v[188:189], v[164:165]
    v_mfma_f32_16x16x32_bf16 a[88:91], v[80:83], v[44:47], a[88:91]
    v_cvt_pk_bf16_f32 v26, v188, v189
    v_lshlrev_b32 v190, 16, v27
    v_and_b32 v191, 0xffff0000, v27
    v_mfma_f32_16x16x32_bf16 a[92:95], v[84:87], v[44:47], a[92:95]
    v_pk_mul_f32 v[190:191], v[190:191], v[166:167]
    v_cvt_pk_bf16_f32 v27, v190, v191
    v_lshlrev_b32 v184, 16, v28
    v_mfma_f32_16x16x32_bf16 a[96:99], v[88:91], v[44:47], a[96:99]
    v_and_b32 v185, 0xffff0000, v28
    v_pk_mul_f32 v[184:185], v[184:185], v[160:161]
    v_cvt_pk_bf16_f32 v28, v184, v185
    v_mfma_f32_16x16x32_bf16 a[100:103], v[92:95], v[44:47], a[100:103]
    v_lshlrev_b32 v186, 16, v29
    v_and_b32 v187, 0xffff0000, v29
    v_pk_mul_f32 v[186:187], v[186:187], v[162:163]
    v_mfma_f32_16x16x32_bf16 a[104:107], v[96:99], v[44:47], a[104:107]
    v_cvt_pk_bf16_f32 v29, v186, v187
    v_lshlrev_b32 v188, 16, v30
    v_and_b32 v189, 0xffff0000, v30
    v_mfma_f32_16x16x32_bf16 a[108:111], v[100:103], v[44:47], a[108:111]
    v_pk_mul_f32 v[188:189], v[188:189], v[164:165]
    v_cvt_pk_bf16_f32 v30, v188, v189
    v_lshlrev_b32 v190, 16, v31
    v_mfma_f32_16x16x32_bf16 a[124:127], v[180:183], v[44:47], a[124:127]
    v_and_b32 v191, 0xffff0000, v31
    v_pk_mul_f32 v[190:191], v[190:191], v[166:167]
    v_cvt_pk_bf16_f32 v31, v190, v191
    s_waitcnt vmcnt(22)
    v_mfma_f32_16x16x32_bf16 a[0:3], v[104:107], v[16:19], a[0:3]
    ds_read_b128 v[32:35], v223 offset:0
    v_mfma_f32_16x16x32_bf16 a[4:7], v[108:111], v[16:19], a[4:7]
    ds_read_b128 v[36:39], v223 offset:2048
    v_mfma_f32_16x16x32_bf16 a[8:11], v[112:115], v[16:19], a[8:11]
    ds_read_b128 v[40:43], v223 offset:4096
    v_mfma_f32_16x16x32_bf16 a[12:15], v[116:119], v[16:19], a[12:15]
    ds_read_b128 v[44:47], v223 offset:6144
    v_mfma_f32_16x16x32_bf16 a[16:19], v[120:123], v[16:19], a[16:19]
    ds_read_b128 v[168:171], v4 offset:1408
    v_mfma_f32_16x16x32_bf16 a[20:23], v[124:127], v[16:19], a[20:23]
    ds_read_b128 v[172:175], v4 offset:1424
    v_mfma_f32_16x16x32_bf16 a[24:27], v[128:131], v[16:19], a[24:27]
    ds_read_b128 v[180:183], v5 offset:704
    v_mfma_f32_16x16x32_bf16 a[112:115], v[176:179], v[16:19], a[112:115]
    buffer_load_dwordx4 v[76:79], v12, s[60:63], s12 offen offset:0 sc1
    v_mfma_f32_16x16x32_bf16 a[28:31], v[104:107], v[20:23], a[28:31]
    buffer_load_dwordx4 v[80:83], v12, s[60:63], s12 offen offset:1024 sc1
    v_mfma_f32_16x16x32_bf16 a[32:35], v[108:111], v[20:23], a[32:35]
    buffer_load_dwordx4 v[84:87], v12, s[60:63], s12 offen offset:2048 sc1
    v_mfma_f32_16x16x32_bf16 a[36:39], v[112:115], v[20:23], a[36:39]
    buffer_load_dwordx4 v[88:91], v12, s[60:63], s12 offen offset:3072 sc1
    v_mfma_f32_16x16x32_bf16 a[40:43], v[116:119], v[20:23], a[40:43]
    buffer_load_dwordx4 v[92:95], v3, s[60:63], s12 offen offset:0 sc1
    v_mfma_f32_16x16x32_bf16 a[44:47], v[120:123], v[20:23], a[44:47]
    buffer_load_dwordx4 v[96:99], v3, s[60:63], s12 offen offset:1024 sc1
    v_mfma_f32_16x16x32_bf16 a[48:51], v[124:127], v[20:23], a[48:51]
    buffer_load_dwordx4 v[100:103], v3, s[60:63], s12 offen offset:2048 sc1
    s_add_u32 s12, s12, 55296
    s_waitcnt lgkmcnt(0)
    v_mfma_f32_16x16x32_bf16 a[52:55], v[128:131], v[20:23], a[52:55]
    s_add_u32 m0, s96, 32768
    s_add_u32 s14, s97, 896
    buffer_load_dwordx4 v220, s[88:91], s14 offen lds
    v_lshlrev_b32 v184, 16, v32
    v_and_b32 v185, 0xffff0000, v32
    v_pk_mul_f32 v[184:185], v[184:185], v[168:169]
    v_cvt_pk_bf16_f32 v32, v184, v185
    v_mfma_f32_16x16x32_bf16 a[116:119], v[176:179], v[20:23], a[116:119]
    s_add_u32 m0, s96, 33792
    s_add_u32 s14, s97, 896
    buffer_load_dwordx4 v221, s[88:91], s14 offen lds
    v_lshlrev_b32 v186, 16, v33
    v_and_b32 v187, 0xffff0000, v33
    v_pk_mul_f32 v[186:187], v[186:187], v[170:171]
    v_cvt_pk_bf16_f32 v33, v186, v187
    v_mfma_f32_16x16x32_bf16 a[56:59], v[104:107], v[24:27], a[56:59]
    s_add_u32 m0, s96, 34816
    s_add_u32 s14, s97, 17280
    buffer_load_dwordx4 v220, s[88:91], s14 offen lds
    v_lshlrev_b32 v188, 16, v34
    v_and_b32 v189, 0xffff0000, v34
    v_pk_mul_f32 v[188:189], v[188:189], v[172:173]
    v_cvt_pk_bf16_f32 v34, v188, v189
    v_mfma_f32_16x16x32_bf16 a[60:63], v[108:111], v[24:27], a[60:63]
    s_add_u32 m0, s96, 35840
    s_add_u32 s14, s97, 17280
    buffer_load_dwordx4 v221, s[88:91], s14 offen lds
    v_lshlrev_b32 v190, 16, v35
    v_and_b32 v191, 0xffff0000, v35
    v_pk_mul_f32 v[190:191], v[190:191], v[174:175]
    v_cvt_pk_bf16_f32 v35, v190, v191
    v_mfma_f32_16x16x32_bf16 a[64:67], v[112:115], v[24:27], a[64:67]
    s_add_u32 m0, s96, 36864
    s_add_u32 s14, s97, 131968
    buffer_load_dwordx4 v220, s[88:91], s14 offen lds
    v_lshlrev_b32 v184, 16, v36
    v_and_b32 v185, 0xffff0000, v36
    v_pk_mul_f32 v[184:185], v[184:185], v[168:169]
    v_cvt_pk_bf16_f32 v36, v184, v185
    v_mfma_f32_16x16x32_bf16 a[68:71], v[116:119], v[24:27], a[68:71]
    s_add_u32 m0, s96, 37888
    s_add_u32 s14, s97, 131968
    buffer_load_dwordx4 v221, s[88:91], s14 offen lds
    v_lshlrev_b32 v186, 16, v37
    v_and_b32 v187, 0xffff0000, v37
    v_pk_mul_f32 v[186:187], v[186:187], v[170:171]
    v_cvt_pk_bf16_f32 v37, v186, v187
    v_mfma_f32_16x16x32_bf16 a[72:75], v[120:123], v[24:27], a[72:75]
    s_add_u32 m0, s96, 38912
    s_add_u32 s14, s97, 148352
    buffer_load_dwordx4 v220, s[88:91], s14 offen lds
    v_lshlrev_b32 v188, 16, v38
    v_and_b32 v189, 0xffff0000, v38
    v_pk_mul_f32 v[188:189], v[188:189], v[172:173]
    v_cvt_pk_bf16_f32 v38, v188, v189
    v_mfma_f32_16x16x32_bf16 a[76:79], v[124:127], v[24:27], a[76:79]
    s_add_u32 m0, s96, 39936
    s_add_u32 s14, s97, 148352
    buffer_load_dwordx4 v221, s[88:91], s14 offen lds
    v_lshlrev_b32 v190, 16, v39
    v_and_b32 v191, 0xffff0000, v39
    v_pk_mul_f32 v[190:191], v[190:191], v[174:175]
    v_cvt_pk_bf16_f32 v39, v190, v191
    v_mfma_f32_16x16x32_bf16 a[80:83], v[128:131], v[24:27], a[80:83]
    v_lshlrev_b32 v184, 16, v40
    v_and_b32 v185, 0xffff0000, v40
    v_pk_mul_f32 v[184:185], v[184:185], v[168:169]
    v_cvt_pk_bf16_f32 v40, v184, v185
    v_mfma_f32_16x16x32_bf16 a[120:123], v[176:179], v[24:27], a[120:123]
    v_lshlrev_b32 v186, 16, v41
    v_and_b32 v187, 0xffff0000, v41
    v_pk_mul_f32 v[186:187], v[186:187], v[170:171]
    v_cvt_pk_bf16_f32 v41, v186, v187
    v_mfma_f32_16x16x32_bf16 a[84:87], v[104:107], v[28:31], a[84:87]
    v_lshlrev_b32 v188, 16, v42
    v_and_b32 v189, 0xffff0000, v42
    v_pk_mul_f32 v[188:189], v[188:189], v[172:173]
    v_mfma_f32_16x16x32_bf16 a[88:91], v[108:111], v[28:31], a[88:91]
    v_cvt_pk_bf16_f32 v42, v188, v189
    v_lshlrev_b32 v190, 16, v43
    v_and_b32 v191, 0xffff0000, v43
    v_mfma_f32_16x16x32_bf16 a[92:95], v[112:115], v[28:31], a[92:95]
    v_pk_mul_f32 v[190:191], v[190:191], v[174:175]
    v_cvt_pk_bf16_f32 v43, v190, v191
    v_lshlrev_b32 v184, 16, v44
    v_mfma_f32_16x16x32_bf16 a[96:99], v[116:119], v[28:31], a[96:99]
    v_and_b32 v185, 0xffff0000, v44
    v_pk_mul_f32 v[184:185], v[184:185], v[168:169]
    v_cvt_pk_bf16_f32 v44, v184, v185
    v_mfma_f32_16x16x32_bf16 a[100:103], v[120:123], v[28:31], a[100:103]
    v_lshlrev_b32 v186, 16, v45
    v_and_b32 v187, 0xffff0000, v45
    v_pk_mul_f32 v[186:187], v[186:187], v[170:171]
    v_mfma_f32_16x16x32_bf16 a[104:107], v[124:127], v[28:31], a[104:107]
    v_cvt_pk_bf16_f32 v45, v186, v187
    v_lshlrev_b32 v188, 16, v46
    v_and_b32 v189, 0xffff0000, v46
    v_mfma_f32_16x16x32_bf16 a[108:111], v[128:131], v[28:31], a[108:111]
    v_pk_mul_f32 v[188:189], v[188:189], v[172:173]
    v_cvt_pk_bf16_f32 v46, v188, v189
    v_lshlrev_b32 v190, 16, v47
    v_mfma_f32_16x16x32_bf16 a[124:127], v[176:179], v[28:31], a[124:127]
    v_and_b32 v191, 0xffff0000, v47
    v_pk_mul_f32 v[190:191], v[190:191], v[174:175]
    v_cvt_pk_bf16_f32 v47, v190, v191
    s_waitcnt vmcnt(22)
    v_mfma_f32_16x16x32_bf16 a[0:3], v[132:135], v[32:35], a[0:3]
    ds_read_b128 v[16:19], v6 offset:0
    v_mfma_f32_16x16x32_bf16 a[4:7], v[136:139], v[32:35], a[4:7]
    ds_read_b128 v[20:23], v6 offset:2048
    v_mfma_f32_16x16x32_bf16 a[8:11], v[140:143], v[32:35], a[8:11]
    ds_read_b128 v[24:27], v6 offset:4096
    v_mfma_f32_16x16x32_bf16 a[12:15], v[144:147], v[32:35], a[12:15]
    ds_read_b128 v[28:31], v6 offset:6144
    v_mfma_f32_16x16x32_bf16 a[16:19], v[148:151], v[32:35], a[16:19]
    ds_read_b128 v[160:163], v4 offset:1536
    v_mfma_f32_16x16x32_bf16 a[20:23], v[152:155], v[32:35], a[20:23]
    ds_read_b128 v[164:167], v4 offset:1552
    v_mfma_f32_16x16x32_bf16 a[24:27], v[156:159], v[32:35], a[24:27]
    ds_read_b128 v[176:179], v5 offset:768
    v_mfma_f32_16x16x32_bf16 a[112:115], v[180:183], v[32:35], a[112:115]
    buffer_load_dwordx4 v[104:107], v12, s[60:63], s12 offen offset:0 sc1
    v_mfma_f32_16x16x32_bf16 a[28:31], v[132:135], v[36:39], a[28:31]
    buffer_load_dwordx4 v[108:111], v12, s[60:63], s12 offen offset:1024 sc1
    v_mfma_f32_16x16x32_bf16 a[32:35], v[136:139], v[36:39], a[32:35]
    buffer_load_dwordx4 v[112:115], v12, s[60:63], s12 offen offset:2048 sc1
    v_mfma_f32_16x16x32_bf16 a[36:39], v[140:143], v[36:39], a[36:39]
    buffer_load_dwordx4 v[116:119], v12, s[60:63], s12 offen offset:3072 sc1
    v_mfma_f32_16x16x32_bf16 a[40:43], v[144:147], v[36:39], a[40:43]
    buffer_load_dwordx4 v[120:123], v3, s[60:63], s12 offen offset:0 sc1
    v_mfma_f32_16x16x32_bf16 a[44:47], v[148:151], v[36:39], a[44:47]
    buffer_load_dwordx4 v[124:127], v3, s[60:63], s12 offen offset:1024 sc1
    v_mfma_f32_16x16x32_bf16 a[48:51], v[152:155], v[36:39], a[48:51]
    buffer_load_dwordx4 v[128:131], v3, s[60:63], s12 offen offset:2048 sc1
    s_add_u32 s12, s12, 55296
    s_waitcnt lgkmcnt(0)
    v_mfma_f32_16x16x32_bf16 a[52:55], v[156:159], v[36:39], a[52:55]
    buffer_load_dword v15, v2, s[84:87], s11 offen sc1
    v_lshlrev_b32 v184, 16, v16
    v_and_b32 v185, 0xffff0000, v16
    v_pk_mul_f32 v[184:185], v[184:185], v[160:161]
    v_cvt_pk_bf16_f32 v16, v184, v185
    v_mfma_f32_16x16x32_bf16 a[116:119], v[180:183], v[36:39], a[116:119]
    v_lshlrev_b32 v186, 16, v17
    v_and_b32 v187, 0xffff0000, v17
    v_pk_mul_f32 v[186:187], v[186:187], v[162:163]
    v_cvt_pk_bf16_f32 v17, v186, v187
    v_mfma_f32_16x16x32_bf16 a[56:59], v[132:135], v[40:43], a[56:59]
    v_lshlrev_b32 v188, 16, v18
    v_and_b32 v189, 0xffff0000, v18
    v_pk_mul_f32 v[188:189], v[188:189], v[164:165]
    v_cvt_pk_bf16_f32 v18, v188, v189
    v_mfma_f32_16x16x32_bf16 a[60:63], v[136:139], v[40:43], a[60:63]
    v_lshlrev_b32 v190, 16, v19
    v_and_b32 v191, 0xffff0000, v19
    v_pk_mul_f32 v[190:191], v[190:191], v[166:167]
    v_cvt_pk_bf16_f32 v19, v190, v191
    v_mfma_f32_16x16x32_bf16 a[64:67], v[140:143], v[40:43], a[64:67]
    v_lshlrev_b32 v184, 16, v20
    v_and_b32 v185, 0xffff0000, v20
    v_pk_mul_f32 v[184:185], v[184:185], v[160:161]
    v_cvt_pk_bf16_f32 v20, v184, v185
    v_mfma_f32_16x16x32_bf16 a[68:71], v[144:147], v[40:43], a[68:71]
    v_lshlrev_b32 v186, 16, v21
    v_and_b32 v187, 0xffff0000, v21
    v_pk_mul_f32 v[186:187], v[186:187], v[162:163]
    v_cvt_pk_bf16_f32 v21, v186, v187
    v_mfma_f32_16x16x32_bf16 a[72:75], v[148:151], v[40:43], a[72:75]
    v_lshlrev_b32 v188, 16, v22
    v_and_b32 v189, 0xffff0000, v22
    v_pk_mul_f32 v[188:189], v[188:189], v[164:165]
    v_cvt_pk_bf16_f32 v22, v188, v189
    v_mfma_f32_16x16x32_bf16 a[76:79], v[152:155], v[40:43], a[76:79]
    v_lshlrev_b32 v190, 16, v23
    v_and_b32 v191, 0xffff0000, v23
    v_pk_mul_f32 v[190:191], v[190:191], v[166:167]
    v_cvt_pk_bf16_f32 v23, v190, v191
    v_mfma_f32_16x16x32_bf16 a[80:83], v[156:159], v[40:43], a[80:83]
    v_lshlrev_b32 v184, 16, v24
    v_and_b32 v185, 0xffff0000, v24
    v_pk_mul_f32 v[184:185], v[184:185], v[160:161]
    v_cvt_pk_bf16_f32 v24, v184, v185
    v_mfma_f32_16x16x32_bf16 a[120:123], v[180:183], v[40:43], a[120:123]
    v_lshlrev_b32 v186, 16, v25
    v_and_b32 v187, 0xffff0000, v25
    v_pk_mul_f32 v[186:187], v[186:187], v[162:163]
    v_cvt_pk_bf16_f32 v25, v186, v187
    v_mfma_f32_16x16x32_bf16 a[84:87], v[132:135], v[44:47], a[84:87]
    v_lshlrev_b32 v188, 16, v26
    v_and_b32 v189, 0xffff0000, v26
    v_pk_mul_f32 v[188:189], v[188:189], v[164:165]
    v_mfma_f32_16x16x32_bf16 a[88:91], v[136:139], v[44:47], a[88:91]
    v_cvt_pk_bf16_f32 v26, v188, v189
    v_lshlrev_b32 v190, 16, v27
    v_and_b32 v191, 0xffff0000, v27
    v_mfma_f32_16x16x32_bf16 a[92:95], v[140:143], v[44:47], a[92:95]
    v_pk_mul_f32 v[190:191], v[190:191], v[166:167]
    v_cvt_pk_bf16_f32 v27, v190, v191
    v_lshlrev_b32 v184, 16, v28
    v_mfma_f32_16x16x32_bf16 a[96:99], v[144:147], v[44:47], a[96:99]
    v_and_b32 v185, 0xffff0000, v28
    v_pk_mul_f32 v[184:185], v[184:185], v[160:161]
    v_cvt_pk_bf16_f32 v28, v184, v185
    v_mfma_f32_16x16x32_bf16 a[100:103], v[148:151], v[44:47], a[100:103]
    v_lshlrev_b32 v186, 16, v29
    v_and_b32 v187, 0xffff0000, v29
    v_pk_mul_f32 v[186:187], v[186:187], v[162:163]
    v_mfma_f32_16x16x32_bf16 a[104:107], v[152:155], v[44:47], a[104:107]
    v_cvt_pk_bf16_f32 v29, v186, v187
    v_lshlrev_b32 v188, 16, v30
    v_and_b32 v189, 0xffff0000, v30
    v_mfma_f32_16x16x32_bf16 a[108:111], v[156:159], v[44:47], a[108:111]
    v_pk_mul_f32 v[188:189], v[188:189], v[164:165]
    v_cvt_pk_bf16_f32 v30, v188, v189
    v_lshlrev_b32 v190, 16, v31
    v_mfma_f32_16x16x32_bf16 a[124:127], v[180:183], v[44:47], a[124:127]
    v_and_b32 v191, 0xffff0000, v31
    v_pk_mul_f32 v[190:191], v[190:191], v[166:167]
    v_cvt_pk_bf16_f32 v31, v190, v191
    s_waitcnt vmcnt(23)
    v_mfma_f32_16x16x32_bf16 a[0:3], v[48:51], v[16:19], a[0:3]
    ds_read_b128 v[32:35], v7 offset:0
    v_mfma_f32_16x16x32_bf16 a[4:7], v[52:55], v[16:19], a[4:7]
    ds_read_b128 v[36:39], v7 offset:2048
    v_mfma_f32_16x16x32_bf16 a[8:11], v[56:59], v[16:19], a[8:11]
    ds_read_b128 v[40:43], v7 offset:4096
    v_mfma_f32_16x16x32_bf16 a[12:15], v[60:63], v[16:19], a[12:15]
    ds_read_b128 v[44:47], v7 offset:6144
    v_mfma_f32_16x16x32_bf16 a[16:19], v[64:67], v[16:19], a[16:19]
    ds_read_b128 v[168:171], v4 offset:1664
    v_mfma_f32_16x16x32_bf16 a[20:23], v[68:71], v[16:19], a[20:23]
    ds_read_b128 v[172:175], v4 offset:1680
    v_mfma_f32_16x16x32_bf16 a[24:27], v[72:75], v[16:19], a[24:27]
    ds_read_b128 v[180:183], v5 offset:832
    v_mfma_f32_16x16x32_bf16 a[112:115], v[176:179], v[16:19], a[112:115]
    buffer_load_dwordx4 v[132:135], v12, s[60:63], s12 offen offset:0 sc1
    v_mfma_f32_16x16x32_bf16 a[28:31], v[48:51], v[20:23], a[28:31]
    buffer_load_dwordx4 v[136:139], v12, s[60:63], s12 offen offset:1024 sc1
    v_mfma_f32_16x16x32_bf16 a[32:35], v[52:55], v[20:23], a[32:35]
    buffer_load_dwordx4 v[140:143], v12, s[60:63], s12 offen offset:2048 sc1
    v_mfma_f32_16x16x32_bf16 a[36:39], v[56:59], v[20:23], a[36:39]
    buffer_load_dwordx4 v[144:147], v12, s[60:63], s12 offen offset:3072 sc1
    v_mfma_f32_16x16x32_bf16 a[40:43], v[60:63], v[20:23], a[40:43]
    buffer_load_dwordx4 v[148:151], v3, s[60:63], s12 offen offset:0 sc1
    v_mfma_f32_16x16x32_bf16 a[44:47], v[64:67], v[20:23], a[44:47]
    buffer_load_dwordx4 v[152:155], v3, s[60:63], s12 offen offset:1024 sc1
    v_mfma_f32_16x16x32_bf16 a[48:51], v[68:71], v[20:23], a[48:51]
    buffer_load_dwordx4 v[156:159], v3, s[60:63], s12 offen offset:2048 sc1
    s_add_u32 s12, s12, 55296
    s_waitcnt lgkmcnt(0)
    v_mfma_f32_16x16x32_bf16 a[52:55], v[72:75], v[20:23], a[52:55]
    v_lshlrev_b32 v184, 16, v32
    v_and_b32 v185, 0xffff0000, v32
    v_pk_mul_f32 v[184:185], v[184:185], v[168:169]
    v_cvt_pk_bf16_f32 v32, v184, v185
    v_mfma_f32_16x16x32_bf16 a[116:119], v[176:179], v[20:23], a[116:119]
    v_lshlrev_b32 v186, 16, v33
    v_and_b32 v187, 0xffff0000, v33
    v_pk_mul_f32 v[186:187], v[186:187], v[170:171]
    v_cvt_pk_bf16_f32 v33, v186, v187
    v_mfma_f32_16x16x32_bf16 a[56:59], v[48:51], v[24:27], a[56:59]
    v_lshlrev_b32 v188, 16, v34
    v_and_b32 v189, 0xffff0000, v34
    v_pk_mul_f32 v[188:189], v[188:189], v[172:173]
    v_cvt_pk_bf16_f32 v34, v188, v189
    v_mfma_f32_16x16x32_bf16 a[60:63], v[52:55], v[24:27], a[60:63]
    v_lshlrev_b32 v190, 16, v35
    v_and_b32 v191, 0xffff0000, v35
    v_pk_mul_f32 v[190:191], v[190:191], v[174:175]
    v_cvt_pk_bf16_f32 v35, v190, v191
    v_mfma_f32_16x16x32_bf16 a[64:67], v[56:59], v[24:27], a[64:67]
    v_lshlrev_b32 v184, 16, v36
    v_and_b32 v185, 0xffff0000, v36
    v_pk_mul_f32 v[184:185], v[184:185], v[168:169]
    v_cvt_pk_bf16_f32 v36, v184, v185
    v_mfma_f32_16x16x32_bf16 a[68:71], v[60:63], v[24:27], a[68:71]
    v_lshlrev_b32 v186, 16, v37
    v_and_b32 v187, 0xffff0000, v37
    v_pk_mul_f32 v[186:187], v[186:187], v[170:171]
    v_cvt_pk_bf16_f32 v37, v186, v187
    v_mfma_f32_16x16x32_bf16 a[72:75], v[64:67], v[24:27], a[72:75]
    v_lshlrev_b32 v188, 16, v38
    v_and_b32 v189, 0xffff0000, v38
    v_pk_mul_f32 v[188:189], v[188:189], v[172:173]
    v_cvt_pk_bf16_f32 v38, v188, v189
    v_mfma_f32_16x16x32_bf16 a[76:79], v[68:71], v[24:27], a[76:79]
    v_lshlrev_b32 v190, 16, v39
    v_and_b32 v191, 0xffff0000, v39
    v_pk_mul_f32 v[190:191], v[190:191], v[174:175]
    v_cvt_pk_bf16_f32 v39, v190, v191
    v_mfma_f32_16x16x32_bf16 a[80:83], v[72:75], v[24:27], a[80:83]
    v_lshlrev_b32 v184, 16, v40
    v_and_b32 v185, 0xffff0000, v40
    v_pk_mul_f32 v[184:185], v[184:185], v[168:169]
    v_cvt_pk_bf16_f32 v40, v184, v185
    v_mfma_f32_16x16x32_bf16 a[120:123], v[176:179], v[24:27], a[120:123]
    v_lshlrev_b32 v186, 16, v41
    v_and_b32 v187, 0xffff0000, v41
    v_pk_mul_f32 v[186:187], v[186:187], v[170:171]
    v_cvt_pk_bf16_f32 v41, v186, v187
    v_mfma_f32_16x16x32_bf16 a[84:87], v[48:51], v[28:31], a[84:87]
    v_lshlrev_b32 v188, 16, v42
    v_and_b32 v189, 0xffff0000, v42
    v_pk_mul_f32 v[188:189], v[188:189], v[172:173]
    v_mfma_f32_16x16x32_bf16 a[88:91], v[52:55], v[28:31], a[88:91]
    v_cvt_pk_bf16_f32 v42, v188, v189
    v_lshlrev_b32 v190, 16, v43
    v_and_b32 v191, 0xffff0000, v43
    v_mfma_f32_16x16x32_bf16 a[92:95], v[56:59], v[28:31], a[92:95]
    v_pk_mul_f32 v[190:191], v[190:191], v[174:175]
    v_cvt_pk_bf16_f32 v43, v190, v191
    v_lshlrev_b32 v184, 16, v44
    v_mfma_f32_16x16x32_bf16 a[96:99], v[60:63], v[28:31], a[96:99]
    v_and_b32 v185, 0xffff0000, v44
    v_pk_mul_f32 v[184:185], v[184:185], v[168:169]
    v_cvt_pk_bf16_f32 v44, v184, v185
    v_mfma_f32_16x16x32_bf16 a[100:103], v[64:67], v[28:31], a[100:103]
    v_lshlrev_b32 v186, 16, v45
    v_and_b32 v187, 0xffff0000, v45
    v_pk_mul_f32 v[186:187], v[186:187], v[170:171]
    v_mfma_f32_16x16x32_bf16 a[104:107], v[68:71], v[28:31], a[104:107]
    v_cvt_pk_bf16_f32 v45, v186, v187
    v_lshlrev_b32 v188, 16, v46
    v_and_b32 v189, 0xffff0000, v46
    v_mfma_f32_16x16x32_bf16 a[108:111], v[72:75], v[28:31], a[108:111]
    v_pk_mul_f32 v[188:189], v[188:189], v[172:173]
    v_cvt_pk_bf16_f32 v46, v188, v189
    v_lshlrev_b32 v190, 16, v47
    v_mfma_f32_16x16x32_bf16 a[124:127], v[176:179], v[28:31], a[124:127]
    v_and_b32 v191, 0xffff0000, v47
    v_pk_mul_f32 v[190:191], v[190:191], v[174:175]
    v_cvt_pk_bf16_f32 v47, v190, v191
    s_waitcnt vmcnt(15)
    s_waitcnt vmcnt(7)
    v_cmp_eq_u32 vcc, 0, v15
    s_nop 0
    s_cmp_eq_u64 vcc, 0
    s_cbranch_scc1 kg_z1ok
    s_mov_b32 s3, 0
kg_pollZ:
    buffer_load_dword v15, v2, s[84:87], s11 offen sc1
    s_waitcnt vmcnt(0)
    v_cmp_eq_u32 vcc, 0, v15
    s_nop 0
    s_cmp_eq_u64 vcc, 0
    s_cbranch_scc1 kg_rdyZ
    s_add_u32 s3, s3, 1
    s_cmp_lt_u32 s3, 100000
    s_cbranch_scc0 kg_rdyZ
    s_sleep 4
    s_branch kg_pollZ
kg_rdyZ:
kg_z1ok:
    v_mfma_f32_16x16x32_bf16 a[0:3], v[76:79], v[32:35], a[0:3]
    ds_read_b128 v[16:19], v6 offset:32768
    v_mfma_f32_16x16x32_bf16 a[4:7], v[80:83], v[32:35], a[4:7]
    ds_read_b128 v[20:23], v6 offset:34816
    v_mfma_f32_16x16x32_bf16 a[8:11], v[84:87], v[32:35], a[8:11]
    ds_read_b128 v[24:27], v6 offset:36864
    v_mfma_f32_16x16x32_bf16 a[12:15], v[88:91], v[32:35], a[12:15]
    ds_read_b128 v[28:31], v6 offset:38912
    v_mfma_f32_16x16x32_bf16 a[16:19], v[92:95], v[32:35], a[16:19]
    ds_read_b128 v[160:163], v4 offset:1792
    v_mfma_f32_16x16x32_bf16 a[20:23], v[96:99], v[32:35], a[20:23]
    ds_read_b128 v[164:167], v4 offset:1808
    v_mfma_f32_16x16x32_bf16 a[24:27], v[100:103], v[32:35], a[24:27]
    ds_read_b128 v[176:179], v5 offset:896
    v_mfma_f32_16x16x32_bf16 a[112:115], v[180:183], v[32:35], a[112:115]
    s_add_u32 s13, s8, 0
    s_lshl_b32 s76, s13, 16
    buffer_load_dwordx2 v[192:193], v217, s[64:67], s76 offen sc1
    v_mfma_f32_16x16x32_bf16 a[28:31], v[76:79], v[36:39], a[28:31]
    s_add_u32 s13, s8, 1
    s_lshl_b32 s77, s13, 16
    buffer_load_dwordx2 v[194:195], v217, s[64:67], s77 offen sc1
    v_mfma_f32_16x16x32_bf16 a[32:35], v[80:83], v[36:39], a[32:35]
    s_add_u32 s13, s8, 2
    s_lshl_b32 s78, s13, 16
    buffer_load_dwordx2 v[196:197], v217, s[64:67], s78 offen sc1
    v_mfma_f32_16x16x32_bf16 a[36:39], v[84:87], v[36:39], a[36:39]
    s_add_u32 s13, s8, 3
    s_lshl_b32 s79, s13, 16
    buffer_load_dwordx2 v[198:199], v217, s[64:67], s79 offen sc1
    v_mfma_f32_16x16x32_bf16 a[40:43], v[88:91], v[36:39], a[40:43]
    s_add_u32 s13, s8, 4
    s_lshl_b32 s80, s13, 16
    buffer_load_dwordx2 v[200:201], v217, s[64:67], s80 offen sc1
    v_mfma_f32_16x16x32_bf16 a[44:47], v[92:95], v[36:39], a[44:47]
    s_add_u32 s13, s8, 5
    s_lshl_b32 s81, s13, 16
    buffer_load_dwordx2 v[202:203], v217, s[64:67], s81 offen sc1
    v_mfma_f32_16x16x32_bf16 a[48:51], v[96:99], v[36:39], a[48:51]
    s_add_u32 s13, s8, 6
    s_lshl_b32 s82, s13, 16
    buffer_load_dwordx2 v[204:205], v217, s[64:67], s82 offen sc1
    s_waitcnt lgkmcnt(0)
    v_mfma_f32_16x16x32_bf16 a[52:55], v[100:103], v[36:39], a[52:55]
    v_lshlrev_b32 v184, 16, v16
    v_and_b32 v185, 0xffff0000, v16
    v_pk_mul_f32 v[184:185], v[184:185], v[160:161]
    v_cvt_pk_bf16_f32 v16, v184, v185
    v_mfma_f32_16x16x32_bf16 a[116:119], v[180:183], v[36:39], a[116:119]
    v_lshlrev_b32 v186, 16, v17
    v_and_b32 v187, 0xffff0000, v17
    v_pk_mul_f32 v[186:187], v[186:187], v[162:163]
    v_cvt_pk_bf16_f32 v17, v186, v187
    v_mfma_f32_16x16x32_bf16 a[56:59], v[76:79], v[40:43], a[56:59]
    v_lshlrev_b32 v188, 16, v18
    v_and_b32 v189, 0xffff0000, v18
    v_pk_mul_f32 v[188:189], v[188:189], v[164:165]
    v_cvt_pk_bf16_f32 v18, v188, v189
    v_mfma_f32_16x16x32_bf16 a[60:63], v[80:83], v[40:43], a[60:63]
    v_lshlrev_b32 v190, 16, v19
    v_and_b32 v191, 0xffff0000, v19
    v_pk_mul_f32 v[190:191], v[190:191], v[166:167]
    v_cvt_pk_bf16_f32 v19, v190, v191
    v_mfma_f32_16x16x32_bf16 a[64:67], v[84:87], v[40:43], a[64:67]
    v_lshlrev_b32 v184, 16, v20
    v_and_b32 v185, 0xffff0000, v20
    v_pk_mul_f32 v[184:185], v[184:185], v[160:161]
    v_cvt_pk_bf16_f32 v20, v184, v185
    v_mfma_f32_16x16x32_bf16 a[68:71], v[88:91], v[40:43], a[68:71]
    v_lshlrev_b32 v186, 16, v21
    v_and_b32 v187, 0xffff0000, v21
    v_pk_mul_f32 v[186:187], v[186:187], v[162:163]
    v_cvt_pk_bf16_f32 v21, v186, v187
    v_mfma_f32_16x16x32_bf16 a[72:75], v[92:95], v[40:43], a[72:75]
    v_lshlrev_b32 v188, 16, v22
    v_and_b32 v189, 0xffff0000, v22
    v_pk_mul_f32 v[188:189], v[188:189], v[164:165]
    v_cvt_pk_bf16_f32 v22, v188, v189
    v_mfma_f32_16x16x32_bf16 a[76:79], v[96:99], v[40:43], a[76:79]
    v_lshlrev_b32 v190, 16, v23
    v_and_b32 v191, 0xffff0000, v23
    v_pk_mul_f32 v[190:191], v[190:191], v[166:167]
    v_cvt_pk_bf16_f32 v23, v190, v191
    v_mfma_f32_16x16x32_bf16 a[80:83], v[100:103], v[40:43], a[80:83]
    v_lshlrev_b32 v184, 16, v24
    v_and_b32 v185, 0xffff0000, v24
    v_pk_mul_f32 v[184:185], v[184:185], v[160:161]
    v_cvt_pk_bf16_f32 v24, v184, v185
    v_mfma_f32_16x16x32_bf16 a[120:123], v[180:183], v[40:43], a[120:123]
    v_lshlrev_b32 v186, 16, v25
    v_and_b32 v187, 0xffff0000, v25
    v_pk_mul_f32 v[186:187], v[186:187], v[162:163]
    v_cvt_pk_bf16_f32 v25, v186, v187
    v_mfma_f32_16x16x32_bf16 a[84:87], v[76:79], v[44:47], a[84:87]
    v_lshlrev_b32 v188, 16, v26
    v_and_b32 v189, 0xffff0000, v26
    v_pk_mul_f32 v[188:189], v[188:189], v[164:165]
    v_mfma_f32_16x16x32_bf16 a[88:91], v[80:83], v[44:47], a[88:91]
    v_cvt_pk_bf16_f32 v26, v188, v189
    v_lshlrev_b32 v190, 16, v27
    v_and_b32 v191, 0xffff0000, v27
    v_mfma_f32_16x16x32_bf16 a[92:95], v[84:87], v[44:47], a[92:95]
    v_pk_mul_f32 v[190:191], v[190:191], v[166:167]
    v_cvt_pk_bf16_f32 v27, v190, v191
    v_lshlrev_b32 v184, 16, v28
    v_mfma_f32_16x16x32_bf16 a[96:99], v[88:91], v[44:47], a[96:99]
    v_and_b32 v185, 0xffff0000, v28
    v_pk_mul_f32 v[184:185], v[184:185], v[160:161]
    v_cvt_pk_bf16_f32 v28, v184, v185
    v_mfma_f32_16x16x32_bf16 a[100:103], v[92:95], v[44:47], a[100:103]
    v_lshlrev_b32 v186, 16, v29
    v_and_b32 v187, 0xffff0000, v29
    v_pk_mul_f32 v[186:187], v[186:187], v[162:163]
    v_mfma_f32_16x16x32_bf16 a[104:107], v[96:99], v[44:47], a[104:107]
    v_cvt_pk_bf16_f32 v29, v186, v187
    v_lshlrev_b32 v188, 16, v30
    v_and_b32 v189, 0xffff0000, v30
    v_mfma_f32_16x16x32_bf16 a[108:111], v[100:103], v[44:47], a[108:111]
    v_pk_mul_f32 v[188:189], v[188:189], v[164:165]
    v_cvt_pk_bf16_f32 v30, v188, v189
    v_lshlrev_b32 v190, 16, v31
    v_mfma_f32_16x16x32_bf16 a[124:127], v[180:183], v[44:47], a[124:127]
    v_and_b32 v191, 0xffff0000, v31
    v_pk_mul_f32 v[190:191], v[190:191], v[166:167]
    v_cvt_pk_bf16_f32 v31, v190, v191
    s_waitcnt vmcnt(15)
    v_mfma_f32_16x16x32_bf16 a[0:3], v[104:107], v[16:19], a[0:3]
    ds_read_b128 v[32:35], v7 offset:32768
    v_mfma_f32_16x16x32_bf16 a[4:7], v[108:111], v[16:19], a[4:7]
    ds_read_b128 v[36:39], v7 offset:34816
    v_mfma_f32_16x16x32_bf16 a[8:11], v[112:115], v[16:19], a[8:11]
    ds_read_b128 v[40:43], v7 offset:36864
    v_mfma_f32_16x16x32_bf16 a[12:15], v[116:119], v[16:19], a[12:15]
    ds_read_b128 v[44:47], v7 offset:38912
    v_mfma_f32_16x16x32_bf16 a[16:19], v[120:123], v[16:19], a[16:19]
    ds_read_b128 v[168:171], v4 offset:1920
    v_mfma_f32_16x16x32_bf16 a[20:23], v[124:127], v[16:19], a[20:23]
    ds_read_b128 v[172:175], v4 offset:1936
    v_mfma_f32_16x16x32_bf16 a[24:27], v[128:131], v[16:19], a[24:27]
    ds_read_b128 v[180:183], v5 offset:960
    v_mfma_f32_16x16x32_bf16 a[112:115], v[176:179], v[16:19], a[112:115]
    v_mfma_f32_16x16x32_bf16 a[28:31], v[104:107], v[20:23], a[28:31]
    v_mfma_f32_16x16x32_bf16 a[32:35], v[108:111], v[20:23], a[32:35]
    v_mfma_f32_16x16x32_bf16 a[36:39], v[112:115], v[20:23], a[36:39]
    v_mfma_f32_16x16x32_bf16 a[40:43], v[116:119], v[20:23], a[40:43]
    v_mfma_f32_16x16x32_bf16 a[44:47], v[120:123], v[20:23], a[44:47]
    v_mfma_f32_16x16x32_bf16 a[48:51], v[124:127], v[20:23], a[48:51]
    s_waitcnt lgkmcnt(0)
    v_mfma_f32_16x16x32_bf16 a[52:55], v[128:131], v[20:23], a[52:55]
    v_lshlrev_b32 v184, 16, v32
    v_and_b32 v185, 0xffff0000, v32
    v_pk_mul_f32 v[184:185], v[184:185], v[168:169]
    v_cvt_pk_bf16_f32 v32, v184, v185
    v_mfma_f32_16x16x32_bf16 a[116:119], v[176:179], v[20:23], a[116:119]
    v_lshlrev_b32 v186, 16, v33
    v_and_b32 v187, 0xffff0000, v33
    v_pk_mul_f32 v[186:187], v[186:187], v[170:171]
    v_cvt_pk_bf16_f32 v33, v186, v187
    v_mfma_f32_16x16x32_bf16 a[56:59], v[104:107], v[24:27], a[56:59]
    v_lshlrev_b32 v188, 16, v34
    v_and_b32 v189, 0xffff0000, v34
    v_pk_mul_f32 v[188:189], v[188:189], v[172:173]
    v_cvt_pk_bf16_f32 v34, v188, v189
    v_mfma_f32_16x16x32_bf16 a[60:63], v[108:111], v[24:27], a[60:63]
    v_lshlrev_b32 v190, 16, v35
    v_and_b32 v191, 0xffff0000, v35
    v_pk_mul_f32 v[190:191], v[190:191], v[174:175]
    v_cvt_pk_bf16_f32 v35, v190, v191
    v_mfma_f32_16x16x32_bf16 a[64:67], v[112:115], v[24:27], a[64:67]
    v_lshlrev_b32 v184, 16, v36
    v_and_b32 v185, 0xffff0000, v36
    v_pk_mul_f32 v[184:185], v[184:185], v[168:169]
    v_cvt_pk_bf16_f32 v36, v184, v185
    v_mfma_f32_16x16x32_bf16 a[68:71], v[116:119], v[24:27], a[68:71]
    v_lshlrev_b32 v186, 16, v37
    v_and_b32 v187, 0xffff0000, v37
    v_pk_mul_f32 v[186:187], v[186:187], v[170:171]
    v_cvt_pk_bf16_f32 v37, v186, v187
    v_mfma_f32_16x16x32_bf16 a[72:75], v[120:123], v[24:27], a[72:75]
    v_lshlrev_b32 v188, 16, v38
    v_and_b32 v189, 0xffff0000, v38
    v_pk_mul_f32 v[188:189], v[188:189], v[172:173]
    v_cvt_pk_bf16_f32 v38, v188, v189
    v_mfma_f32_16x16x32_bf16 a[76:79], v[124:127], v[24:27], a[76:79]
    v_lshlrev_b32 v190, 16, v39
    v_and_b32 v191, 0xffff0000, v39
    v_pk_mul_f32 v[190:191], v[190:191], v[174:175]
    v_cvt_pk_bf16_f32 v39, v190, v191
    v_mfma_f32_16x16x32_bf16 a[80:83], v[128:131], v[24:27], a[80:83]
    v_lshlrev_b32 v184, 16, v40
    v_and_b32 v185, 0xffff0000, v40
    v_pk_mul_f32 v[184:185], v[184:185], v[168:169]
    v_cvt_pk_bf16_f32 v40, v184, v185
    v_mfma_f32_16x16x32_bf16 a[120:123], v[176:179], v[24:27], a[120:123]
    v_lshlrev_b32 v186, 16, v41
    v_and_b32 v187, 0xffff0000, v41
    v_pk_mul_f32 v[186:187], v[186:187], v[170:171]
    v_cvt_pk_bf16_f32 v41, v186, v187
    v_mfma_f32_16x16x32_bf16 a[84:87], v[104:107], v[28:31], a[84:87]
    v_lshlrev_b32 v188, 16, v42
    v_and_b32 v189, 0xffff0000, v42
    v_pk_mul_f32 v[188:189], v[188:189], v[172:173]
    v_mfma_f32_16x16x32_bf16 a[88:91], v[108:111], v[28:31], a[88:91]
    v_cvt_pk_bf16_f32 v42, v188, v189
    v_lshlrev_b32 v190, 16, v43
    v_and_b32 v191, 0xffff0000, v43
    v_mfma_f32_16x16x32_bf16 a[92:95], v[112:115], v[28:31], a[92:95]
    v_pk_mul_f32 v[190:191], v[190:191], v[174:175]
    v_cvt_pk_bf16_f32 v43, v190, v191
    v_lshlrev_b32 v184, 16, v44
    v_mfma_f32_16x16x32_bf16 a[96:99], v[116:119], v[28:31], a[96:99]
    v_and_b32 v185, 0xffff0000, v44
    v_pk_mul_f32 v[184:185], v[184:185], v[168:169]
    v_cvt_pk_bf16_f32 v44, v184, v185
    v_mfma_f32_16x16x32_bf16 a[100:103], v[120:123], v[28:31], a[100:103]
    v_lshlrev_b32 v186, 16, v45
    v_and_b32 v187, 0xffff0000, v45
    v_pk_mul_f32 v[186:187], v[186:187], v[170:171]
    v_mfma_f32_16x16x32_bf16 a[104:107], v[124:127], v[28:31], a[104:107]
    v_cvt_pk_bf16_f32 v45, v186, v187
    v_lshlrev_b32 v188, 16, v46
    v_and_b32 v189, 0xffff0000, v46
    v_mfma_f32_16x16x32_bf16 a[108:111], v[128:131], v[28:31], a[108:111]
    v_pk_mul_f32 v[188:189], v[188:189], v[172:173]
    v_cvt_pk_bf16_f32 v46, v188, v189
    v_lshlrev_b32 v190, 16, v47
    v_mfma_f32_16x16x32_bf16 a[124:127], v[176:179], v[28:31], a[124:127]
    v_and_b32 v191, 0xffff0000, v47
    v_pk_mul_f32 v[190:191], v[190:191], v[174:175]
    v_cvt_pk_bf16_f32 v47, v190, v191
    s_waitcnt vmcnt(7)
    v_mfma_f32_16x16x32_bf16 a[0:3], v[132:135], v[32:35], a[0:3]
    v_mfma_f32_16x16x32_bf16 a[4:7], v[136:139], v[32:35], a[4:7]
    v_mfma_f32_16x16x32_bf16 a[8:11], v[140:143], v[32:35], a[8:11]
    v_mfma_f32_16x16x32_bf16 a[12:15], v[144:147], v[32:35], a[12:15]
    v_mfma_f32_16x16x32_bf16 a[16:19], v[148:151], v[32:35], a[16:19]
    v_mfma_f32_16x16x32_bf16 a[20:23], v[152:155], v[32:35], a[20:23]
    v_mfma_f32_16x16x32_bf16 a[24:27], v[156:159], v[32:35], a[24:27]
    v_mfma_f32_16x16x32_bf16 a[112:115], v[180:183], v[32:35], a[112:115]
    v_mfma_f32_16x16x32_bf16 a[28:31], v[132:135], v[36:39], a[28:31]
    v_mfma_f32_16x16x32_bf16 a[32:35], v[136:139], v[36:39], a[32:35]
    v_mfma_f32_16x16x32_bf16 a[36:39], v[140:143], v[36:39], a[36:39]
    v_mfma_f32_16x16x32_bf16 a[40:43], v[144:147], v[36:39], a[40:43]
    v_mfma_f32_16x16x32_bf16 a[44:47], v[148:151], v[36:39], a[44:47]
    v_mfma_f32_16x16x32_bf16 a[48:51], v[152:155], v[36:39], a[48:51]
    v_mfma_f32_16x16x32_bf16 a[52:55], v[156:159], v[36:39], a[52:55]
    v_mfma_f32_16x16x32_bf16 a[116:119], v[180:183], v[36:39], a[116:119]
    v_mfma_f32_16x16x32_bf16 a[56:59], v[132:135], v[40:43], a[56:59]
    v_mfma_f32_16x16x32_bf16 a[60:63], v[136:139], v[40:43], a[60:63]
    v_mfma_f32_16x16x32_bf16 a[64:67], v[140:143], v[40:43], a[64:67]
    v_mfma_f32_16x16x32_bf16 a[68:71], v[144:147], v[40:43], a[68:71]
    v_mfma_f32_16x16x32_bf16 a[72:75], v[148:151], v[40:43], a[72:75]
    v_mfma_f32_16x16x32_bf16 a[76:79], v[152:155], v[40:43], a[76:79]
    v_mfma_f32_16x16x32_bf16 a[80:83], v[156:159], v[40:43], a[80:83]
    v_mfma_f32_16x16x32_bf16 a[120:123], v[180:183], v[40:43], a[120:123]
    v_mfma_f32_16x16x32_bf16 a[84:87], v[132:135], v[44:47], a[84:87]
    v_mfma_f32_16x16x32_bf16 a[88:91], v[136:139], v[44:47], a[88:91]
    v_mfma_f32_16x16x32_bf16 a[92:95], v[140:143], v[44:47], a[92:95]
    v_mfma_f32_16x16x32_bf16 a[96:99], v[144:147], v[44:47], a[96:99]
    v_mfma_f32_16x16x32_bf16 a[100:103], v[148:151], v[44:47], a[100:103]
    v_mfma_f32_16x16x32_bf16 a[104:107], v[152:155], v[44:47], a[104:107]
    v_mfma_f32_16x16x32_bf16 a[108:111], v[156:159], v[44:47], a[108:111]
    v_mfma_f32_16x16x32_bf16 a[124:127], v[180:183], v[44:47], a[124:127]
    v_accvgpr_read_b32 v16, a112
    v_accvgpr_read_b32 v17, a113
    v_accvgpr_read_b32 v18, a116
    v_accvgpr_read_b32 v19, a117
    v_accvgpr_read_b32 v20, a120
    v_accvgpr_read_b32 v21, a121
    s_nop 1
    v_accvgpr_read_b32 v22, a124
    v_accvgpr_read_b32 v23, a125
    s_lshl_b32 s5, s4, 8
    s_add_u32 s5, s5, 115712
    v_lshlrev_b32 v15, 2, v13
    v_add_u32 v11, s5, v15
    v_add_f32 v16, v16, v17
    v_add_f32 v18, v18, v19
    v_add_f32 v20, v20, v21
    v_add_f32 v22, v22, v23
    s_mov_b64 exec, 0xffff
    ds_write_b32 v11, v16
    ds_write_b32 v11, v18 offset:64
    ds_write_b32 v11, v20 offset:128
    ds_write_b32 v11, v22 offset:192
    s_mov_b64 exec, -1
    s_barrier
    s_cmp_eq_u32 s4, 0
    s_cbranch_scc0 kgB_red_0
    v_add_u32 v11, 35840, v12
    ds_write_b128 v11, a[28:31] offset:0
    ds_write_b128 v11, a[32:35] offset:1024
    ds_write_b128 v11, a[36:39] offset:2048
    ds_write_b128 v11, a[40:43] offset:3072
    ds_write_b128 v11, a[44:47] offset:4096
    ds_write_b128 v11, a[48:51] offset:5120
    ds_write_b128 v11, a[52:55] offset:6144
    v_add_u32 v11, 50176, v12
    ds_write_b128 v11, a[56:59] offset:0
    ds_write_b128 v11, a[60:63] offset:1024
    ds_write_b128 v11, a[64:67] offset:2048
    ds_write_b128 v11, a[68:71] offset:3072
    ds_write_b128 v11, a[72:75] offset:4096
    ds_write_b128 v11, a[76:79] offset:5120
    ds_write_b128 v11, a[80:83] offset:6144
    v_add_u32 v11, 64512, v12
    ds_write_b128 v11, a[84:87] offset:0
    ds_write_b128 v11, a[88:91] offset:1024
    ds_write_b128 v11, a[92:95] offset:2048
    ds_write_b128 v11, a[96:99] offset:3072
    ds_write_b128 v11, a[100:103] offset:4096
    ds_write_b128 v11, a[104:107] offset:5120
    ds_write_b128 v11, a[108:111] offset:6144
    v_accvgpr_read_b32 v16, a0
    v_accvgpr_read_b32 v17, a1
    v_accvgpr_read_b32 v18, a2
    v_accvgpr_read_b32 v19, a3
    v_accvgpr_read_b32 v20, a4
    v_accvgpr_read_b32 v21, a5
    v_accvgpr_read_b32 v22, a6
    v_accvgpr_read_b32 v23, a7
    v_accvgpr_read_b32 v24, a8
    v_accvgpr_read_b32 v25, a9
    v_accvgpr_read_b32 v26, a10
    v_accvgpr_read_b32 v27, a11
    v_accvgpr_read_b32 v28, a12
    v_accvgpr_read_b32 v29, a13
    v_accvgpr_read_b32 v30, a14
    v_accvgpr_read_b32 v31, a15
    v_accvgpr_read_b32 v32, a16
    v_accvgpr_read_b32 v33, a17
    v_accvgpr_read_b32 v34, a18
    v_accvgpr_read_b32 v35, a19
    v_accvgpr_read_b32 v36, a20
    v_accvgpr_read_b32 v37, a21
    v_accvgpr_read_b32 v38, a22
    v_accvgpr_read_b32 v39, a23
    v_accvgpr_read_b32 v40, a24
    v_accvgpr_read_b32 v41, a25
    v_accvgpr_read_b32 v42, a26
    v_accvgpr_read_b32 v43, a27
kgB_red_0:
    s_cmp_eq_u32 s4, 1
    s_cbranch_scc0 kgB_red_1
    v_add_u32 v11, 0, v12
    ds_write_b128 v11, a[0:3] offset:0
    ds_write_b128 v11, a[4:7] offset:1024
    ds_write_b128 v11, a[8:11] offset:2048
    ds_write_b128 v11, a[12:15] offset:3072
    ds_write_b128 v11, a[16:19] offset:4096
    ds_write_b128 v11, a[20:23] offset:5120
    ds_write_b128 v11, a[24:27] offset:6144
    v_add_u32 v11, 57344, v12
    ds_write_b128 v11, a[56:59] offset:0
    ds_write_b128 v11, a[60:63] offset:1024
    ds_write_b128 v11, a[64:67] offset:2048
    ds_write_b128 v11, a[68:71] offset:3072
    ds_write_b128 v11, a[72:75] offset:4096
    ds_write_b128 v11, a[76:79] offset:5120
    ds_write_b128 v11, a[80:83] offset:6144
    v_add_u32 v11, 71680, v12
    ds_write_b128 v11, a[84:87] offset:0
    ds_write_b128 v11, a[88:91] offset:1024
    ds_write_b128 v11, a[92:95] offset:2048
    ds_write_b128 v11, a[96:99] offset:3072
    ds_write_b128 v11, a[100:103] offset:4096
    ds_write_b128 v11, a[104:107] offset:5120
    ds_write_b128 v11, a[108:111] offset:6144
    v_accvgpr_read_b32 v16, a28
    v_accvgpr_read_b32 v17, a29
    v_accvgpr_read_b32 v18, a30
    v_accvgpr_read_b32 v19, a31
    v_accvgpr_read_b32 v20, a32
    v_accvgpr_read_b32 v21, a33
    v_accvgpr_read_b32 v22, a34
    v_accvgpr_read_b32 v23, a35
    v_accvgpr_read_b32 v24, a36
    v_accvgpr_read_b32 v25, a37
    v_accvgpr_read_b32 v26, a38
    v_accvgpr_read_b32 v27, a39
    v_accvgpr_read_b32 v28, a40
    v_accvgpr_read_b32 v29, a41
    v_accvgpr_read_b32 v30, a42
    v_accvgpr_read_b32 v31, a43
    v_accvgpr_read_b32 v32, a44
    v_accvgpr_read_b32 v33, a45
    v_accvgpr_read_b32 v34, a46
    v_accvgpr_read_b32 v35, a47
    v_accvgpr_read_b32 v36, a48
    v_accvgpr_read_b32 v37, a49
    v_accvgpr_read_b32 v38, a50
    v_accvgpr_read_b32 v39, a51
    v_accvgpr_read_b32 v40, a52
    v_accvgpr_read_b32 v41, a53
    v_accvgpr_read_b32 v42, a54
    v_accvgpr_read_b32 v43, a55
kgB_red_1:
    s_cmp_eq_u32 s4, 2
    s_cbranch_scc0 kgB_red_2
    v_add_u32 v11, 7168, v12
    ds_write_b128 v11, a[0:3] offset:0
    ds_write_b128 v11, a[4:7] offset:1024
    ds_write_b128 v11, a[8:11] offset:2048
    ds_write_b128 v11, a[12:15] offset:3072
    ds_write_b128 v11, a[16:19] offset:4096
    ds_write_b128 v11, a[20:23] offset:5120
    ds_write_b128 v11, a[24:27] offset:6144
    v_add_u32 v11, 21504, v12
    ds_write_b128 v11, a[28:31] offset:0
    ds_write_b128 v11, a[32:35] offset:1024
    ds_write_b128 v11, a[36:39] offset:2048
    ds_write_b128 v11, a[40:43] offset:3072
    ds_write_b128 v11, a[44:47] offset:4096
    ds_write_b128 v11, a[48:51] offset:5120
    ds_write_b128 v11, a[52:55] offset:6144
    v_add_u32 v11, 78848, v12
    ds_write_b128 v11, a[84:87] offset:0
    ds_write_b128 v11, a[88:91] offset:1024
    ds_write_b128 v11, a[92:95] offset:2048
    ds_write_b128 v11, a[96:99] offset:3072
    ds_write_b128 v11, a[100:103] offset:4096
    ds_write_b128 v11, a[104:107] offset:5120
    ds_write_b128 v11, a[108:111] offset:6144
    v_accvgpr_read_b32 v16, a56
    v_accvgpr_read_b32 v17, a57
    v_accvgpr_read_b32 v18, a58
    v_accvgpr_read_b32 v19, a59
    v_accvgpr_read_b32 v20, a60
    v_accvgpr_read_b32 v21, a61
    v_accvgpr_read_b32 v22, a62
    v_accvgpr_read_b32 v23, a63
    v_accvgpr_read_b32 v24, a64
    v_accvgpr_read_b32 v25, a65
    v_accvgpr_read_b32 v26, a66
    v_accvgpr_read_b32 v27, a67
    v_accvgpr_read_b32 v28, a68
    v_accvgpr_read_b32 v29, a69
    v_accvgpr_read_b32 v30, a70
    v_accvgpr_read_b32 v31, a71
    v_accvgpr_read_b32 v32, a72
    v_accvgpr_read_b32 v33, a73
    v_accvgpr_read_b32 v34, a74
    v_accvgpr_read_b32 v35, a75
    v_accvgpr_read_b32 v36, a76
    v_accvgpr_read_b32 v37, a77
    v_accvgpr_read_b32 v38, a78
    v_accvgpr_read_b32 v39, a79
    v_accvgpr_read_b32 v40, a80
    v_accvgpr_read_b32 v41, a81
    v_accvgpr_read_b32 v42, a82
    v_accvgpr_read_b32 v43, a83
kgB_red_2:
    s_cmp_eq_u32 s4, 3
    s_cbranch_scc0 kgB_red_3
    v_add_u32 v11, 14336, v12
    ds_write_b128 v11, a[0:3] offset:0
    ds_write_b128 v11, a[4:7] offset:1024
    ds_write_b128 v11, a[8:11] offset:2048
    ds_write_b128 v11, a[12:15] offset:3072
    ds_write_b128 v11, a[16:19] offset:4096
    ds_write_b128 v11, a[20:23] offset:5120
    ds_write_b128 v11, a[24:27] offset:6144
    v_add_u32 v11, 28672, v12
    ds_write_b128 v11, a[28:31] offset:0
    ds_write_b128 v11, a[32:35] offset:1024
    ds_write_b128 v11, a[36:39] offset:2048
    ds_write_b128 v11, a[40:43] offset:3072
    ds_write_b128 v11, a[44:47] offset:4096
    ds_write_b128 v11, a[48:51] offset:5120
    ds_write_b128 v11, a[52:55] offset:6144
    v_add_u32 v11, 43008, v12
    ds_write_b128 v11, a[56:59] offset:0
    ds_write_b128 v11, a[60:63] offset:1024
    ds_write_b128 v11, a[64:67] offset:2048
    ds_write_b128 v11, a[68:71] offset:3072
    ds_write_b128 v11, a[72:75] offset:4096
    ds_write_b128 v11, a[76:79] offset:5120
    ds_write_b128 v11, a[80:83] offset:6144
    v_accvgpr_read_b32 v16, a84
    v_accvgpr_read_b32 v17, a85
    v_accvgpr_read_b32 v18, a86
    v_accvgpr_read_b32 v19, a87
    v_accvgpr_read_b32 v20, a88
    v_accvgpr_read_b32 v21, a89
    v_accvgpr_read_b32 v22, a90
    v_accvgpr_read_b32 v23, a91
    v_accvgpr_read_b32 v24, a92
    v_accvgpr_read_b32 v25, a93
    v_accvgpr_read_b32 v26, a94
    v_accvgpr_read_b32 v27, a95
    v_accvgpr_read_b32 v28, a96
    v_accvgpr_read_b32 v29, a97
    v_accvgpr_read_b32 v30, a98
    v_accvgpr_read_b32 v31, a99
    v_accvgpr_read_b32 v32, a100
    v_accvgpr_read_b32 v33, a101
    v_accvgpr_read_b32 v34, a102
    v_accvgpr_read_b32 v35, a103
    v_accvgpr_read_b32 v36, a104
    v_accvgpr_read_b32 v37, a105
    v_accvgpr_read_b32 v38, a106
    v_accvgpr_read_b32 v39, a107
    v_accvgpr_read_b32 v40, a108
    v_accvgpr_read_b32 v41, a109
    v_accvgpr_read_b32 v42, a110
    v_accvgpr_read_b32 v43, a111
kgB_red_3:
    s_mul_i32 s14, s4, 21504
    v_add_u32 v11, s14, v12
    s_lshl_b32 s5, s4, 6
    s_add_u32 s5, s5, 115712
    v_add_u32 v15, s5, v15
    s_waitcnt lgkmcnt(0)
    s_barrier
    ds_read_b32 v140, v15
    ds_read_b32 v141, v15 offset:256
    ds_read_b32 v142, v15 offset:512
    ds_read_b32 v143, v15 offset:768
    ds_read_b128 v[48:51], v11 offset:0
    ds_read_b128 v[52:55], v11 offset:7168
    ds_read_b128 v[56:59], v11 offset:14336
    ds_read_b128 v[60:63], v11 offset:1024
    ds_read_b128 v[64:67], v11 offset:8192
    ds_read_b128 v[68:71], v11 offset:15360
    ds_read_b128 v[72:75], v11 offset:2048
    ds_read_b128 v[76:79], v11 offset:9216
    ds_read_b128 v[80:83], v11 offset:16384
    s_waitcnt lgkmcnt(9) vmcnt(0)
    v_lshlrev_b32 v206, 16, v206
    v_add_f32 v140, v140, v141
    v_add_f32 v142, v142, v143
    v_sub_f32 v206, v206, v140
    v_sub_f32 v206, v206, v142
    v_mov_b32 v207, v206
    ds_read_b128 v[84:87], v11 offset:3072
    ds_read_b128 v[88:91], v11 offset:10240
    ds_read_b128 v[92:95], v11 offset:17408
    ds_read_b128 v[96:99], v11 offset:4096
    ds_read_b128 v[100:103], v11 offset:11264
    ds_read_b128 v[104:107], v11 offset:18432
    ds_read_b128 v[108:111], v11 offset:5120
    ds_read_b128 v[112:115], v11 offset:12288
    ds_read_b128 v[116:119], v11 offset:19456
    ds_read_b128 v[120:123], v11 offset:6144
    ds_read_b128 v[124:127], v11 offset:13312
    ds_read_b128 v[128:131], v11 offset:20480
    s_waitcnt lgkmcnt(15)
    v_pk_add_f32 v[16:17], v[16:17], v[48:49]
    v_pk_add_f32 v[52:53], v[52:53], v[56:57]
    v_pk_add_f32 v[16:17], v[16:17], v[206:207]
    v_lshlrev_b32 v48, 16, v192
    v_and_b32 v49, 0xffff0000, v192
    v_pk_add_f32 v[16:17], v[16:17], v[52:53]
    v_pk_mul_f32 v[16:17], v[16:17], v[48:49]
    v_cvt_pk_bf16_f32 v192, v16, v17
    v_pk_add_f32 v[18:19], v[18:19], v[50:51]
    v_pk_add_f32 v[54:55], v[54:55], v[58:59]
    v_pk_add_f32 v[18:19], v[18:19], v[206:207]
    v_lshlrev_b32 v48, 16, v193
    v_and_b32 v49, 0xffff0000, v193
    v_pk_add_f32 v[18:19], v[18:19], v[54:55]
    v_pk_mul_f32 v[18:19], v[18:19], v[48:49]
    v_cvt_pk_bf16_f32 v193, v18, v19
    s_waitcnt lgkmcnt(15)
    v_pk_add_f32 v[20:21], v[20:21], v[60:61]
    v_pk_add_f32 v[64:65], v[64:65], v[68:69]
    v_pk_add_f32 v[20:21], v[20:21], v[206:207]
    v_lshlrev_b32 v60, 16, v194
    v_and_b32 v61, 0xffff0000, v194
    v_pk_add_f32 v[20:21], v[20:21], v[64:65]
    v_pk_mul_f32 v[20:21], v[20:21], v[60:61]
    v_cvt_pk_bf16_f32 v194, v20, v21
    v_pk_add_f32 v[22:23], v[22:23], v[62:63]
    v_pk_add_f32 v[66:67], v[66:67], v[70:71]
    v_pk_add_f32 v[22:23], v[22:23], v[206:207]
    v_lshlrev_b32 v60, 16, v195
    v_and_b32 v61, 0xffff0000, v195
    v_pk_add_f32 v[22:23], v[22:23], v[66:67]
    v_pk_mul_f32 v[22:23], v[22:23], v[60:61]
    v_cvt_pk_bf16_f32 v195, v22, v23
    s_waitcnt lgkmcnt(12)
    v_pk_add_f32 v[24:25], v[24:25], v[72:73]
    v_pk_add_f32 v[76:77], v[76:77], v[80:81]
    v_pk_add_f32 v[24:25], v[24:25], v[206:207]
    v_lshlrev_b32 v72, 16, v196
    v_and_b32 v73, 0xffff0000, v196
    v_pk_add_f32 v[24:25], v[24:25], v[76:77]
    v_pk_mul_f32 v[24:25], v[24:25], v[72:73]
    v_cvt_pk_bf16_f32 v196, v24, v25
    v_pk_add_f32 v[26:27], v[26:27], v[74:75]
    v_pk_add_f32 v[78:79], v[78:79], v[82:83]
    v_pk_add_f32 v[26:27], v[26:27], v[206:207]
    v_lshlrev_b32 v72, 16, v197
    v_and_b32 v73, 0xffff0000, v197
    v_pk_add_f32 v[26:27], v[26:27], v[78:79]
    v_pk_mul_f32 v[26:27], v[26:27], v[72:73]
    v_cvt_pk_bf16_f32 v197, v26, v27
    s_waitcnt lgkmcnt(9)
    v_pk_add_f32 v[28:29], v[28:29], v[84:85]
    v_pk_add_f32 v[88:89], v[88:89], v[92:93]
    v_pk_add_f32 v[28:29], v[28:29], v[206:207]
    v_lshlrev_b32 v84, 16, v198
    v_and_b32 v85, 0xffff0000, v198
    v_pk_add_f32 v[28:29], v[28:29], v[88:89]
    v_pk_mul_f32 v[28:29], v[28:29], v[84:85]
    v_cvt_pk_bf16_f32 v198, v28, v29
    v_pk_add_f32 v[30:31], v[30:31], v[86:87]
    v_pk_add_f32 v[90:91], v[90:91], v[94:95]
    v_pk_add_f32 v[30:31], v[30:31], v[206:207]
    v_lshlrev_b32 v84, 16, v199
    v_and_b32 v85, 0xffff0000, v199
    v_pk_add_f32 v[30:31], v[30:31], v[90:91]
    v_pk_mul_f32 v[30:31], v[30:31], v[84:85]
    v_cvt_pk_bf16_f32 v199, v30, v31
    s_waitcnt lgkmcnt(6)
    v_pk_add_f32 v[32:33], v[32:33], v[96:97]
    v_pk_add_f32 v[100:101], v[100:101], v[104:105]
    v_pk_add_f32 v[32:33], v[32:33], v[206:207]
    v_lshlrev_b32 v96, 16, v200
    v_and_b32 v97, 0xffff0000, v200
    v_pk_add_f32 v[32:33], v[32:33], v[100:101]
    v_pk_mul_f32 v[32:33], v[32:33], v[96:97]
    v_cvt_pk_bf16_f32 v200, v32, v33
    v_pk_add_f32 v[34:35], v[34:35], v[98:99]
    v_pk_add_f32 v[102:103], v[102:103], v[106:107]
    v_pk_add_f32 v[34:35], v[34:35], v[206:207]
    v_lshlrev_b32 v96, 16, v201
    v_and_b32 v97, 0xffff0000, v201
    v_pk_add_f32 v[34:35], v[34:35], v[102:103]
    v_pk_mul_f32 v[34:35], v[34:35], v[96:97]
    v_cvt_pk_bf16_f32 v201, v34, v35
    s_waitcnt lgkmcnt(3)
    v_pk_add_f32 v[36:37], v[36:37], v[108:109]
    v_pk_add_f32 v[112:113], v[112:113], v[116:117]
    v_pk_add_f32 v[36:37], v[36:37], v[206:207]
    v_lshlrev_b32 v108, 16, v202
    v_and_b32 v109, 0xffff0000, v202
    v_pk_add_f32 v[36:37], v[36:37], v[112:113]
    v_pk_mul_f32 v[36:37], v[36:37], v[108:109]
    v_cvt_pk_bf16_f32 v202, v36, v37
    v_pk_add_f32 v[38:39], v[38:39], v[110:111]
    v_pk_add_f32 v[114:115], v[114:115], v[118:119]
    v_pk_add_f32 v[38:39], v[38:39], v[206:207]
    v_lshlrev_b32 v108, 16, v203
    v_and_b32 v109, 0xffff0000, v203
    v_pk_add_f32 v[38:39], v[38:39], v[114:115]
    v_pk_mul_f32 v[38:39], v[38:39], v[108:109]
    v_cvt_pk_bf16_f32 v203, v38, v39
    s_waitcnt lgkmcnt(0)
    v_pk_add_f32 v[40:41], v[40:41], v[120:121]
    v_pk_add_f32 v[124:125], v[124:125], v[128:129]
    v_pk_add_f32 v[40:41], v[40:41], v[206:207]
    v_lshlrev_b32 v120, 16, v204
    v_and_b32 v121, 0xffff0000, v204
    v_pk_add_f32 v[40:41], v[40:41], v[124:125]
    v_pk_mul_f32 v[40:41], v[40:41], v[120:121]
    v_cvt_pk_bf16_f32 v204, v40, v41
    v_pk_add_f32 v[42:43], v[42:43], v[122:123]
    v_pk_add_f32 v[126:127], v[126:127], v[130:131]
    v_pk_add_f32 v[42:43], v[42:43], v[206:207]
    v_lshlrev_b32 v120, 16, v205
    v_and_b32 v121, 0xffff0000, v205
    v_pk_add_f32 v[42:43], v[42:43], v[126:127]
    v_pk_mul_f32 v[42:43], v[42:43], v[120:121]
    v_cvt_pk_bf16_f32 v205, v42, v43
    s_add_u32 s5, s8, 1
    s_lshr_b32 s5, s5, 1
    s_lshl_b32 s5, s5, 17
    s_add_u32 s6, s5, 131072
    s_add_u32 s7, s5, 262144
    s_and_b32 s13, s8, 1
    s_cmp_eq_u32 s13, 0
    s_cbranch_scc0 kgB_odd
    s_add_u32 s13, s5, 393216
    buffer_store_dwordx4 v[192:195], v10, s[68:71], s5 offen sc1
    buffer_store_dwordx4 v[196:199], v10, s[68:71], s6 offen sc1
    buffer_store_dwordx4 v[200:203], v10, s[68:71], s7 offen sc1
    buffer_store_dwordx2 v[204:205], v10, s[68:71], s13 offen sc1
    s_branch kgB_st
kgB_odd:
    s_sub_u32 s13, s5, 131072
    buffer_store_dwordx4 v[194:197], v10, s[68:71], s5 offen sc1
    buffer_store_dwordx4 v[198:201], v10, s[68:71], s6 offen sc1
    buffer_store_dwordx4 v[202:205], v10, s[68:71], s7 offen sc1
    buffer_store_dwordx2 v[192:193], v10, s[68:71], s13 offen offset:8 sc1
kgB_st:
    s_lshl_b32 s3, s98, 3
    s_add_u32 s3, s3, s99
    s_lshl_b32 s3, s3, 2
    s_add_u32 s3, s3, s4
    s_lshl_b32 s3, s3, 2
    s_add_u32 s3, s3, 4096
    v_mov_b32 v15, 0
    v_mov_b32 v16, 1
    s_waitcnt vmcnt(0)
    s_mov_b64 exec, 1
    buffer_store_dword v16, v15, s[84:87], s3 offen sc1
    s_mov_b64 exec, -1
    s_barrier
    s_add_u32 s56, s52, 7995392
    s_addc_u32 s57, s53, 0
    s_mov_b32 s58, 1105920
    s_mov_b32 s59, 0x00020000
    s_mul_i32 s5, s4, 40
    s_mul_i32 s6, s99, 5
    s_add_u32 s5, s5, s6
    s_lshl_b32 s5, s5, 10
    s_mul_i32 s6, s4, 5120
    s_add_u32 m0, s6, 0
    s_nop 0
    buffer_load_dwordx4 v12, s[56:59], s5 offen offset:0 lds
    buffer_load_dwordx4 v12, s[56:59], s5 offen offset:1024 lds
    buffer_load_dwordx4 v12, s[56:59], s5 offen offset:2048 lds
    buffer_load_dwordx4 v12, s[56:59], s5 offen offset:3072 lds
    s_add_u32 m0, s6, 4096
    s_nop 0
    buffer_load_dwordx4 v3, s[56:59], s5 offen lds
    s_add_u32 s5, s5, 163840
    s_add_u32 m0, s6, 20480
    s_nop 0
    buffer_load_dwordx4 v12, s[56:59], s5 offen offset:0 lds
    buffer_load_dwordx4 v12, s[56:59], s5 offen offset:1024 lds
    buffer_load_dwordx4 v12, s[56:59], s5 offen offset:2048 lds
    buffer_load_dwordx4 v12, s[56:59], s5 offen offset:3072 lds
    s_add_u32 m0, s6, 24576
    s_nop 0
    buffer_load_dwordx4 v3, s[56:59], s5 offen lds
    s_add_u32 s5, s5, 163840
    s_add_u32 m0, s6, 40960
    s_nop 0
    buffer_load_dwordx4 v12, s[56:59], s5 offen offset:0 lds
    buffer_load_dwordx4 v12, s[56:59], s5 offen offset:1024 lds
    buffer_load_dwordx4 v12, s[56:59], s5 offen offset:2048 lds
    buffer_load_dwordx4 v12, s[56:59], s5 offen offset:3072 lds
    s_add_u32 m0, s6, 45056
    s_nop 0
    buffer_load_dwordx4 v3, s[56:59], s5 offen lds
    s_add_u32 s5, s5, 163840
    s_add_u32 m0, s6, 61440
    s_nop 0
    buffer_load_dwordx4 v12, s[56:59], s5 offen offset:0 lds
    buffer_load_dwordx4 v12, s[56:59], s5 offen offset:1024 lds
    buffer_load_dwordx4 v12, s[56:59], s5 offen offset:2048 lds
    buffer_load_dwordx4 v12, s[56:59], s5 offen offset:3072 lds
    s_add_u32 m0, s6, 65536
    s_nop 0
    buffer_load_dwordx4 v3, s[56:59], s5 offen lds
    s_add_u32 s5, s5, 163840
    s_add_u32 m0, s6, 81920
    s_nop 0
    buffer_load_dwordx4 v12, s[56:59], s5 offen offset:0 lds
    buffer_load_dwordx4 v12, s[56:59], s5 offen offset:1024 lds
    buffer_load_dwordx4 v12, s[56:59], s5 offen offset:2048 lds
    buffer_load_dwordx4 v12, s[56:59], s5 offen offset:3072 lds
    s_add_u32 m0, s6, 86016
    s_nop 0
    buffer_load_dwordx4 v3, s[56:59], s5 offen lds
    s_add_u32 s5, s5, 163840
    s_add_u32 m0, s6, 102400
    s_nop 0
    buffer_load_dwordx4 v12, s[56:59], s5 offen offset:0 lds
    buffer_load_dwordx4 v12, s[56:59], s5 offen offset:1024 lds
    buffer_load_dwordx4 v12, s[56:59], s5 offen offset:2048 lds
    buffer_load_dwordx4 v12, s[56:59], s5 offen offset:3072 lds
    s_add_u32 m0, s6, 106496
    s_nop 0
    buffer_load_dwordx4 v3, s[56:59], s5 offen lds
    s_add_u32 s5, s5, 163840
    s_add_u32 m0, s6, 122880
    s_nop 0
    buffer_load_dwordx4 v12, s[56:59], s5 offen offset:0 lds
    buffer_load_dwordx4 v12, s[56:59], s5 offen offset:1024 lds
    buffer_load_dwordx4 v12, s[56:59], s5 offen offset:2048 lds
    buffer_load_dwordx4 v12, s[56:59], s5 offen offset:3072 lds
    s_add_u32 m0, s6, 126976
    s_nop 0
    buffer_load_dwordx4 v3, s[56:59], s5 offen lds
    s_add_u32 s5, s5, 163840
    s_add_u32 s60, s52, 23773184
    s_addc_u32 s61, s53, 0
    s_mov_b32 s62, 3538944
    s_mov_b32 s63, 0x00020000
    s_add_u32 s64, s52, 14073856
    s_addc_u32 s65, s53, 0
    s_mov_b32 s66, 2621440
    s_mov_b32 s67, 0x00020000
    s_add_u32 s68, s52, 61440
    s_addc_u32 s69, s53, 0
    s_mov_b32 s70, 15360
    s_mov_b32 s71, 0x00020000
    s_mov_b32 s72, s48
    s_mov_b32 s73, s49
    s_mov_b32 s74, 2621440
    s_mov_b32 s75, 0x00020000
    s_mul_i32 s8, s99, 5
    v_mul_u32_u24 v4, 1280, v8
    v_lshl_add_u32 v4, v14, 4, v4
    v_lshlrev_b32 v5, 5, v14
    s_mov_b32 s12, 0
    s_lshr_b32 s14, s4, 1
    s_lshl_b32 s14, s14, 5
    s_and_b32 s15, s4, 1
    s_lshl_b32 s15, s15, 2
    s_add_u32 s14, s14, s15
    s_lshl_b32 s15, s98, 6
    s_add_u32 s14, s14, s15
    s_mul_i32 s13, s14, 1280
    v_add_u32 v6, 61440, v12
    v_add_u32 v7, 122880, v12
    s_add_u32 s14, s8, 0
    s_lshr_b32 s15, s14, 1
    s_and_b32 s14, s14, 1
    s_lshl_b32 s5, s15, 17
    s_lshl_b32 s6, s14, 3
    s_add_u32 s76, s5, s6
    s_lshl_b32 s5, s15, 6
    s_add_u32 s5, s5, s6
    s_add_u32 s88, s5, s13
    s_lshl_b32 s5, s5, 1
    s_add_u32 s5, s5, 12800
    buffer_load_dwordx4 v[228:231], v5, s[68:71], s5 offen
    s_add_u32 s14, s8, 1
    s_lshr_b32 s15, s14, 1
    s_and_b32 s14, s14, 1
    s_lshl_b32 s5, s15, 17
    s_lshl_b32 s6, s14, 3
    s_add_u32 s77, s5, s6
    s_lshl_b32 s5, s15, 6
    s_add_u32 s5, s5, s6
    s_add_u32 s89, s5, s13
    s_lshl_b32 s5, s5, 1
    s_add_u32 s5, s5, 12800
    buffer_load_dwordx4 v[232:235], v5, s[68:71], s5 offen
    s_add_u32 s14, s8, 2
    s_lshr_b32 s15, s14, 1
    s_and_b32 s14, s14, 1
    s_lshl_b32 s5, s15, 17
    s_lshl_b32 s6, s14, 3
    s_add_u32 s78, s5, s6
    s_lshl_b32 s5, s15, 6
    s_add_u32 s5, s5, s6
    s_add_u32 s90, s5, s13
    s_lshl_b32 s5, s5, 1
    s_add_u32 s5, s5, 12800
    buffer_load_dwordx4 v[236:239], v5, s[68:71], s5 offen
    s_add_u32 s14, s8, 3
    s_lshr_b32 s15, s14, 1
    s_and_b32 s14, s14, 1
    s_lshl_b32 s5, s15, 17
    s_lshl_b32 s6, s14, 3
    s_add_u32 s79, s5, s6
    s_lshl_b32 s5, s15, 6
    s_add_u32 s5, s5, s6
    s_add_u32 s91, s5, s13
    s_lshl_b32 s5, s5, 1
    s_add_u32 s5, s5, 12800
    buffer_load_dwordx4 v[240:243], v5, s[68:71], s5 offen
    s_add_u32 s14, s8, 4
    s_lshr_b32 s15, s14, 1
    s_and_b32 s14, s14, 1
    s_lshl_b32 s5, s15, 17
    s_lshl_b32 s6, s14, 3
    s_add_u32 s80, s5, s6
    s_lshl_b32 s5, s15, 6
    s_add_u32 s5, s5, s6
    s_add_u32 s92, s5, s13
    s_lshl_b32 s5, s5, 1
    s_add_u32 s5, s5, 12800
    buffer_load_dwordx4 v[244:247], v5, s[68:71], s5 offen
    s_lshl_b32 s3, s98, 7
    s_lshl_b32 s5, s4, 2
    s_add_u32 s3, s3, s5
    s_add_u32 s3, s3, 4096
    v_add_u32 v2, s3, v12
    s_lshr_b32 s5, s8, 1
    s_add_u32 s5, s5, 8
    v_add_u32 v17, s5, v1
    v_and_b32 v17, 15, v17
    v_lshlrev_b32 v18, 2, v17
    s_lshr_b32 s5, s9, 1
    s_lshl_b32 s5, s5, 6
    s_add_u32 s5, s5, 8192
    v_add_u32 v18, s5, v18
    v_cmp_gt_u32 vcc, 8, v1
    s_nop 1
    v_cndmask_b32 v2, v18, v2, vcc
    s_mov_b64 exec, 0x7ff
    s_mov_b32 s3, 0
kg_pollC:
    buffer_load_dword v15, v2, s[84:87], 0 offen sc1
    s_waitcnt vmcnt(0)
    v_cmp_eq_u32 vcc, 0, v15
    s_nop 0
    s_cmp_eq_u64 vcc, 0
    s_cbranch_scc1 kg_rdyC
    s_add_u32 s3, s3, 1
    s_cmp_lt_u32 s3, 100000
    s_cbranch_scc0 kg_rdyC
    s_sleep 2
    s_branch kg_pollC
kg_rdyC:
    s_mov_b64 exec, -1
    buffer_load_dwordx4 v[16:19], v10, s[60:63], s12 offen sc1
    s_add_u32 s12, s12, 131072
    buffer_load_dwordx4 v[20:23], v10, s[60:63], s12 offen sc1
    s_add_u32 s12, s12, 131072
    buffer_load_dwordx4 v[24:27], v10, s[60:63], s12 offen sc1
    s_add_u32 s12, s12, 131072
    buffer_load_dwordx4 v[28:31], v10, s[60:63], s12 offen sc1
    s_add_u32 s12, s12, 131072
    buffer_load_dwordx4 v[32:35], v10, s[60:63], s12 offen sc1
    s_add_u32 s12, s12, 131072
    buffer_load_dwordx4 v[36:39], v10, s[60:63], s12 offen sc1
    s_add_u32 s12, s12, 131072
    buffer_load_dwordx4 v[40:43], v10, s[60:63], s12 offen sc1
    s_add_u32 s12, s12, 131072
    buffer_load_dwordx2 v[196:197], v10, s[64:67], s76 offen sc1
    buffer_load_dwordx2 v[198:199], v10, s[64:67], s77 offen sc1
    buffer_load_dwordx2 v[200:201], v10, s[64:67], s78 offen sc1
    buffer_load_dwordx2 v[202:203], v10, s[64:67], s79 offen sc1
    buffer_load_dwordx2 v[204:205], v10, s[64:67], s80 offen sc1
    s_barrier
    ds_read_b128 v[48:51], v12 offset:0
    ds_read_b128 v[52:55], v12 offset:1024
    ds_read_b128 v[56:59], v12 offset:2048
    ds_read_b128 v[60:63], v12 offset:3072
    ds_read_b128 v[64:67], v12 offset:4096
    s_waitcnt vmcnt(11) lgkmcnt(0)
    v_mfma_f32_16x16x32_bf16 v[88:91], v[48:51], v[16:19], 0
    ds_read_b128 v[68:71], v12 offset:5120
    v_mfma_f32_16x16x32_bf16 v[92:95], v[52:55], v[16:19], 0
    ds_read_b128 v[72:75], v12 offset:6144
    v_mfma_f32_16x16x32_bf16 v[96:99], v[56:59], v[16:19], 0
    ds_read_b128 v[76:79], v12 offset:7168
    v_mfma_f32_16x16x32_bf16 v[100:103], v[60:63], v[16:19], 0
    ds_read_b128 v[80:83], v12 offset:8192
    v_mfma_f32_16x16x32_bf16 v[104:107], v[64:67], v[16:19], 0
    ds_read_b128 v[84:87], v12 offset:9216
    buffer_load_dwordx4 v[44:47], v10, s[60:63], s12 offen sc1
    s_add_u32 s12, s12, 131072
    s_waitcnt vmcnt(11) lgkmcnt(0)
    v_mfma_f32_16x16x32_bf16 v[88:91], v[68:71], v[20:23], v[88:91]
    ds_read_b128 v[48:51], v12 offset:10240
    v_mfma_f32_16x16x32_bf16 v[92:95], v[72:75], v[20:23], v[92:95]
    ds_read_b128 v[52:55], v12 offset:11264
    v_mfma_f32_16x16x32_bf16 v[96:99], v[76:79], v[20:23], v[96:99]
    ds_read_b128 v[56:59], v12 offset:12288
    v_mfma_f32_16x16x32_bf16 v[100:103], v[80:83], v[20:23], v[100:103]
    ds_read_b128 v[60:63], v12 offset:13312
    v_mfma_f32_16x16x32_bf16 v[104:107], v[84:87], v[20:23], v[104:107]
    ds_read_b128 v[64:67], v12 offset:14336
    buffer_load_dwordx4 v[16:19], v10, s[60:63], s12 offen sc1
    s_add_u32 s12, s12, 131072
    s_waitcnt vmcnt(11) lgkmcnt(0)
    v_mfma_f32_16x16x32_bf16 v[88:91], v[48:51], v[24:27], v[88:91]
    ds_read_b128 v[68:71], v12 offset:15360
    v_mfma_f32_16x16x32_bf16 v[92:95], v[52:55], v[24:27], v[92:95]
    ds_read_b128 v[72:75], v12 offset:16384
    v_mfma_f32_16x16x32_bf16 v[96:99], v[56:59], v[24:27], v[96:99]
    ds_read_b128 v[76:79], v12 offset:17408
    v_mfma_f32_16x16x32_bf16 v[100:103], v[60:63], v[24:27], v[100:103]
    ds_read_b128 v[80:83], v12 offset:18432
    v_mfma_f32_16x16x32_bf16 v[104:107], v[64:67], v[24:27], v[104:107]
    ds_read_b128 v[84:87], v12 offset:19456
    buffer_load_dwordx4 v[20:23], v10, s[60:63], s12 offen sc1
    s_add_u32 s12, s12, 131072
    s_waitcnt vmcnt(11) lgkmcnt(0)
    v_mfma_f32_16x16x32_bf16 v[88:91], v[68:71], v[28:31], v[88:91]
    ds_read_b128 v[48:51], v12 offset:20480
    v_mfma_f32_16x16x32_bf16 v[92:95], v[72:75], v[28:31], v[92:95]
    ds_read_b128 v[52:55], v12 offset:21504
    v_mfma_f32_16x16x32_bf16 v[96:99], v[76:79], v[28:31], v[96:99]
    ds_read_b128 v[56:59], v12 offset:22528
    v_mfma_f32_16x16x32_bf16 v[100:103], v[80:83], v[28:31], v[100:103]
    ds_read_b128 v[60:63], v12 offset:23552
    v_mfma_f32_16x16x32_bf16 v[104:107], v[84:87], v[28:31], v[104:107]
    ds_read_b128 v[64:67], v12 offset:24576
    buffer_load_dwordx4 v[24:27], v10, s[60:63], s12 offen sc1
    s_add_u32 s12, s12, 131072
    s_waitcnt vmcnt(11) lgkmcnt(0)
    v_mfma_f32_16x16x32_bf16 v[88:91], v[48:51], v[32:35], v[88:91]
    ds_read_b128 v[68:71], v12 offset:25600
    v_mfma_f32_16x16x32_bf16 v[92:95], v[52:55], v[32:35], v[92:95]
    ds_read_b128 v[72:75], v12 offset:26624
    v_mfma_f32_16x16x32_bf16 v[96:99], v[56:59], v[32:35], v[96:99]
    ds_read_b128 v[76:79], v12 offset:27648
    v_mfma_f32_16x16x32_bf16 v[100:103], v[60:63], v[32:35], v[100:103]
    ds_read_b128 v[80:83], v12 offset:28672
    v_mfma_f32_16x16x32_bf16 v[104:107], v[64:67], v[32:35], v[104:107]
    ds_read_b128 v[84:87], v12 offset:29696
    buffer_load_dwordx4 v[28:31], v10, s[60:63], s12 offen sc1
    s_add_u32 s12, s12, 131072
    s_waitcnt vmcnt(11) lgkmcnt(0)
    v_mfma_f32_16x16x32_bf16 v[88:91], v[68:71], v[36:39], v[88:91]
    ds_read_b128 v[48:51], v12 offset:30720
    v_mfma_f32_16x16x32_bf16 v[92:95], v[72:75], v[36:39], v[92:95]
    ds_read_b128 v[52:55], v12 offset:31744
    v_mfma_f32_16x16x32_bf16 v[96:99], v[76:79], v[36:39], v[96:99]
    ds_read_b128 v[56:59], v12 offset:32768
    v_mfma_f32_16x16x32_bf16 v[100:103], v[80:83], v[36:39], v[100:103]
    ds_read_b128 v[60:63], v12 offset:33792
    v_mfma_f32_16x16x32_bf16 v[104:107], v[84:87], v[36:39], v[104:107]
    ds_read_b128 v[64:67], v12 offset:34816
    buffer_load_dwordx4 v[32:35], v10, s[60:63], s12 offen sc1
    s_add_u32 s12, s12, 131072
    s_waitcnt vmcnt(11) lgkmcnt(0)
    v_mfma_f32_16x16x32_bf16 v[88:91], v[48:51], v[40:43], v[88:91]
    ds_read_b128 v[68:71], v12 offset:35840
    v_mfma_f32_16x16x32_bf16 v[92:95], v[52:55], v[40:43], v[92:95]
    ds_read_b128 v[72:75], v12 offset:36864
    v_mfma_f32_16x16x32_bf16 v[96:99], v[56:59], v[40:43], v[96:99]
    ds_read_b128 v[76:79], v12 offset:37888
    v_mfma_f32_16x16x32_bf16 v[100:103], v[60:63], v[40:43], v[100:103]
    ds_read_b128 v[80:83], v12 offset:38912
    v_mfma_f32_16x16x32_bf16 v[104:107], v[64:67], v[40:43], v[104:107]
    ds_read_b128 v[84:87], v12 offset:39936
    buffer_load_dwordx4 v[36:39], v10, s[60:63], s12 offen sc1
    s_add_u32 s12, s12, 131072
    s_waitcnt vmcnt(6) lgkmcnt(0)
    v_mfma_f32_16x16x32_bf16 v[88:91], v[68:71], v[44:47], v[88:91]
    ds_read_b128 v[48:51], v12 offset:40960
    v_mfma_f32_16x16x32_bf16 v[92:95], v[72:75], v[44:47], v[92:95]
    ds_read_b128 v[52:55], v12 offset:41984
    v_mfma_f32_16x16x32_bf16 v[96:99], v[76:79], v[44:47], v[96:99]
    ds_read_b128 v[56:59], v12 offset:43008
    v_mfma_f32_16x16x32_bf16 v[100:103], v[80:83], v[44:47], v[100:103]
    ds_read_b128 v[60:63], v12 offset:44032
    v_mfma_f32_16x16x32_bf16 v[104:107], v[84:87], v[44:47], v[104:107]
    ds_read_b128 v[64:67], v12 offset:45056
    buffer_load_dwordx4 v[40:43], v10, s[60:63], s12 offen sc1
    s_add_u32 s12, s12, 131072
    s_waitcnt vmcnt(6) lgkmcnt(0)
    v_mfma_f32_16x16x32_bf16 v[88:91], v[48:51], v[16:19], v[88:91]
    ds_read_b128 v[68:71], v12 offset:46080
    v_mfma_f32_16x16x32_bf16 v[92:95], v[52:55], v[16:19], v[92:95]
    ds_read_b128 v[72:75], v12 offset:47104
    v_mfma_f32_16x16x32_bf16 v[96:99], v[56:59], v[16:19], v[96:99]
    ds_read_b128 v[76:79], v12 offset:48128
    v_mfma_f32_16x16x32_bf16 v[100:103], v[60:63], v[16:19], v[100:103]
    ds_read_b128 v[80:83], v12 offset:49152
    v_mfma_f32_16x16x32_bf16 v[104:107], v[64:67], v[16:19], v[104:107]
    ds_read_b128 v[84:87], v12 offset:50176
    buffer_load_dwordx4 v[44:47], v10, s[60:63], s12 offen sc1
    s_add_u32 s12, s12, 131072
    s_waitcnt vmcnt(6) lgkmcnt(0)
    v_mfma_f32_16x16x32_bf16 v[88:91], v[68:71], v[20:23], v[88:91]
    ds_read_b128 v[48:51], v12 offset:51200
    v_mfma_f32_16x16x32_bf16 v[92:95], v[72:75], v[20:23], v[92:95]
    ds_read_b128 v[52:55], v12 offset:52224
    v_mfma_f32_16x16x32_bf16 v[96:99], v[76:79], v[20:23], v[96:99]
    ds_read_b128 v[56:59], v12 offset:53248
    v_mfma_f32_16x16x32_bf16 v[100:103], v[80:83], v[20:23], v[100:103]
    ds_read_b128 v[60:63], v12 offset:54272
    v_mfma_f32_16x16x32_bf16 v[104:107], v[84:87], v[20:23], v[104:107]
    ds_read_b128 v[64:67], v12 offset:55296
    buffer_load_dwordx4 v[16:19], v10, s[60:63], s12 offen sc1
    s_add_u32 s12, s12, 131072
    s_waitcnt vmcnt(6) lgkmcnt(0)
    v_mfma_f32_16x16x32_bf16 v[88:91], v[48:51], v[24:27], v[88:91]
    ds_read_b128 v[68:71], v12 offset:56320
    v_mfma_f32_16x16x32_bf16 v[92:95], v[52:55], v[24:27], v[92:95]
    ds_read_b128 v[72:75], v12 offset:57344
    v_mfma_f32_16x16x32_bf16 v[96:99], v[56:59], v[24:27], v[96:99]
    ds_read_b128 v[76:79], v12 offset:58368
    v_mfma_f32_16x16x32_bf16 v[100:103], v[60:63], v[24:27], v[100:103]
    ds_read_b128 v[80:83], v12 offset:59392
    v_mfma_f32_16x16x32_bf16 v[104:107], v[64:67], v[24:27], v[104:107]
    ds_read_b128 v[84:87], v12 offset:60416
    buffer_load_dwordx4 v[20:23], v10, s[60:63], s12 offen sc1
    s_add_u32 s12, s12, 131072
    s_waitcnt vmcnt(6) lgkmcnt(0)
    v_mfma_f32_16x16x32_bf16 v[88:91], v[68:71], v[28:31], v[88:91]
    ds_read_b128 v[48:51], v6 offset:0
    v_mfma_f32_16x16x32_bf16 v[92:95], v[72:75], v[28:31], v[92:95]
    ds_read_b128 v[52:55], v6 offset:1024
    v_mfma_f32_16x16x32_bf16 v[96:99], v[76:79], v[28:31], v[96:99]
    ds_read_b128 v[56:59], v6 offset:2048
    v_mfma_f32_16x16x32_bf16 v[100:103], v[80:83], v[28:31], v[100:103]
    ds_read_b128 v[60:63], v6 offset:3072
    v_mfma_f32_16x16x32_bf16 v[104:107], v[84:87], v[28:31], v[104:107]
    ds_read_b128 v[64:67], v6 offset:4096
    buffer_load_dwordx4 v[24:27], v10, s[60:63], s12 offen sc1
    s_add_u32 s12, s12, 131072
    s_waitcnt vmcnt(6) lgkmcnt(0)
    v_mfma_f32_16x16x32_bf16 v[88:91], v[48:51], v[32:35], v[88:91]
    ds_read_b128 v[68:71], v6 offset:5120
    v_mfma_f32_16x16x32_bf16 v[92:95], v[52:55], v[32:35], v[92:95]
    ds_read_b128 v[72:75], v6 offset:6144
    v_mfma_f32_16x16x32_bf16 v[96:99], v[56:59], v[32:35], v[96:99]
    ds_read_b128 v[76:79], v6 offset:7168
    v_mfma_f32_16x16x32_bf16 v[100:103], v[60:63], v[32:35], v[100:103]
    ds_read_b128 v[80:83], v6 offset:8192
    v_mfma_f32_16x16x32_bf16 v[104:107], v[64:67], v[32:35], v[104:107]
    ds_read_b128 v[84:87], v6 offset:9216
    buffer_load_dwordx4 v[28:31], v10, s[60:63], s12 offen sc1
    s_add_u32 s12, s12, 131072
    s_waitcnt vmcnt(6) lgkmcnt(0)
    v_mfma_f32_16x16x32_bf16 v[88:91], v[68:71], v[36:39], v[88:91]
    ds_read_b128 v[48:51], v6 offset:10240
    v_mfma_f32_16x16x32_bf16 v[92:95], v[72:75], v[36:39], v[92:95]
    ds_read_b128 v[52:55], v6 offset:11264
    v_mfma_f32_16x16x32_bf16 v[96:99], v[76:79], v[36:39], v[96:99]
    ds_read_b128 v[56:59], v6 offset:12288
    v_mfma_f32_16x16x32_bf16 v[100:103], v[80:83], v[36:39], v[100:103]
    ds_read_b128 v[60:63], v6 offset:13312
    v_mfma_f32_16x16x32_bf16 v[104:107], v[84:87], v[36:39], v[104:107]
    ds_read_b128 v[64:67], v6 offset:14336
    buffer_load_dwordx4 v[32:35], v10, s[60:63], s12 offen sc1
    s_add_u32 s12, s12, 131072
    s_waitcnt vmcnt(6) lgkmcnt(0)
    v_mfma_f32_16x16x32_bf16 v[88:91], v[48:51], v[40:43], v[88:91]
    ds_read_b128 v[68:71], v6 offset:15360
    v_mfma_f32_16x16x32_bf16 v[92:95], v[52:55], v[40:43], v[92:95]
    ds_read_b128 v[72:75], v6 offset:16384
    v_mfma_f32_16x16x32_bf16 v[96:99], v[56:59], v[40:43], v[96:99]
    ds_read_b128 v[76:79], v6 offset:17408
    v_mfma_f32_16x16x32_bf16 v[100:103], v[60:63], v[40:43], v[100:103]
    ds_read_b128 v[80:83], v6 offset:18432
    v_mfma_f32_16x16x32_bf16 v[104:107], v[64:67], v[40:43], v[104:107]
    ds_read_b128 v[84:87], v6 offset:19456
    buffer_load_dwordx4 v[36:39], v10, s[60:63], s12 offen sc1
    s_add_u32 s12, s12, 131072
    s_waitcnt vmcnt(6) lgkmcnt(0)
    v_mfma_f32_16x16x32_bf16 v[88:91], v[68:71], v[44:47], v[88:91]
    ds_read_b128 v[48:51], v6 offset:20480
    v_mfma_f32_16x16x32_bf16 v[92:95], v[72:75], v[44:47], v[92:95]
    ds_read_b128 v[52:55], v6 offset:21504
    v_mfma_f32_16x16x32_bf16 v[96:99], v[76:79], v[44:47], v[96:99]
    ds_read_b128 v[56:59], v6 offset:22528
    v_mfma_f32_16x16x32_bf16 v[100:103], v[80:83], v[44:47], v[100:103]
    ds_read_b128 v[60:63], v6 offset:23552
    v_mfma_f32_16x16x32_bf16 v[104:107], v[84:87], v[44:47], v[104:107]
    ds_read_b128 v[64:67], v6 offset:24576
    buffer_load_dwordx4 v[40:43], v10, s[60:63], s12 offen sc1
    s_add_u32 s12, s12, 131072
    s_waitcnt vmcnt(6) lgkmcnt(0)
    v_mfma_f32_16x16x32_bf16 v[88:91], v[48:51], v[16:19], v[88:91]
    ds_read_b128 v[68:71], v6 offset:25600
    v_mfma_f32_16x16x32_bf16 v[92:95], v[52:55], v[16:19], v[92:95]
    ds_read_b128 v[72:75], v6 offset:26624
    v_mfma_f32_16x16x32_bf16 v[96:99], v[56:59], v[16:19], v[96:99]
    ds_read_b128 v[76:79], v6 offset:27648
    v_mfma_f32_16x16x32_bf16 v[100:103], v[60:63], v[16:19], v[100:103]
    ds_read_b128 v[80:83], v6 offset:28672
    v_mfma_f32_16x16x32_bf16 v[104:107], v[64:67], v[16:19], v[104:107]
    ds_read_b128 v[84:87], v6 offset:29696
    buffer_load_dwordx4 v[44:47], v10, s[60:63], s12 offen sc1
    s_add_u32 s12, s12, 131072
    s_waitcnt vmcnt(6) lgkmcnt(0)
    v_mfma_f32_16x16x32_bf16 v[88:91], v[68:71], v[20:23], v[88:91]
    ds_read_b128 v[48:51], v6 offset:30720
    v_mfma_f32_16x16x32_bf16 v[92:95], v[72:75], v[20:23], v[92:95]
    ds_read_b128 v[52:55], v6 offset:31744
    v_mfma_f32_16x16x32_bf16 v[96:99], v[76:79], v[20:23], v[96:99]
    ds_read_b128 v[56:59], v6 offset:32768
    v_mfma_f32_16x16x32_bf16 v[100:103], v[80:83], v[20:23], v[100:103]
    ds_read_b128 v[60:63], v6 offset:33792
    v_mfma_f32_16x16x32_bf16 v[104:107], v[84:87], v[20:23], v[104:107]
    ds_read_b128 v[64:67], v6 offset:34816
    buffer_load_dwordx4 v[16:19], v10, s[60:63], s12 offen sc1
    s_add_u32 s12, s12, 131072
    s_waitcnt vmcnt(6) lgkmcnt(0)
    v_mfma_f32_16x16x32_bf16 v[88:91], v[48:51], v[24:27], v[88:91]
    ds_read_b128 v[68:71], v6 offset:35840
    v_mfma_f32_16x16x32_bf16 v[92:95], v[52:55], v[24:27], v[92:95]
    ds_read_b128 v[72:75], v6 offset:36864
    v_mfma_f32_16x16x32_bf16 v[96:99], v[56:59], v[24:27], v[96:99]
    ds_read_b128 v[76:79], v6 offset:37888
    v_mfma_f32_16x16x32_bf16 v[100:103], v[60:63], v[24:27], v[100:103]
    ds_read_b128 v[80:83], v6 offset:38912
    v_mfma_f32_16x16x32_bf16 v[104:107], v[64:67], v[24:27], v[104:107]
    ds_read_b128 v[84:87], v6 offset:39936
    buffer_load_dwordx4 v[20:23], v10, s[60:63], s12 offen sc1
    s_add_u32 s12, s12, 131072
    s_waitcnt vmcnt(6) lgkmcnt(0)
    v_mfma_f32_16x16x32_bf16 v[88:91], v[68:71], v[28:31], v[88:91]
    ds_read_b128 v[48:51], v6 offset:40960
    v_mfma_f32_16x16x32_bf16 v[92:95], v[72:75], v[28:31], v[92:95]
    ds_read_b128 v[52:55], v6 offset:41984
    v_mfma_f32_16x16x32_bf16 v[96:99], v[76:79], v[28:31], v[96:99]
    ds_read_b128 v[56:59], v6 offset:43008
    v_mfma_f32_16x16x32_bf16 v[100:103], v[80:83], v[28:31], v[100:103]
    ds_read_b128 v[60:63], v6 offset:44032
    v_mfma_f32_16x16x32_bf16 v[104:107], v[84:87], v[28:31], v[104:107]
    ds_read_b128 v[64:67], v6 offset:45056
    buffer_load_dwordx4 v[24:27], v10, s[60:63], s12 offen sc1
    s_add_u32 s12, s12, 131072
    s_waitcnt vmcnt(6) lgkmcnt(0)
    v_mfma_f32_16x16x32_bf16 v[88:91], v[48:51], v[32:35], v[88:91]
    ds_read_b128 v[68:71], v6 offset:46080
    v_mfma_f32_16x16x32_bf16 v[92:95], v[52:55], v[32:35], v[92:95]
    ds_read_b128 v[72:75], v6 offset:47104
    v_mfma_f32_16x16x32_bf16 v[96:99], v[56:59], v[32:35], v[96:99]
    ds_read_b128 v[76:79], v6 offset:48128
    v_mfma_f32_16x16x32_bf16 v[100:103], v[60:63], v[32:35], v[100:103]
    ds_read_b128 v[80:83], v6 offset:49152
    v_mfma_f32_16x16x32_bf16 v[104:107], v[64:67], v[32:35], v[104:107]
    ds_read_b128 v[84:87], v6 offset:50176
    s_waitcnt vmcnt(5) lgkmcnt(0)
    v_mfma_f32_16x16x32_bf16 v[88:91], v[68:71], v[36:39], v[88:91]
    ds_read_b128 v[48:51], v6 offset:51200
    v_mfma_f32_16x16x32_bf16 v[92:95], v[72:75], v[36:39], v[92:95]
    ds_read_b128 v[52:55], v6 offset:52224
    v_mfma_f32_16x16x32_bf16 v[96:99], v[76:79], v[36:39], v[96:99]
    ds_read_b128 v[56:59], v6 offset:53248
    v_mfma_f32_16x16x32_bf16 v[100:103], v[80:83], v[36:39], v[100:103]
    ds_read_b128 v[60:63], v6 offset:54272
    v_mfma_f32_16x16x32_bf16 v[104:107], v[84:87], v[36:39], v[104:107]
    ds_read_b128 v[64:67], v6 offset:55296
    s_waitcnt vmcnt(4) lgkmcnt(0)
    v_mfma_f32_16x16x32_bf16 v[88:91], v[48:51], v[40:43], v[88:91]
    ds_read_b128 v[68:71], v6 offset:56320
    v_mfma_f32_16x16x32_bf16 v[92:95], v[52:55], v[40:43], v[92:95]
    ds_read_b128 v[72:75], v6 offset:57344
    v_mfma_f32_16x16x32_bf16 v[96:99], v[56:59], v[40:43], v[96:99]
    ds_read_b128 v[76:79], v6 offset:58368
    v_mfma_f32_16x16x32_bf16 v[100:103], v[60:63], v[40:43], v[100:103]
    ds_read_b128 v[80:83], v6 offset:59392
    v_mfma_f32_16x16x32_bf16 v[104:107], v[64:67], v[40:43], v[104:107]
    ds_read_b128 v[84:87], v6 offset:60416
    s_waitcnt vmcnt(3) lgkmcnt(0)
    v_mfma_f32_16x16x32_bf16 v[88:91], v[68:71], v[44:47], v[88:91]
    ds_read_b128 v[48:51], v7 offset:0
    v_mfma_f32_16x16x32_bf16 v[92:95], v[72:75], v[44:47], v[92:95]
    ds_read_b128 v[52:55], v7 offset:1024
    v_mfma_f32_16x16x32_bf16 v[96:99], v[76:79], v[44:47], v[96:99]
    ds_read_b128 v[56:59], v7 offset:2048
    v_mfma_f32_16x16x32_bf16 v[100:103], v[80:83], v[44:47], v[100:103]
    ds_read_b128 v[60:63], v7 offset:3072
    v_mfma_f32_16x16x32_bf16 v[104:107], v[84:87], v[44:47], v[104:107]
    ds_read_b128 v[64:67], v7 offset:4096
    s_waitcnt vmcnt(2) lgkmcnt(0)
    v_mfma_f32_16x16x32_bf16 v[88:91], v[48:51], v[16:19], v[88:91]
    ds_read_b128 v[68:71], v7 offset:5120
    v_mfma_f32_16x16x32_bf16 v[92:95], v[52:55], v[16:19], v[92:95]
    ds_read_b128 v[72:75], v7 offset:6144
    v_mfma_f32_16x16x32_bf16 v[96:99], v[56:59], v[16:19], v[96:99]
    ds_read_b128 v[76:79], v7 offset:7168
    v_mfma_f32_16x16x32_bf16 v[100:103], v[60:63], v[16:19], v[100:103]
    ds_read_b128 v[80:83], v7 offset:8192
    v_mfma_f32_16x16x32_bf16 v[104:107], v[64:67], v[16:19], v[104:107]
    ds_read_b128 v[84:87], v7 offset:9216
    s_waitcnt vmcnt(1) lgkmcnt(0)
    v_mfma_f32_16x16x32_bf16 v[88:91], v[68:71], v[20:23], v[88:91]
    ds_read_b128 v[48:51], v7 offset:10240
    v_mfma_f32_16x16x32_bf16 v[92:95], v[72:75], v[20:23], v[92:95]
    ds_read_b128 v[52:55], v7 offset:11264
    v_mfma_f32_16x16x32_bf16 v[96:99], v[76:79], v[20:23], v[96:99]
    ds_read_b128 v[56:59], v7 offset:12288
    v_mfma_f32_16x16x32_bf16 v[100:103], v[80:83], v[20:23], v[100:103]
    ds_read_b128 v[60:63], v7 offset:13312
    v_mfma_f32_16x16x32_bf16 v[104:107], v[84:87], v[20:23], v[104:107]
    ds_read_b128 v[64:67], v7 offset:14336
    s_waitcnt vmcnt(0) lgkmcnt(0)
    v_mfma_f32_16x16x32_bf16 v[88:91], v[48:51], v[24:27], v[88:91]
    v_mfma_f32_16x16x32_bf16 v[92:95], v[52:55], v[24:27], v[92:95]
    v_mfma_f32_16x16x32_bf16 v[96:99], v[56:59], v[24:27], v[96:99]
    v_mfma_f32_16x16x32_bf16 v[100:103], v[60:63], v[24:27], v[100:103]
    v_mfma_f32_16x16x32_bf16 v[104:107], v[64:67], v[24:27], v[104:107]
    s_waitcnt vmcnt(0)
    v_lshlrev_b32 v16, 16, v196
    v_and_b32 v17, 0xffff0000, v196
    s_nop 0
    v_pk_fma_f32 v[88:89], v[88:89], v[228:229], v[16:17]
    v_cvt_pk_bf16_f32 v196, v88, v89
    v_lshlrev_b32 v18, 16, v197
    v_and_b32 v19, 0xffff0000, v197
    v_pk_fma_f32 v[90:91], v[90:91], v[230:231], v[18:19]
    v_cvt_pk_bf16_f32 v197, v90, v91
    buffer_store_dwordx2 v[196:197], v4, s[72:75], s88 offen
    v_lshlrev_b32 v20, 16, v198
    v_and_b32 v21, 0xffff0000, v198
    v_pk_fma_f32 v[92:93], v[92:93], v[232:233], v[20:21]
    v_cvt_pk_bf16_f32 v198, v92, v93
    v_lshlrev_b32 v22, 16, v199
    v_and_b32 v23, 0xffff0000, v199
    v_pk_fma_f32 v[94:95], v[94:95], v[234:235], v[22:23]
    v_cvt_pk_bf16_f32 v199, v94, v95
    buffer_store_dwordx2 v[198:199], v4, s[72:75], s89 offen
    v_lshlrev_b32 v24, 16, v200
    v_and_b32 v25, 0xffff0000, v200
    v_pk_fma_f32 v[96:97], v[96:97], v[236:237], v[24:25]
    v_cvt_pk_bf16_f32 v200, v96, v97
    v_lshlrev_b32 v26, 16, v201
    v_and_b32 v27, 0xffff0000, v201
    v_pk_fma_f32 v[98:99], v[98:99], v[238:239], v[26:27]
    v_cvt_pk_bf16_f32 v201, v98, v99
    buffer_store_dwordx2 v[200:201], v4, s[72:75], s90 offen
    v_lshlrev_b32 v28, 16, v202
    v_and_b32 v29, 0xffff0000, v202
    v_pk_fma_f32 v[100:101], v[100:101], v[240:241], v[28:29]
    v_cvt_pk_bf16_f32 v202, v100, v101
    v_lshlrev_b32 v30, 16, v203
    v_and_b32 v31, 0xffff0000, v203
    v_pk_fma_f32 v[102:103], v[102:103], v[242:243], v[30:31]
    v_cvt_pk_bf16_f32 v203, v102, v103
    buffer_store_dwordx2 v[202:203], v4, s[72:75], s91 offen
    v_lshlrev_b32 v32, 16, v204
    v_and_b32 v33, 0xffff0000, v204
    v_pk_fma_f32 v[104:105], v[104:105], v[244:245], v[32:33]
    v_cvt_pk_bf16_f32 v204, v104, v105
    v_lshlrev_b32 v34, 16, v205
    v_and_b32 v35, 0xffff0000, v205
    v_pk_fma_f32 v[106:107], v[106:107], v[246:247], v[34:35]
    v_cvt_pk_bf16_f32 v205, v106, v107
    buffer_store_dwordx2 v[204:205], v4, s[72:75], s92 offen
kg_exit:
    s_endpgm
gemm_kernel_end:
.section .rodata,"a"
.p2align 6
.amdhsa_kernel prep_kernel
  .amdhsa_next_free_vgpr 95
  .amdhsa_next_free_sgpr 88
  .amdhsa_accum_offset 96
  .amdhsa_group_segment_fixed_size 0
  .amdhsa_kernarg_size 152
  .amdhsa_user_sgpr_count 2
  .amdhsa_user_sgpr_kernarg_segment_ptr 1
  .amdhsa_system_sgpr_workgroup_id_x 1
  .amdhsa_float_denorm_mode_32 3
.end_amdhsa_kernel
.p2align 6
.amdhsa_kernel conv_kernel
  .amdhsa_next_free_vgpr 104
  .amdhsa_next_free_sgpr 84
  .amdhsa_accum_offset 104
  .amdhsa_group_segment_fixed_size 0
  .amdhsa_kernarg_size 152
  .amdhsa_user_sgpr_count 2
  .amdhsa_user_sgpr_kernarg_segment_ptr 1
  .amdhsa_system_sgpr_workgroup_id_x 1
  .amdhsa_float_denorm_mode_32 3
.end_amdhsa_kernel
.p2align 6
.amdhsa_kernel gemm_kernel
  .amdhsa_next_free_vgpr 408
  .amdhsa_next_free_sgpr 100
  .amdhsa_accum_offset 248
  .amdhsa_group_segment_fixed_size 0
  .amdhsa_kernarg_size 152
  .amdhsa_user_sgpr_count 2
  .amdhsa_user_sgpr_kernarg_segment_ptr 1
  .amdhsa_system_sgpr_workgroup_id_x 1
  .amdhsa_float_denorm_mode_32 3
.end_amdhsa_kernel
```
